```python
import torch

def _softmax(x, axis=-1):
    return torch.softmax(x, dim=axis)
def _gelu(x):
    return torch.nn.functional.gelu(x, approximate="tanh")
def _silu(x):
    return torch.nn.functional.silu(x)
def _sigmoid(x):
    return torch.sigmoid(x)
def _layernorm(x, axis=-1, eps=1e-5):
    m = x.mean(dim=axis, keepdim=True)
    v = x.var(dim=axis, keepdim=True, unbiased=False)
    return (x - m) / torch.sqrt(v + eps)
def _scatter_add(tgt, idx, src, axis=0):
    return tgt.clone().index_add_(axis, idx, src)
def _segment_sum(src, seg, n):
    out = torch.zeros((n,) + src.shape[1:], dtype=src.dtype)
    return out.index_add_(0, seg, src)
def _pad(x, pw):
    flat = tuple(v for pair in reversed(pw) for v in pair)
    return torch.nn.functional.pad(x, flat)

kernel_name = 'standalone__mha_softmax__near_ridge'

def setup_inputs():

    _w = (lambda a: (lambda t: t.to(torch.bfloat16) if t.is_floating_point() else t)(torch.as_tensor(a)))
    B, H, Sq, Sk, D = 8, 32, 1600, 512, 128
    return {
        "q": _w((lambda *s: torch.randn(*s, dtype=torch.bfloat16) * 0.8)(B, H, Sq, D)),
        "k": _w((lambda *s: torch.randn(*s, dtype=torch.bfloat16) * 0.8)(B, H, Sk, D)),
        "v": _w((lambda *s: torch.randn(*s, dtype=torch.bfloat16) * 0.05)(B, H, Sk, D)),
    }

def reference(q, k, v):
    scale = q.shape[-1] ** -0.5
    scores = torch.einsum("bhqd,bhkd->bhqk", q, k) * scale
    p = _softmax(scores, axis=-1)
    return torch.einsum("bhqk,bhkd->bhqd", p, v)
```

```asm
; @launch grid=(256,1,1) block=(256,1,1) lds=163840
.amdgcn_target "amdgcn-amd-amdhsa--gfx950"
.text
.globl standalone__mha_softmax__near_ridge_kernel
.p2align 8
.type standalone__mha_softmax__near_ridge_kernel,@function
standalone__mha_softmax__near_ridge_kernel:
    s_mov_b32 s29, 10
    s_cmp_ge_u32 s2, 256
    s_cbranch_scc1 L_end
    s_load_dwordx4 s[4:7], s[0:1], 0
    s_load_dwordx4 s[8:11], s[0:1], 16
    v_lshrrev_b32 v48, 6, v0
    v_and_b32 v49, 63, v0
    v_readfirstlane_b32 s28, v48
    v_and_b32 v50, 15, v0
    v_bfe_u32 v51, v0, 4, 2
    v_lshrrev_b32 v16, 2, v50
    v_lshlrev_b32 v16, 11, v16
    v_and_b32 v52, 3, v50
    v_lshl_add_u32 v16, v52, 8, v16
    v_lshl_add_u32 v16, v51, 4, v16
    v_lshl_add_u32 v16, v48, 13, v16
    v_lshrrev_b32 v53, 4, v0
    v_xor_b32 v54, v53, v50
    v_lshlrev_b32 v1, 8, v53
    v_lshl_add_u32 v1, v54, 4, v1
    s_lshl_b32 s32, s28, 10
    s_add_u32 s32, s32, 65536
    s_mul_i32 s46, s2, 409600
    s_bfe_u32 s51, s2, 0x20003
    s_lshl_b32 s51, s51, 15
    s_xor_b32 s39, s51, 4096
    s_lshl_b32 s47, s2, 17
    s_mov_b32 s18, 131072
    s_mov_b32 s19, 0x00020000
    s_mov_b32 s14, 409600
    s_mov_b32 s15, 0x00020000
    s_mov_b32 s22, 131072
    s_mov_b32 s23, 0x00020000
    s_mov_b32 s26, 409600
    s_mov_b32 s27, 0x00020000
    s_getpc_b64 s[48:49]
L_pc:
    s_lshr_b32 s50, s2, 3
    s_lshl_b32 s50, s50, 2
    s_add_u32 s50, s50, s28
    s_and_b32 s50, s50, 63
    s_min_u32 s50, s50, (L_slow-L_pc)/1024
    s_lshl_b32 s50, s50, 10
    s_add_u32 s48, s48, s50
    s_addc_u32 s49, s49, 0
    s_and_b32 s48, s48, 0xffffff80
    v_lshlrev_b32 v62, 4, v49
    v_mov_b32 v63, s49
    v_add_co_u32 v62, vcc, s48, v62
    s_nop 1
    v_addc_co_u32 v63, vcc, 0, v63, vcc
    global_load_dwordx4 v[92:95], v[62:63], off
    s_waitcnt lgkmcnt(0)
    s_add_u32 s16, s6, s47
    s_addc_u32 s17, s7, 0
    buffer_load_dwordx4 v[128:131], v16, s[16:19], s51 offen offset:0 nt
    s_add_u32 s12, s4, s46
    s_addc_u32 s13, s5, 0
    s_add_u32 s20, s8, s47
    s_addc_u32 s21, s9, 0
    s_add_u32 s24, s10, s46
    s_addc_u32 s25, s11, 0
    buffer_load_dwordx4 v[132:135], v16, s[16:19], s51 offen offset:64 nt
    buffer_load_dwordx4 v[136:139], v16, s[16:19], s51 offen offset:128 nt
    buffer_load_dwordx4 v[140:143], v16, s[16:19], s51 offen offset:192 nt
    buffer_load_dwordx4 v[144:147], v16, s[16:19], s51 offen offset:1024 nt
    buffer_load_dwordx4 v[148:151], v16, s[16:19], s51 offen offset:1088 nt
    buffer_load_dwordx4 v[152:155], v16, s[16:19], s51 offen offset:1152 nt
    buffer_load_dwordx4 v[156:159], v16, s[16:19], s51 offen offset:1216 nt
    s_xor_b32 s36, s51, 32768
    s_xor_b32 s37, s51, 65536
    s_xor_b32 s38, s51, 98304
    s_xor_b32 s40, s51, 36864
    s_xor_b32 s41, s51, 69632
    s_xor_b32 s42, s51, 102400
    s_lshl_b32 s33, s28, 13
    s_add_u32 s33, s33, 131072
    s_mov_b32 s34, 0x3e0293ee
    s_mov_b32 s35, s34
    s_mov_b32 s30, 73728
    s_mov_b32 s31, 40960
    v_lshlrev_b32 v55, 2, v51
    v_xor_b32 v55, v55, v50
    v_lshlrev_b32 v17, 4, v55
    v_lshl_add_u32 v17, v51, 8, v17
    v_lshl_add_u32 v17, v48, 13, v17
    v_lshlrev_b32 v56, 4, v49
    v_lshlrev_b32 v2, 8, v50
    v_lshl_add_u32 v2, v48, 6, v2
    v_lshl_add_u32 v2, v51, 4, v2
    v_lshl_add_u32 v3, v48, 13, v56
    v_add_u32 v4, 0x2000, v3
    v_and_b32 v4, 0x7fff, v4
    v_add_u32 v5, 0x4000, v3
    v_and_b32 v5, 0x7fff, v5
    v_add_u32 v6, 0x6000, v3
    v_and_b32 v6, 0x7fff, v6
    v_lshrrev_b32 v60, 1, v51
    v_lshlrev_b32 v9, 4, v50
    v_lshl_add_u32 v9, v60, 8, v9
    v_add_u32 v9, 122880, v9
    v_lshl_add_u32 v8, v48, 2, v9
    v_mov_b32 v10, 0x51800000
    s_mov_b32 s60, 0x2e800000
    v_bfe_u32 v57, v0, 2, 2
    v_xor_b32 v58, v57, v48
    v_lshlrev_b32 v18, 6, v58
    v_lshl_add_u32 v18, v52, 4, v18
    v_lshl_add_u32 v18, v57, 8, v18
    v_lshl_add_u32 v18, v51, 11, v18
    v_add_u32 v18, 131072, v18
    v_sub_u32 v18, v18, v56
    v_lshrrev_b32 v61, 3, v50
    v_xor_b32 v61, v61, v60
    v_and_b32 v59, 2, v50
    v_or_b32 v61, v61, v59
    v_mov_b32 v59, 0x3f803f80
    v_cmp_eq_u32 vcc, 0, v61
    v_mov_b32 v24, 0x44444444
    v_and_b32 v61, 1, v50
    v_cndmask_b32 v60, 0, v59, vcc
    v_cmp_eq_u32 vcc, 1, v61
    v_mov_b32 v59, 0xeeeeeeee
    v_mov_b64 v[28:29], 0
    v_cndmask_b32 v24, v24, v59, vcc
    v_mov_b64 v[30:31], 0
    v_xor_b32 v59, v51, v50
    v_lshlrev_b32 v7, 4, v59
    v_lshl_add_u32 v7, v50, 8, v7
    v_add_u32 v7, 65536, v7
    v_xor_b32 v0, 64, v7
    v_xor_b32 v15, 0x80, v7
    v_xor_b32 v25, 0xc0, v7
    ds_write_b128 v9, v[28:31] offset:4096
    ds_write_b128 v9, v[28:31] offset:4608
    ds_write_b128 v9, v[28:31] offset:5120
    ds_write_b128 v9, v[28:31] offset:5632
    ds_write_b128 v9, v[28:31] offset:6144
    s_mov_b32 s46, 0
    s_mov_b32 s47, 0
    v_accvgpr_write_b32 a192, v60
    v_accvgpr_write_b32 a193, v60
    v_accvgpr_write_b32 a194, v60
    v_accvgpr_write_b32 a195, v60
    v_accvgpr_write_b32 a196, 0
    v_accvgpr_write_b32 a197, 0
    v_accvgpr_write_b32 a198, 0
    v_accvgpr_write_b32 a199, 0
    v_accvgpr_write_b32 a160, 0
    v_accvgpr_write_b32 a161, 0
    v_accvgpr_write_b32 a162, 0
    v_accvgpr_write_b32 a163, 0
    v_accvgpr_write_b32 a176, 0
    v_accvgpr_write_b32 a177, 0
    v_accvgpr_write_b32 a178, 0
    v_accvgpr_write_b32 a179, 0
    v_accvgpr_write_b32 a248, 0
    v_accvgpr_write_b32 a249, 0
    v_accvgpr_write_b32 a250, 0
    v_accvgpr_write_b32 a251, 0
    s_add_u32 m0, s32, 32768
    s_mov_b32 s43, 0
    buffer_load_dwordx4 v1, s[12:15], s43 offen lds
    s_add_u32 m0, s32, 36864
    s_mov_b32 s43, 4096
    buffer_load_dwordx4 v1, s[12:15], s43 offen lds
    s_add_u32 m0, s32, 40960
    s_mov_b32 s43, 8192
    buffer_load_dwordx4 v1, s[12:15], s43 offen lds
    s_add_u32 m0, s32, 45056
    s_mov_b32 s43, 12288
    buffer_load_dwordx4 v1, s[12:15], s43 offen lds
    s_waitcnt vmcnt(11)
    v_lshlrev_b32 v12, 16, v128
    v_and_b32 v13, 0xffff0000, v128
    v_lshlrev_b32 v20, 16, v129
    v_and_b32 v21, 0xffff0000, v129
    v_lshlrev_b32 v22, 16, v130
    v_and_b32 v23, 0xffff0000, v130
    v_lshlrev_b32 v26, 16, v131
    v_and_b32 v27, 0xffff0000, v131
    v_pk_mul_f32 v[12:13], v[12:13], s[34:35]
    v_pk_mul_f32 v[20:21], v[20:21], s[34:35]
    v_pk_mul_f32 v[22:23], v[22:23], s[34:35]
    v_pk_mul_f32 v[26:27], v[26:27], s[34:35]
    v_cvt_pk_bf16_f32 v128, v12, v13
    v_cvt_pk_bf16_f32 v129, v20, v21
    v_cvt_pk_bf16_f32 v130, v22, v23
    v_cvt_pk_bf16_f32 v131, v26, v27
    s_waitcnt vmcnt(10)
    v_lshlrev_b32 v12, 16, v132
    v_and_b32 v13, 0xffff0000, v132
    v_lshlrev_b32 v20, 16, v133
    v_and_b32 v21, 0xffff0000, v133
    v_lshlrev_b32 v22, 16, v134
    v_and_b32 v23, 0xffff0000, v134
    v_lshlrev_b32 v26, 16, v135
    v_and_b32 v27, 0xffff0000, v135
    v_pk_mul_f32 v[12:13], v[12:13], s[34:35]
    v_pk_mul_f32 v[20:21], v[20:21], s[34:35]
    v_pk_mul_f32 v[22:23], v[22:23], s[34:35]
    v_pk_mul_f32 v[26:27], v[26:27], s[34:35]
    v_cvt_pk_bf16_f32 v132, v12, v13
    v_cvt_pk_bf16_f32 v133, v20, v21
    v_cvt_pk_bf16_f32 v134, v22, v23
    v_cvt_pk_bf16_f32 v135, v26, v27
    s_add_u32 m0, s32, 49152
    s_mov_b32 s43, 16384
    buffer_load_dwordx4 v1, s[12:15], s43 offen lds
    s_waitcnt vmcnt(10)
    v_lshlrev_b32 v12, 16, v136
    v_and_b32 v13, 0xffff0000, v136
    v_lshlrev_b32 v20, 16, v137
    v_and_b32 v21, 0xffff0000, v137
    v_lshlrev_b32 v22, 16, v138
    v_and_b32 v23, 0xffff0000, v138
    v_lshlrev_b32 v26, 16, v139
    v_and_b32 v27, 0xffff0000, v139
    v_pk_mul_f32 v[12:13], v[12:13], s[34:35]
    v_pk_mul_f32 v[20:21], v[20:21], s[34:35]
    v_pk_mul_f32 v[22:23], v[22:23], s[34:35]
    v_pk_mul_f32 v[26:27], v[26:27], s[34:35]
    v_cvt_pk_bf16_f32 v136, v12, v13
    v_cvt_pk_bf16_f32 v137, v20, v21
    v_cvt_pk_bf16_f32 v138, v22, v23
    v_cvt_pk_bf16_f32 v139, v26, v27
    s_add_u32 m0, s32, 53248
    s_mov_b32 s43, 20480
    buffer_load_dwordx4 v1, s[12:15], s43 offen lds
    s_waitcnt vmcnt(10)
    v_lshlrev_b32 v12, 16, v140
    v_and_b32 v13, 0xffff0000, v140
    v_lshlrev_b32 v20, 16, v141
    v_and_b32 v21, 0xffff0000, v141
    v_lshlrev_b32 v22, 16, v142
    v_and_b32 v23, 0xffff0000, v142
    v_lshlrev_b32 v26, 16, v143
    v_and_b32 v27, 0xffff0000, v143
    v_pk_mul_f32 v[12:13], v[12:13], s[34:35]
    v_pk_mul_f32 v[20:21], v[20:21], s[34:35]
    v_pk_mul_f32 v[22:23], v[22:23], s[34:35]
    v_pk_mul_f32 v[26:27], v[26:27], s[34:35]
    v_cvt_pk_bf16_f32 v140, v12, v13
    v_cvt_pk_bf16_f32 v141, v20, v21
    v_cvt_pk_bf16_f32 v142, v22, v23
    v_cvt_pk_bf16_f32 v143, v26, v27
    s_add_u32 m0, s32, 24576
    s_mov_b32 s43, 24576
    buffer_load_dwordx4 v1, s[12:15], s43 offen lds
    s_waitcnt vmcnt(10)
    v_lshlrev_b32 v12, 16, v144
    v_and_b32 v13, 0xffff0000, v144
    v_lshlrev_b32 v20, 16, v145
    v_and_b32 v21, 0xffff0000, v145
    v_lshlrev_b32 v22, 16, v146
    v_and_b32 v23, 0xffff0000, v146
    v_lshlrev_b32 v26, 16, v147
    v_and_b32 v27, 0xffff0000, v147
    v_pk_mul_f32 v[12:13], v[12:13], s[34:35]
    v_pk_mul_f32 v[20:21], v[20:21], s[34:35]
    v_pk_mul_f32 v[22:23], v[22:23], s[34:35]
    v_pk_mul_f32 v[26:27], v[26:27], s[34:35]
    v_cvt_pk_bf16_f32 v144, v12, v13
    v_cvt_pk_bf16_f32 v145, v20, v21
    v_cvt_pk_bf16_f32 v146, v22, v23
    v_cvt_pk_bf16_f32 v147, v26, v27
    s_waitcnt vmcnt(9)
    v_lshlrev_b32 v12, 16, v148
    v_and_b32 v13, 0xffff0000, v148
    v_lshlrev_b32 v20, 16, v149
    v_and_b32 v21, 0xffff0000, v149
    v_lshlrev_b32 v22, 16, v150
    v_and_b32 v23, 0xffff0000, v150
    v_lshlrev_b32 v26, 16, v151
    v_and_b32 v27, 0xffff0000, v151
    v_pk_mul_f32 v[12:13], v[12:13], s[34:35]
    v_pk_mul_f32 v[20:21], v[20:21], s[34:35]
    v_pk_mul_f32 v[22:23], v[22:23], s[34:35]
    v_pk_mul_f32 v[26:27], v[26:27], s[34:35]
    v_cvt_pk_bf16_f32 v148, v12, v13
    v_cvt_pk_bf16_f32 v149, v20, v21
    v_cvt_pk_bf16_f32 v150, v22, v23
    v_cvt_pk_bf16_f32 v151, v26, v27
    s_add_u32 m0, s32, 28672
    s_mov_b32 s43, 28672
    buffer_load_dwordx4 v1, s[12:15], s43 offen lds
    s_waitcnt vmcnt(9)
    v_lshlrev_b32 v12, 16, v152
    v_and_b32 v13, 0xffff0000, v152
    v_lshlrev_b32 v20, 16, v153
    v_and_b32 v21, 0xffff0000, v153
    v_lshlrev_b32 v22, 16, v154
    v_and_b32 v23, 0xffff0000, v154
    v_lshlrev_b32 v26, 16, v155
    v_and_b32 v27, 0xffff0000, v155
    v_pk_mul_f32 v[12:13], v[12:13], s[34:35]
    v_pk_mul_f32 v[20:21], v[20:21], s[34:35]
    v_pk_mul_f32 v[22:23], v[22:23], s[34:35]
    v_pk_mul_f32 v[26:27], v[26:27], s[34:35]
    v_cvt_pk_bf16_f32 v152, v12, v13
    v_cvt_pk_bf16_f32 v153, v20, v21
    v_cvt_pk_bf16_f32 v154, v22, v23
    v_cvt_pk_bf16_f32 v155, v26, v27
    s_mov_b32 m0, s33
    s_nop 0
    buffer_load_dwordx4 v17, s[20:23], s51 offen offset:0 nt lds
    s_waitcnt vmcnt(9)
    v_lshlrev_b32 v12, 16, v156
    v_and_b32 v13, 0xffff0000, v156
    v_lshlrev_b32 v20, 16, v157
    v_and_b32 v21, 0xffff0000, v157
    v_lshlrev_b32 v22, 16, v158
    v_and_b32 v23, 0xffff0000, v158
    v_lshlrev_b32 v26, 16, v159
    v_and_b32 v27, 0xffff0000, v159
    v_pk_mul_f32 v[12:13], v[12:13], s[34:35]
    v_pk_mul_f32 v[20:21], v[20:21], s[34:35]
    v_pk_mul_f32 v[22:23], v[22:23], s[34:35]
    v_pk_mul_f32 v[26:27], v[26:27], s[34:35]
    v_cvt_pk_bf16_f32 v156, v12, v13
    v_cvt_pk_bf16_f32 v157, v20, v21
    v_cvt_pk_bf16_f32 v158, v22, v23
    v_cvt_pk_bf16_f32 v159, v26, v27
    s_mov_b32 m0, s33
    s_nop 0
    buffer_load_dwordx4 v17, s[20:23], s51 offen offset:1024 nt lds
    s_waitcnt vmcnt(6) lgkmcnt(0)
    s_barrier
    ds_read_b128 a[128:131], v7 offset:32768
    ds_read_b128 a[132:135], v0 offset:32768
    ds_read_b128 a[136:139], v15 offset:32768
    ds_read_b128 a[140:143], v25 offset:32768
    ds_read_b128 a[144:147], v7 offset:36864
    ds_read_b128 a[148:151], v0 offset:36864
    ds_read_b128 a[152:155], v15 offset:36864
    ds_read_b128 a[156:159], v25 offset:36864
    s_waitcnt lgkmcnt(7)
    v_mfma_f32_16x16x32_bf16 v[48:51], v[128:131], a[128:131], -4.0
    s_waitcnt lgkmcnt(6)
    v_mfma_f32_16x16x32_bf16 v[48:51], v[132:135], a[132:135], v[48:51]
    s_waitcnt lgkmcnt(5)
    s_mov_b32 m0, s33
    s_nop 0
    buffer_load_dwordx4 v17, s[20:23], s51 offen offset:2048 nt lds
    v_mfma_f32_16x16x32_bf16 v[48:51], v[136:139], a[136:139], v[48:51]
    s_waitcnt lgkmcnt(4)
    v_mfma_f32_16x16x32_bf16 v[48:51], v[140:143], a[140:143], v[48:51]
    v_mfma_f32_16x16x32_bf16 v[52:55], v[156:159], a[140:143], -4.0
    v_mfma_f32_16x16x32_bf16 v[52:55], v[152:155], a[136:139], v[52:55]
    v_mfma_f32_16x16x32_bf16 v[52:55], v[148:151], a[132:135], v[52:55]
    v_mfma_f32_16x16x32_bf16 v[52:55], v[144:147], a[128:131], v[52:55]
    s_waitcnt lgkmcnt(0)
    s_nop 2
    v_exp_f32 v48, v48
    s_mov_b32 m0, s33
    s_nop 0
    buffer_load_dwordx4 v17, s[20:23], s51 offen offset:3072 nt lds
    v_exp_f32 v49, v49
    ds_read_b128 a[128:131], v7 offset:40960
    ds_read_b128 a[132:135], v0 offset:40960
    v_exp_f32 v50, v50
    ds_read_b128 a[136:139], v15 offset:40960
    v_cvt_pk_bf16_f32 v64, v48, v49
    v_exp_f32 v51, v51
    s_nop 0
    v_cvt_pk_bf16_f32 v65, v50, v51
    v_mfma_f32_16x16x32_bf16 v[56:59], v[128:131], a[144:147], -4.0
    v_exp_f32 v52, v52
    v_mfma_f32_16x16x32_bf16 v[56:59], v[132:135], a[148:151], v[56:59]
    s_waitcnt vmcnt(4)
    s_barrier
    v_mfma_f32_16x16x32_bf16 v[56:59], v[136:139], a[152:155], v[56:59]
    v_exp_f32 v53, v53
    s_add_u32 m0, s33, 4096
    s_nop 0
    buffer_load_dwordx4 v17, s[20:23], s39 offen offset:0 nt lds
    v_mfma_f32_16x16x32_bf16 v[56:59], v[140:143], a[156:159], v[56:59]
    v_cvt_pk_bf16_f32 v66, v52, v53
    v_mfma_f32_16x16x32_bf16 v[60:63], v[156:159], a[156:159], -4.0
    v_exp_f32 v54, v54
    v_mfma_f32_16x16x32_bf16 v[60:63], v[152:155], a[152:155], v[60:63]
    ds_read_b128 a[140:143], v25 offset:40960
    v_mfma_f32_16x16x32_bf16 v[60:63], v[148:151], a[148:151], v[60:63]
    v_exp_f32 v55, v55
    v_mfma_f32_16x16x32_bf16 v[60:63], v[144:147], a[144:147], v[60:63]
    s_waitcnt lgkmcnt(1)
    v_cvt_pk_bf16_f32 v67, v54, v55
    v_exp_f32 v56, v56
    ds_write_b128 v3, v[64:67] offset:0
    v_exp_f32 v57, v57
    ds_read_b128 a[144:147], v7 offset:45056
    ds_read_b128 a[148:151], v0 offset:45056
    v_exp_f32 v58, v58
    ds_read_b128 a[152:155], v15 offset:45056
    v_cvt_pk_bf16_f32 v68, v56, v57
    v_exp_f32 v59, v59
    s_nop 0
    v_cvt_pk_bf16_f32 v69, v58, v59
    v_mfma_f32_16x16x32_bf16 v[48:51], v[128:131], a[128:131], -4.0
    v_exp_f32 v60, v60
    v_mfma_f32_16x16x32_bf16 v[48:51], v[132:135], a[132:135], v[48:51]
    s_add_u32 m0, s33, 4096
    s_nop 0
    buffer_load_dwordx4 v17, s[20:23], s39 offen offset:1024 nt lds
    v_mfma_f32_16x16x32_bf16 v[48:51], v[136:139], a[136:139], v[48:51]
    s_waitcnt lgkmcnt(4)
    v_exp_f32 v61, v61
    v_mfma_f32_16x16x32_bf16 v[48:51], v[140:143], a[140:143], v[48:51]
    ds_read_b128 a[156:159], v25 offset:45056
    v_cvt_pk_bf16_f32 v70, v60, v61
    v_mfma_f32_16x16x32_bf16 v[52:55], v[156:159], a[140:143], -4.0
    v_exp_f32 v62, v62
    v_mfma_f32_16x16x32_bf16 v[52:55], v[152:155], a[136:139], v[52:55]
    s_add_u32 m0, s33, 4096
    s_nop 0
    buffer_load_dwordx4 v17, s[20:23], s39 offen offset:2048 nt lds
    v_mfma_f32_16x16x32_bf16 v[52:55], v[148:151], a[132:135], v[52:55]
    v_exp_f32 v63, v63
    v_mfma_f32_16x16x32_bf16 v[52:55], v[144:147], a[128:131], v[52:55]
    s_waitcnt lgkmcnt(1)
    v_cvt_pk_bf16_f32 v71, v62, v63
    v_exp_f32 v48, v48
    ds_write_b128 v3, v[68:71] offset:1024
    v_exp_f32 v49, v49
    ds_read_b128 a[128:131], v7 offset:49152
    ds_read_b128 a[132:135], v0 offset:49152
    v_exp_f32 v50, v50
    ds_read_b128 a[136:139], v15 offset:49152
    v_cvt_pk_bf16_f32 v72, v48, v49
    v_exp_f32 v51, v51
    s_nop 0
    v_cvt_pk_bf16_f32 v73, v50, v51
    v_mfma_f32_16x16x32_bf16 v[56:59], v[128:131], a[144:147], -4.0
    v_exp_f32 v52, v52
    v_mfma_f32_16x16x32_bf16 v[56:59], v[132:135], a[148:151], v[56:59]
    s_add_u32 m0, s33, 4096
    s_nop 0
    buffer_load_dwordx4 v17, s[20:23], s39 offen offset:3072 nt lds
    v_mfma_f32_16x16x32_bf16 v[56:59], v[136:139], a[152:155], v[56:59]
    s_waitcnt lgkmcnt(4)
    v_exp_f32 v53, v53
    v_mfma_f32_16x16x32_bf16 v[56:59], v[140:143], a[156:159], v[56:59]
    v_cvt_pk_bf16_f32 v74, v52, v53
    s_add_u32 m0, s32, 0
    s_mov_b32 s43, 32768
    buffer_load_dwordx4 v1, s[12:15], s43 offen lds
    v_mfma_f32_16x16x32_bf16 v[60:63], v[156:159], a[156:159], -4.0
    v_exp_f32 v54, v54
    v_mfma_f32_16x16x32_bf16 v[60:63], v[152:155], a[152:155], v[60:63]
    ds_read_b128 a[140:143], v25 offset:49152
    v_mfma_f32_16x16x32_bf16 v[60:63], v[148:151], a[148:151], v[60:63]
    v_exp_f32 v55, v55
    v_mfma_f32_16x16x32_bf16 v[60:63], v[144:147], a[144:147], v[60:63]
    v_cvt_pk_bf16_f32 v75, v54, v55
    v_exp_f32 v56, v56
    ds_write_b128 v3, v[72:75] offset:2048
    v_exp_f32 v57, v57
    ds_read_b128 a[144:147], v7 offset:53248
    ds_read_b128 a[148:151], v0 offset:53248
    v_exp_f32 v58, v58
    ds_read_b128 a[152:155], v15 offset:53248
    v_cvt_pk_bf16_f32 v76, v56, v57
    v_exp_f32 v59, v59
    s_nop 0
    v_cvt_pk_bf16_f32 v77, v58, v59
    v_smfmac_f32_16x16x64_bf16 v[28:31], a[192:195], v[64:71], v24
    s_waitcnt lgkmcnt(5)
    v_mfma_f32_16x16x32_bf16 v[48:51], v[128:131], a[128:131], -4.0
    v_exp_f32 v60, v60
    v_mfma_f32_16x16x32_bf16 v[48:51], v[132:135], a[132:135], v[48:51]
    s_add_u32 m0, s32, 4096
    s_mov_b32 s43, 36864
    buffer_load_dwordx4 v1, s[12:15], s43 offen lds
    v_mfma_f32_16x16x32_bf16 v[48:51], v[136:139], a[136:139], v[48:51]
    s_waitcnt lgkmcnt(4)
    v_exp_f32 v61, v61
    v_mfma_f32_16x16x32_bf16 v[48:51], v[140:143], a[140:143], v[48:51]
    ds_read_b128 a[156:159], v25 offset:53248
    v_cvt_pk_bf16_f32 v78, v60, v61
    v_mfma_f32_16x16x32_bf16 v[52:55], v[156:159], a[140:143], -4.0
    v_exp_f32 v62, v62
    v_mfma_f32_16x16x32_bf16 v[52:55], v[152:155], a[136:139], v[52:55]
    buffer_load_dwordx4 v[160:163], v16, s[16:19], s36 offen offset:0 nt
    buffer_load_dwordx4 v[164:167], v16, s[16:19], s36 offen offset:64 nt
    v_mfma_f32_16x16x32_bf16 v[52:55], v[148:151], a[132:135], v[52:55]
    v_exp_f32 v63, v63
    v_mfma_f32_16x16x32_bf16 v[52:55], v[144:147], a[128:131], v[52:55]
    s_waitcnt lgkmcnt(1)
    v_cvt_pk_bf16_f32 v79, v62, v63
    v_exp_f32 v48, v48
    ds_write_b128 v3, v[76:79] offset:3072
    v_exp_f32 v49, v49
    ds_read_b128 a[128:131], v7 offset:24576
    ds_read_b128 a[132:135], v0 offset:24576
    v_exp_f32 v50, v50
    ds_read_b128 a[136:139], v15 offset:24576
    v_cvt_pk_bf16_f32 v80, v48, v49
    v_exp_f32 v51, v51
    s_nop 0
    v_cvt_pk_bf16_f32 v81, v50, v51
    v_mfma_f32_16x16x32_bf16 v[56:59], v[128:131], a[144:147], -4.0
    v_exp_f32 v52, v52
    v_mfma_f32_16x16x32_bf16 v[56:59], v[132:135], a[148:151], v[56:59]
    buffer_load_dwordx4 v[168:171], v16, s[16:19], s36 offen offset:128 nt
    buffer_load_dwordx4 v[172:175], v16, s[16:19], s36 offen offset:192 nt
    v_mfma_f32_16x16x32_bf16 v[56:59], v[136:139], a[152:155], v[56:59]
    s_waitcnt lgkmcnt(4)
    v_exp_f32 v53, v53
    v_mfma_f32_16x16x32_bf16 v[56:59], v[140:143], a[156:159], v[56:59]
    v_cvt_pk_bf16_f32 v82, v52, v53
    v_mfma_f32_16x16x32_bf16 v[60:63], v[156:159], a[156:159], -4.0
    v_exp_f32 v54, v54
    v_mfma_f32_16x16x32_bf16 v[60:63], v[152:155], a[152:155], v[60:63]
    ds_read_b128 a[140:143], v25 offset:24576
    buffer_load_dwordx4 v[176:179], v16, s[16:19], s36 offen offset:1024 nt
    buffer_load_dwordx4 v[180:183], v16, s[16:19], s36 offen offset:1088 nt
    v_mfma_f32_16x16x32_bf16 v[60:63], v[148:151], a[148:151], v[60:63]
    v_exp_f32 v55, v55
    v_mfma_f32_16x16x32_bf16 v[60:63], v[144:147], a[144:147], v[60:63]
    v_cvt_pk_bf16_f32 v83, v54, v55
    v_exp_f32 v56, v56
    ds_write_b128 v3, v[80:83] offset:4096
    v_exp_f32 v57, v57
    ds_read_b128 a[144:147], v7 offset:28672
    ds_read_b128 a[148:151], v0 offset:28672
    v_exp_f32 v58, v58
    ds_read_b128 a[152:155], v15 offset:28672
    v_cvt_pk_bf16_f32 v84, v56, v57
    v_exp_f32 v59, v59
    buffer_load_dwordx4 v[184:187], v16, s[16:19], s36 offen offset:1152 nt
    buffer_load_dwordx4 v[188:191], v16, s[16:19], s36 offen offset:1216 nt
    v_cvt_pk_bf16_f32 v85, v58, v59
    v_smfmac_f32_16x16x64_bf16 a[196:199], a[192:195], v[72:79], v24
    s_waitcnt lgkmcnt(5)
    v_mfma_f32_16x16x32_bf16 v[48:51], v[128:131], a[128:131], -4.0
    v_exp_f32 v60, v60
    v_mfma_f32_16x16x32_bf16 v[48:51], v[132:135], a[132:135], v[48:51]
    s_waitcnt vmcnt(8) lgkmcnt(3)
    s_barrier
    v_add_u32 v19, v18, v3
    v_add_u32 v14, v18, v4
    ds_read_b64_tr_b16 a[0:1], v19 offset:0
    ds_read_b64_tr_b16 a[2:3], v19 offset:1024
    ds_read_b64_tr_b16 a[64:65], v19 offset:8
    ds_read_b64_tr_b16 a[66:67], v19 offset:1032
    ds_read_b64_tr_b16 a[16:17], v14 offset:0
    ds_read_b64_tr_b16 a[18:19], v14 offset:1024
    ds_read_b64_tr_b16 a[80:81], v14 offset:8
    ds_read_b64_tr_b16 a[82:83], v14 offset:1032
    v_add_u32 v19, v18, v5
    v_add_u32 v14, v18, v6
    ds_read_b64_tr_b16 a[32:33], v19 offset:0
    ds_read_b64_tr_b16 a[34:35], v19 offset:1024
    ds_read_b64_tr_b16 a[96:97], v19 offset:8
    ds_read_b64_tr_b16 a[98:99], v19 offset:1032
    ds_read_b64_tr_b16 a[48:49], v14 offset:0
    ds_read_b64_tr_b16 a[50:51], v14 offset:1024
    ds_read_b64_tr_b16 a[112:113], v14 offset:8
    ds_read_b64_tr_b16 a[114:115], v14 offset:1032
    ds_inc_u32 v9, v24 offset:4608
    v_mfma_f32_16x16x32_bf16 v[48:51], v[136:139], a[136:139], v[48:51]
    v_exp_f32 v61, v61
    v_mfma_f32_16x16x32_bf16 v[48:51], v[140:143], a[140:143], v[48:51]
    ds_read_b128 a[156:159], v25 offset:28672
    v_cvt_pk_bf16_f32 v86, v60, v61
    v_mfma_f32_16x16x32_bf16 v[52:55], v[156:159], a[140:143], -4.0
    v_exp_f32 v62, v62
    v_mfma_f32_16x16x32_bf16 v[52:55], v[152:155], a[136:139], v[52:55]
    v_mfma_f32_16x16x32_bf16 v[52:55], v[148:151], a[132:135], v[52:55]
    v_exp_f32 v63, v63
    v_mfma_f32_16x16x32_bf16 v[52:55], v[144:147], a[128:131], v[52:55]
    ds_read_b32 v11, v9 offset:4608
    v_cvt_pk_bf16_f32 v87, v62, v63
    v_exp_f32 v48, v48
    ds_write_b128 v3, v[84:87] offset:5120
    v_exp_f32 v49, v49
    ds_read_b128 a[128:131], v7 offset:0
    ds_read_b128 a[132:135], v0 offset:0
    v_exp_f32 v50, v50
    ds_read_b128 a[136:139], v15 offset:0
    v_cvt_pk_bf16_f32 v88, v48, v49
    s_waitcnt lgkmcnt(4)
    v_cmp_gt_u32 vcc, 8, v11
    v_exp_f32 v51, v51
    s_nop 0
    v_cvt_pk_bf16_f32 v89, v50, v51
    v_mfma_f32_16x16x32_bf16 v[56:59], v[128:131], a[144:147], -4.0
    v_exp_f32 v52, v52
    v_mfma_f32_16x16x32_bf16 v[56:59], v[132:135], a[148:151], v[56:59]
    s_cbranch_vccnz L_wait0
L_go0:
    v_mfma_f32_16x16x32_bf16 v[56:59], v[136:139], a[152:155], v[56:59]
    v_exp_f32 v53, v53
    s_mov_b32 m0, s33
    s_nop 0
    buffer_load_dwordx4 v17, s[20:23], s36 offen offset:0 nt lds
    s_waitcnt vmcnt(8)
    v_lshlrev_b32 v12, 16, v160
    v_and_b32 v13, 0xffff0000, v160
    v_lshlrev_b32 v20, 16, v161
    v_and_b32 v21, 0xffff0000, v161
    v_lshlrev_b32 v22, 16, v162
    v_and_b32 v23, 0xffff0000, v162
    v_lshlrev_b32 v26, 16, v163
    v_and_b32 v27, 0xffff0000, v163
    v_pk_mul_f32 v[12:13], v[12:13], s[34:35]
    v_pk_mul_f32 v[20:21], v[20:21], s[34:35]
    v_pk_mul_f32 v[22:23], v[22:23], s[34:35]
    v_pk_mul_f32 v[26:27], v[26:27], s[34:35]
    v_cvt_pk_bf16_f32 v160, v12, v13
    v_cvt_pk_bf16_f32 v161, v20, v21
    v_cvt_pk_bf16_f32 v162, v22, v23
    v_cvt_pk_bf16_f32 v163, v26, v27
    v_mfma_f32_16x16x32_bf16 v[56:59], v[140:143], a[156:159], v[56:59]
    ds_read_b128 a[164:167], v4 offset:0
    v_cvt_pk_bf16_f32 v90, v52, v53
    v_mfma_f32_16x16x32_bf16 v[60:63], v[156:159], a[156:159], -4.0
    v_exp_f32 v54, v54
    v_mfma_f32_16x16x32_bf16 v[60:63], v[152:155], a[152:155], v[60:63]
    ds_read_b128 a[140:143], v25 offset:0
    ds_read_b128 a[168:171], v5 offset:0
    v_mfma_f32_16x16x32_bf16 v[60:63], v[148:151], a[148:151], v[60:63]
    v_exp_f32 v55, v55
    v_mfma_f32_16x16x32_bf16 v[60:63], v[144:147], a[144:147], v[60:63]
    ds_read_b128 a[172:175], v6 offset:0
    v_cvt_pk_bf16_f32 v91, v54, v55
    v_exp_f32 v56, v56
    s_mov_b32 m0, s33
    s_nop 0
    buffer_load_dwordx4 v17, s[20:23], s36 offen offset:1024 nt lds
    s_waitcnt vmcnt(8)
    v_lshlrev_b32 v12, 16, v164
    v_and_b32 v13, 0xffff0000, v164
    v_lshlrev_b32 v20, 16, v165
    v_and_b32 v21, 0xffff0000, v165
    v_lshlrev_b32 v22, 16, v166
    v_and_b32 v23, 0xffff0000, v166
    v_lshlrev_b32 v26, 16, v167
    v_and_b32 v27, 0xffff0000, v167
    v_pk_mul_f32 v[12:13], v[12:13], s[34:35]
    v_pk_mul_f32 v[20:21], v[20:21], s[34:35]
    v_pk_mul_f32 v[22:23], v[22:23], s[34:35]
    v_pk_mul_f32 v[26:27], v[26:27], s[34:35]
    v_cvt_pk_bf16_f32 v164, v12, v13
    v_cvt_pk_bf16_f32 v165, v20, v21
    v_cvt_pk_bf16_f32 v166, v22, v23
    v_cvt_pk_bf16_f32 v167, v26, v27
    ds_write_b128 v3, v[88:91] offset:6144
    v_exp_f32 v57, v57
    ds_read_b128 a[144:147], v7 offset:4096
    ds_read_b128 a[148:151], v0 offset:4096
    v_exp_f32 v58, v58
    ds_read_b128 a[152:155], v15 offset:4096
    v_cvt_pk_bf16_f32 v92, v56, v57
    v_exp_f32 v59, v59
    ds_read_b128 a[180:183], v4 offset:1024
    v_cvt_pk_bf16_f32 v93, v58, v59
    v_smfmac_f32_16x16x64_bf16 a[160:163], a[192:195], v[80:87], v24
    s_waitcnt lgkmcnt(9)
    ds_read_b128 a[184:187], v5 offset:1024
    v_mfma_f32_16x16x32_bf16 v[48:51], v[128:131], a[128:131], -4.0
    v_exp_f32 v60, v60
    v_mfma_f32_16x16x32_bf16 v[48:51], v[132:135], a[132:135], v[48:51]
    s_mov_b32 m0, s33
    s_nop 0
    buffer_load_dwordx4 v17, s[20:23], s36 offen offset:2048 nt lds
    s_waitcnt vmcnt(8)
    v_lshlrev_b32 v12, 16, v168
    v_and_b32 v13, 0xffff0000, v168
    v_lshlrev_b32 v20, 16, v169
    v_and_b32 v21, 0xffff0000, v169
    v_lshlrev_b32 v22, 16, v170
    v_and_b32 v23, 0xffff0000, v170
    v_lshlrev_b32 v26, 16, v171
    v_and_b32 v27, 0xffff0000, v171
    v_pk_mul_f32 v[12:13], v[12:13], s[34:35]
    v_pk_mul_f32 v[20:21], v[20:21], s[34:35]
    v_pk_mul_f32 v[22:23], v[22:23], s[34:35]
    v_pk_mul_f32 v[26:27], v[26:27], s[34:35]
    v_cvt_pk_bf16_f32 v168, v12, v13
    v_cvt_pk_bf16_f32 v169, v20, v21
    v_cvt_pk_bf16_f32 v170, v22, v23
    v_cvt_pk_bf16_f32 v171, v26, v27
    v_mfma_f32_16x16x32_bf16 v[48:51], v[136:139], a[136:139], v[48:51]
    s_waitcnt lgkmcnt(8)
    v_exp_f32 v61, v61
    v_mfma_f32_16x16x32_bf16 v[48:51], v[140:143], a[140:143], v[48:51]
    ds_read_b128 a[156:159], v25 offset:4096
    v_cvt_pk_bf16_f32 v94, v60, v61
    v_mfma_f32_16x16x32_bf16 v[52:55], v[156:159], a[140:143], -4.0
    v_exp_f32 v62, v62
    v_mfma_f32_16x16x32_bf16 v[52:55], v[152:155], a[136:139], v[52:55]
    s_mov_b32 m0, s33
    s_nop 0
    buffer_load_dwordx4 v17, s[20:23], s36 offen offset:3072 nt lds
    s_waitcnt vmcnt(8)
    v_lshlrev_b32 v12, 16, v172
    v_and_b32 v13, 0xffff0000, v172
    v_lshlrev_b32 v20, 16, v173
    v_and_b32 v21, 0xffff0000, v173
    v_lshlrev_b32 v22, 16, v174
    v_and_b32 v23, 0xffff0000, v174
    v_lshlrev_b32 v26, 16, v175
    v_and_b32 v27, 0xffff0000, v175
    v_pk_mul_f32 v[12:13], v[12:13], s[34:35]
    v_pk_mul_f32 v[20:21], v[20:21], s[34:35]
    v_pk_mul_f32 v[22:23], v[22:23], s[34:35]
    v_pk_mul_f32 v[26:27], v[26:27], s[34:35]
    v_cvt_pk_bf16_f32 v172, v12, v13
    v_cvt_pk_bf16_f32 v173, v20, v21
    v_cvt_pk_bf16_f32 v174, v22, v23
    v_cvt_pk_bf16_f32 v175, v26, v27
    v_mfma_f32_16x16x32_bf16 v[52:55], v[148:151], a[132:135], v[52:55]
    v_exp_f32 v63, v63
    v_mfma_f32_16x16x32_bf16 v[52:55], v[144:147], a[128:131], v[52:55]
    s_waitcnt lgkmcnt(1)
    ds_read_b128 a[188:191], v6 offset:1024
    v_cvt_pk_bf16_f32 v95, v62, v63
    v_mfma_f32_16x16x32_bf16 v[112:115], a[48:51], a[172:175], 0
    v_exp_f32 v48, v48
    v_mfma_f32_16x16x32_bf16 v[112:115], a[32:35], a[168:171], v[112:115]
    ds_write_b128 v3, v[92:95] offset:7168
    v_mfma_f32_16x16x32_bf16 v[112:115], a[16:19], a[164:167], v[112:115]
    v_exp_f32 v49, v49
    v_mfma_f32_16x16x32_bf16 v[112:115], a[0:3], v[64:67], v[112:115]
    ds_read_b128 a[128:131], v7 offset:32768
    ds_read_b128 a[132:135], v0 offset:32768
    s_add_u32 m0, s33, 4096
    s_nop 0
    buffer_load_dwordx4 v17, s[20:23], s40 offen offset:0 nt lds
    s_waitcnt vmcnt(8)
    v_lshlrev_b32 v12, 16, v176
    v_and_b32 v13, 0xffff0000, v176
    v_lshlrev_b32 v20, 16, v177
    v_and_b32 v21, 0xffff0000, v177
    v_lshlrev_b32 v22, 16, v178
    v_and_b32 v23, 0xffff0000, v178
    v_lshlrev_b32 v26, 16, v179
    v_and_b32 v27, 0xffff0000, v179
    v_pk_mul_f32 v[12:13], v[12:13], s[34:35]
    v_pk_mul_f32 v[20:21], v[20:21], s[34:35]
    v_pk_mul_f32 v[22:23], v[22:23], s[34:35]
    v_pk_mul_f32 v[26:27], v[26:27], s[34:35]
    v_cvt_pk_bf16_f32 v176, v12, v13
    v_cvt_pk_bf16_f32 v177, v20, v21
    v_cvt_pk_bf16_f32 v178, v22, v23
    v_cvt_pk_bf16_f32 v179, v26, v27
    v_mfma_f32_16x16x32_bf16 v[116:119], a[64:67], v[64:67], 0
    v_exp_f32 v50, v50
    v_mfma_f32_16x16x32_bf16 v[116:119], a[80:83], a[164:167], v[116:119]
    ds_read_b128 a[136:139], v15 offset:32768
    v_cvt_pk_bf16_f32 v64, v48, v49
    v_mfma_f32_16x16x32_bf16 v[116:119], a[96:99], a[168:171], v[116:119]
    v_exp_f32 v51, v51
    v_mfma_f32_16x16x32_bf16 v[116:119], a[112:115], a[172:175], v[116:119]
    v_cvt_pk_bf16_f32 v65, v50, v51
    v_mfma_f32_16x16x32_bf16 v[56:59], v[128:131], a[144:147], -4.0
    v_exp_f32 v52, v52
    v_mfma_f32_16x16x32_bf16 v[56:59], v[132:135], a[148:151], v[56:59]
    ds_inc_u32 v9, v24 offset:4612
    v_mfma_f32_16x16x32_bf16 v[56:59], v[136:139], a[152:155], v[56:59]
    s_waitcnt lgkmcnt(5)
    v_exp_f32 v53, v53
    s_add_u32 m0, s33, 4096
    s_nop 0
    buffer_load_dwordx4 v17, s[20:23], s40 offen offset:1024 nt lds
    s_waitcnt vmcnt(8)
    v_lshlrev_b32 v12, 16, v180
    v_and_b32 v13, 0xffff0000, v180
    v_lshlrev_b32 v20, 16, v181
    v_and_b32 v21, 0xffff0000, v181
    v_lshlrev_b32 v22, 16, v182
    v_and_b32 v23, 0xffff0000, v182
    v_lshlrev_b32 v26, 16, v183
    v_and_b32 v27, 0xffff0000, v183
    v_pk_mul_f32 v[12:13], v[12:13], s[34:35]
    v_pk_mul_f32 v[20:21], v[20:21], s[34:35]
    v_pk_mul_f32 v[22:23], v[22:23], s[34:35]
    v_pk_mul_f32 v[26:27], v[26:27], s[34:35]
    v_cvt_pk_bf16_f32 v180, v12, v13
    v_cvt_pk_bf16_f32 v181, v20, v21
    v_cvt_pk_bf16_f32 v182, v22, v23
    v_cvt_pk_bf16_f32 v183, v26, v27
    v_mfma_f32_16x16x32_bf16 v[56:59], v[140:143], a[156:159], v[56:59]
    ds_read_b128 a[164:167], v4 offset:2048
    v_cvt_pk_bf16_f32 v66, v52, v53
    v_mfma_f32_16x16x32_bf16 v[60:63], v[156:159], a[156:159], -4.0
    v_exp_f32 v54, v54
    v_mfma_f32_16x16x32_bf16 v[60:63], v[152:155], a[152:155], v[60:63]
    ds_read_b128 a[140:143], v25 offset:32768
    ds_read_b128 a[168:171], v5 offset:2048
    v_mfma_f32_16x16x32_bf16 v[60:63], v[148:151], a[148:151], v[60:63]
    v_exp_f32 v55, v55
    v_mfma_f32_16x16x32_bf16 v[60:63], v[144:147], a[144:147], v[60:63]
    ds_read_b128 a[172:175], v6 offset:2048
    v_cvt_pk_bf16_f32 v67, v54, v55
    v_mfma_f32_16x16x32_bf16 v[120:123], a[48:51], a[188:191], 0
    v_exp_f32 v56, v56
    v_mfma_f32_16x16x32_bf16 v[120:123], a[32:35], a[184:187], v[120:123]
    ds_write_b128 v3, v[64:67] offset:32768
    s_add_u32 m0, s33, 4096
    s_nop 0
    buffer_load_dwordx4 v17, s[20:23], s40 offen offset:2048 nt lds
    s_waitcnt vmcnt(8)
    v_lshlrev_b32 v12, 16, v184
    v_and_b32 v13, 0xffff0000, v184
    v_lshlrev_b32 v20, 16, v185
    v_and_b32 v21, 0xffff0000, v185
    v_lshlrev_b32 v22, 16, v186
    v_and_b32 v23, 0xffff0000, v186
    v_lshlrev_b32 v26, 16, v187
    v_and_b32 v27, 0xffff0000, v187
    v_pk_mul_f32 v[12:13], v[12:13], s[34:35]
    v_pk_mul_f32 v[20:21], v[20:21], s[34:35]
    v_pk_mul_f32 v[22:23], v[22:23], s[34:35]
    v_pk_mul_f32 v[26:27], v[26:27], s[34:35]
    v_cvt_pk_bf16_f32 v184, v12, v13
    v_cvt_pk_bf16_f32 v185, v20, v21
    v_cvt_pk_bf16_f32 v186, v22, v23
    v_cvt_pk_bf16_f32 v187, v26, v27
    v_mfma_f32_16x16x32_bf16 v[120:123], a[16:19], a[180:183], v[120:123]
    v_exp_f32 v57, v57
    v_mfma_f32_16x16x32_bf16 v[120:123], a[0:3], v[68:71], v[120:123]
    ds_read_b128 a[144:147], v7 offset:36864
    ds_read_b128 a[148:151], v0 offset:36864
    v_mfma_f32_16x16x32_bf16 v[124:127], a[64:67], v[68:71], 0
    v_exp_f32 v58, v58
    v_mfma_f32_16x16x32_bf16 v[124:127], a[80:83], a[180:183], v[124:127]
    ds_read_b128 a[152:155], v15 offset:36864
    v_cvt_pk_bf16_f32 v68, v56, v57
    v_mfma_f32_16x16x32_bf16 v[124:127], a[96:99], a[184:187], v[124:127]
    v_exp_f32 v59, v59
    v_mfma_f32_16x16x32_bf16 v[124:127], a[112:115], a[188:191], v[124:127]
    ds_read_b128 a[180:183], v4 offset:3072
    v_cvt_pk_bf16_f32 v69, v58, v59
    v_smfmac_f32_16x16x64_bf16 a[176:179], a[192:195], v[88:95], v24
    s_waitcnt lgkmcnt(5)
    ds_read_b128 a[184:187], v5 offset:3072
    s_add_u32 m0, s33, 4096
    s_nop 0
    buffer_load_dwordx4 v17, s[20:23], s40 offen offset:3072 nt lds
    s_waitcnt vmcnt(8)
    v_lshlrev_b32 v12, 16, v188
    v_and_b32 v13, 0xffff0000, v188
    v_lshlrev_b32 v20, 16, v189
    v_and_b32 v21, 0xffff0000, v189
    v_lshlrev_b32 v22, 16, v190
    v_and_b32 v23, 0xffff0000, v190
    v_lshlrev_b32 v26, 16, v191
    v_and_b32 v27, 0xffff0000, v191
    v_pk_mul_f32 v[12:13], v[12:13], s[34:35]
    v_pk_mul_f32 v[20:21], v[20:21], s[34:35]
    v_pk_mul_f32 v[22:23], v[22:23], s[34:35]
    v_pk_mul_f32 v[26:27], v[26:27], s[34:35]
    v_cvt_pk_bf16_f32 v188, v12, v13
    v_cvt_pk_bf16_f32 v189, v20, v21
    v_cvt_pk_bf16_f32 v190, v22, v23
    v_cvt_pk_bf16_f32 v191, v26, v27
    v_mfma_f32_16x16x32_bf16 v[48:51], v[160:163], a[128:131], -4.0
    v_exp_f32 v60, v60
    v_mfma_f32_16x16x32_bf16 v[48:51], v[164:167], a[132:135], v[48:51]
    buffer_load_dwordx4 v[192:195], v16, s[16:19], s37 offen offset:0 nt
    buffer_load_dwordx4 v[196:199], v16, s[16:19], s37 offen offset:64 nt
    v_mfma_f32_16x16x32_bf16 v[48:51], v[168:171], a[136:139], v[48:51]
    v_exp_f32 v61, v61
    v_mfma_f32_16x16x32_bf16 v[48:51], v[172:175], a[140:143], v[48:51]
    ds_read_b128 a[156:159], v25 offset:36864
    v_cvt_pk_bf16_f32 v70, v60, v61
    v_mfma_f32_16x16x32_bf16 v[52:55], v[188:191], a[140:143], -4.0
    v_exp_f32 v62, v62
    v_mfma_f32_16x16x32_bf16 v[52:55], v[184:187], a[136:139], v[52:55]
    v_mfma_f32_16x16x32_bf16 v[52:55], v[180:183], a[132:135], v[52:55]
    ds_read_b32 v11, v9 offset:4612
    v_exp_f32 v63, v63
    v_mfma_f32_16x16x32_bf16 v[52:55], v[176:179], a[128:131], v[52:55]
    ds_read_b128 a[188:191], v6 offset:3072
    v_cvt_pk_bf16_f32 v71, v62, v63
    v_mfma_f32_16x16x32_bf16 v[96:99], a[48:51], a[172:175], 0
    v_exp_f32 v48, v48
    v_mfma_f32_16x16x32_bf16 v[96:99], a[32:35], a[168:171], v[96:99]
    ds_write_b128 v3, v[68:71] offset:33792
    v_mfma_f32_16x16x32_bf16 v[96:99], a[16:19], a[164:167], v[96:99]
    v_exp_f32 v49, v49
    v_mfma_f32_16x16x32_bf16 v[96:99], a[0:3], v[72:75], v[96:99]
    ds_read_b128 a[128:131], v7 offset:40960
    ds_read_b128 a[132:135], v0 offset:40960
    v_mfma_f32_16x16x32_bf16 v[100:103], a[64:67], v[72:75], 0
    v_exp_f32 v50, v50
    v_mfma_f32_16x16x32_bf16 v[100:103], a[80:83], a[164:167], v[100:103]
    s_waitcnt lgkmcnt(4)
    ds_read_b128 a[136:139], v15 offset:40960
    v_cvt_pk_bf16_f32 v72, v48, v49
    v_cmp_gt_u32 vcc, 8, v11
    v_mfma_f32_16x16x32_bf16 v[100:103], a[96:99], a[168:171], v[100:103]
    v_exp_f32 v51, v51
    v_mfma_f32_16x16x32_bf16 v[100:103], a[112:115], a[172:175], v[100:103]
    v_cvt_pk_bf16_f32 v73, v50, v51
    v_mfma_f32_16x16x32_bf16 v[56:59], v[160:163], a[144:147], -4.0
    v_exp_f32 v52, v52
    v_mfma_f32_16x16x32_bf16 v[56:59], v[164:167], a[148:151], v[56:59]
    s_cbranch_vccnz L_wait1
L_go1:
    v_mfma_f32_16x16x32_bf16 v[56:59], v[168:171], a[152:155], v[56:59]
    v_exp_f32 v53, v53
    v_mfma_f32_16x16x32_bf16 v[56:59], v[172:175], a[156:159], v[56:59]
    ds_read_b128 a[164:167], v4 offset:4096
    v_cvt_pk_bf16_f32 v74, v52, v53
    v_mfma_f32_16x16x32_bf16 v[60:63], v[188:191], a[156:159], -4.0
    v_exp_f32 v54, v54
    v_mfma_f32_16x16x32_bf16 v[60:63], v[184:187], a[152:155], v[60:63]
    ds_read_b128 a[140:143], v25 offset:40960
    ds_read_b128 a[168:171], v5 offset:4096
    v_mfma_f32_16x16x32_bf16 v[60:63], v[180:183], a[148:151], v[60:63]
    v_exp_f32 v55, v55
    v_mfma_f32_16x16x32_bf16 v[60:63], v[176:179], a[144:147], v[60:63]
    s_waitcnt lgkmcnt(3)
    ds_read_b128 a[172:175], v6 offset:4096
    v_cvt_pk_bf16_f32 v75, v54, v55
    v_mfma_f32_16x16x32_bf16 v[104:107], a[48:51], a[188:191], 0
    v_exp_f32 v56, v56
    v_mfma_f32_16x16x32_bf16 v[104:107], a[32:35], a[184:187], v[104:107]
    ds_write_b128 v3, v[72:75] offset:34816
    v_mfma_f32_16x16x32_bf16 v[104:107], a[16:19], a[180:183], v[104:107]
    v_exp_f32 v57, v57
    v_mfma_f32_16x16x32_bf16 v[104:107], a[0:3], v[76:79], v[104:107]
    ds_read_b128 a[144:147], v7 offset:45056
    ds_read_b128 a[148:151], v0 offset:45056
    v_mfma_f32_16x16x32_bf16 v[108:111], a[64:67], v[76:79], 0
    v_exp_f32 v58, v58
    v_mfma_f32_16x16x32_bf16 v[108:111], a[80:83], a[180:183], v[108:111]
    ds_read_b128 a[152:155], v15 offset:45056
    v_cvt_pk_bf16_f32 v76, v56, v57
    v_mfma_f32_16x16x32_bf16 v[108:111], a[96:99], a[184:187], v[108:111]
    v_exp_f32 v59, v59
    v_mfma_f32_16x16x32_bf16 v[108:111], a[112:115], a[188:191], v[108:111]
    ds_read_b128 a[180:183], v4 offset:5120
    v_cvt_pk_bf16_f32 v77, v58, v59
    v_smfmac_f32_16x16x64_bf16 a[248:251], a[192:195], v[64:71], v24
    ds_read_b128 a[184:187], v5 offset:5120
    v_mfma_f32_16x16x32_bf16 v[48:51], v[160:163], a[128:131], -4.0
    v_exp_f32 v60, v60
    v_mfma_f32_16x16x32_bf16 v[48:51], v[164:167], a[132:135], v[48:51]
    buffer_load_dwordx4 v[200:203], v16, s[16:19], s37 offen offset:128 nt
    buffer_load_dwordx4 v[204:207], v16, s[16:19], s37 offen offset:192 nt
    v_mfma_f32_16x16x32_bf16 v[48:51], v[168:171], a[136:139], v[48:51]
    s_waitcnt lgkmcnt(3)
    v_exp_f32 v61, v61
    v_mfma_f32_16x16x32_bf16 v[48:51], v[172:175], a[140:143], v[48:51]
    ds_read_b128 a[156:159], v25 offset:45056
    v_cvt_pk_bf16_f32 v78, v60, v61
    v_mfma_f32_16x16x32_bf16 v[52:55], v[188:191], a[140:143], -4.0
    v_exp_f32 v62, v62
    v_mfma_f32_16x16x32_bf16 v[52:55], v[184:187], a[136:139], v[52:55]
    v_mfma_f32_16x16x32_bf16 v[52:55], v[180:183], a[132:135], v[52:55]
    v_exp_f32 v63, v63
    v_mfma_f32_16x16x32_bf16 v[52:55], v[176:179], a[128:131], v[52:55]
    ds_read_b128 a[188:191], v6 offset:5120
    v_cvt_pk_bf16_f32 v79, v62, v63
    v_mfma_f32_16x16x32_bf16 v[32:35], a[48:51], a[172:175], 0
    v_exp_f32 v48, v48
    v_mfma_f32_16x16x32_bf16 v[32:35], a[32:35], a[168:171], v[32:35]
    ds_write_b128 v3, v[76:79] offset:35840
    v_mfma_f32_16x16x32_bf16 v[32:35], a[16:19], a[164:167], v[32:35]
    v_exp_f32 v49, v49
    v_mfma_f32_16x16x32_bf16 v[32:35], a[0:3], v[80:83], v[32:35]
    ds_read_b128 a[128:131], v7 offset:49152
    ds_read_b128 a[132:135], v0 offset:49152
    v_mfma_f32_16x16x32_bf16 v[36:39], a[64:67], v[80:83], 0
    v_exp_f32 v50, v50
    v_mfma_f32_16x16x32_bf16 v[36:39], a[80:83], a[164:167], v[36:39]
    ds_read_b128 a[136:139], v15 offset:49152
    v_cvt_pk_bf16_f32 v80, v48, v49
    v_mfma_f32_16x16x32_bf16 v[36:39], a[96:99], a[168:171], v[36:39]
    v_exp_f32 v51, v51
    v_mfma_f32_16x16x32_bf16 v[36:39], a[112:115], a[172:175], v[36:39]
    v_cvt_pk_bf16_f32 v81, v50, v51
    v_mfma_f32_16x16x32_bf16 v[56:59], v[160:163], a[144:147], -4.0
    v_exp_f32 v52, v52
    v_mfma_f32_16x16x32_bf16 v[56:59], v[164:167], a[148:151], v[56:59]
    s_waitcnt lgkmcnt(4)
    buffer_load_dwordx4 v[208:211], v16, s[16:19], s37 offen offset:1024 nt
    buffer_load_dwordx4 v[212:215], v16, s[16:19], s37 offen offset:1088 nt
    v_mfma_f32_16x16x32_bf16 v[56:59], v[168:171], a[152:155], v[56:59]
    v_exp_f32 v53, v53
    v_mfma_f32_16x16x32_bf16 v[56:59], v[172:175], a[156:159], v[56:59]
    ds_read_b128 a[164:167], v4 offset:6144
    v_cvt_pk_bf16_f32 v82, v52, v53
    v_mfma_f32_16x16x32_bf16 v[60:63], v[188:191], a[156:159], -4.0
    v_exp_f32 v54, v54
    v_mfma_f32_16x16x32_bf16 v[60:63], v[184:187], a[152:155], v[60:63]
    ds_read_b128 a[140:143], v25 offset:49152
    ds_read_b128 a[168:171], v5 offset:6144
    v_mfma_f32_16x16x32_bf16 v[60:63], v[180:183], a[148:151], v[60:63]
    v_exp_f32 v55, v55
    v_mfma_f32_16x16x32_bf16 v[60:63], v[176:179], a[144:147], v[60:63]
    ds_read_b128 a[172:175], v6 offset:6144
    v_cvt_pk_bf16_f32 v83, v54, v55
    v_mfma_f32_16x16x32_bf16 v[40:43], a[48:51], a[188:191], 0
    v_exp_f32 v56, v56
    v_mfma_f32_16x16x32_bf16 v[40:43], a[32:35], a[184:187], v[40:43]
    ds_write_b128 v3, v[80:83] offset:36864
    v_mfma_f32_16x16x32_bf16 v[40:43], a[16:19], a[180:183], v[40:43]
    v_exp_f32 v57, v57
    v_mfma_f32_16x16x32_bf16 v[40:43], a[0:3], v[84:87], v[40:43]
    ds_read_b128 a[144:147], v7 offset:53248
    ds_read_b128 a[148:151], v0 offset:53248
    v_mfma_f32_16x16x32_bf16 v[44:47], a[64:67], v[84:87], 0
    v_exp_f32 v58, v58
    v_mfma_f32_16x16x32_bf16 v[44:47], a[80:83], a[180:183], v[44:47]
    ds_read_b128 a[152:155], v15 offset:53248
    v_cvt_pk_bf16_f32 v84, v56, v57
    v_mfma_f32_16x16x32_bf16 v[44:47], a[96:99], a[184:187], v[44:47]
    v_exp_f32 v59, v59
    v_mfma_f32_16x16x32_bf16 v[44:47], a[112:115], a[188:191], v[44:47]
    ds_read_b128 a[180:183], v4 offset:7168
    v_cvt_pk_bf16_f32 v85, v58, v59
    v_smfmac_f32_16x16x64_bf16 v[28:31], a[192:195], v[72:79], v24
    s_waitcnt lgkmcnt(5)
    ds_read_b128 a[184:187], v5 offset:7168
    v_mfma_f32_16x16x32_bf16 v[48:51], v[160:163], a[128:131], -4.0
    v_exp_f32 v60, v60
    v_mfma_f32_16x16x32_bf16 v[48:51], v[164:167], a[132:135], v[48:51]
    s_waitcnt vmcnt(6)
    ds_inc_u32 v9, v24 offset:4616
    v_mfma_f32_16x16x32_bf16 v[48:51], v[168:171], a[136:139], v[48:51]
    v_exp_f32 v61, v61
    v_mfma_f32_16x16x32_bf16 v[48:51], v[172:175], a[140:143], v[48:51]
    ds_read_b128 a[156:159], v25 offset:53248
    v_cvt_pk_bf16_f32 v86, v60, v61
    v_mfma_f32_16x16x32_bf16 v[52:55], v[188:191], a[140:143], -4.0
    v_exp_f32 v62, v62
    buffer_load_dwordx4 v[216:219], v16, s[16:19], s37 offen offset:1152 nt
    buffer_load_dwordx4 v[220:223], v16, s[16:19], s37 offen offset:1216 nt
    v_mfma_f32_16x16x32_bf16 v[52:55], v[184:187], a[136:139], v[52:55]
    v_mfma_f32_16x16x32_bf16 v[52:55], v[180:183], a[132:135], v[52:55]
    v_exp_f32 v63, v63
    v_mfma_f32_16x16x32_bf16 v[52:55], v[176:179], a[128:131], v[52:55]
    ds_read_b128 a[188:191], v6 offset:7168
    ds_read_b32 v11, v9 offset:4616
    v_cvt_pk_bf16_f32 v87, v62, v63
    v_mfma_f32_16x16x32_bf16 a[200:203], a[48:51], a[172:175], 0
    v_exp_f32 v48, v48
    v_mfma_f32_16x16x32_bf16 a[200:203], a[32:35], a[168:171], a[200:203]
    ds_write_b128 v3, v[84:87] offset:37888
    v_mfma_f32_16x16x32_bf16 a[200:203], a[16:19], a[164:167], a[200:203]
    v_exp_f32 v49, v49
    v_mfma_f32_16x16x32_bf16 a[200:203], a[0:3], v[88:91], a[200:203]
    ds_read_b128 a[128:131], v7 offset:24576
    ds_read_b128 a[132:135], v0 offset:24576
    v_mfma_f32_16x16x32_bf16 a[204:207], a[64:67], v[88:91], 0
    v_exp_f32 v50, v50
    v_mfma_f32_16x16x32_bf16 a[204:207], a[80:83], a[164:167], a[204:207]
    ds_read_b128 a[136:139], v15 offset:24576
    v_cvt_pk_bf16_f32 v88, v48, v49
    v_mfma_f32_16x16x32_bf16 a[204:207], a[96:99], a[168:171], a[204:207]
    v_exp_f32 v51, v51
    v_mfma_f32_16x16x32_bf16 a[204:207], a[112:115], a[172:175], a[204:207]
    s_waitcnt lgkmcnt(4)
    v_cvt_pk_bf16_f32 v89, v50, v51
    v_cmp_gt_u32 vcc, 8, v11
    v_mfma_f32_16x16x32_bf16 v[56:59], v[160:163], a[144:147], -4.0
    v_exp_f32 v52, v52
    v_mfma_f32_16x16x32_bf16 v[56:59], v[164:167], a[148:151], v[56:59]
    v_mfma_f32_16x16x32_bf16 v[56:59], v[168:171], a[152:155], v[56:59]
    s_cbranch_vccnz L_wait2
L_go2:
    v_exp_f32 v53, v53
    v_add_u32 v19, v18, v3
    v_add_u32 v14, v18, v4
    ds_read_b64_tr_b16 a[4:5], v19 offset:0
    ds_read_b64_tr_b16 a[6:7], v19 offset:1024
    ds_read_b64_tr_b16 a[68:69], v19 offset:8
    ds_read_b64_tr_b16 a[70:71], v19 offset:1032
    ds_read_b64_tr_b16 a[20:21], v14 offset:0
    ds_read_b64_tr_b16 a[22:23], v14 offset:1024
    ds_read_b64_tr_b16 a[84:85], v14 offset:8
    ds_read_b64_tr_b16 a[86:87], v14 offset:1032
    v_add_u32 v19, v18, v5
    v_add_u32 v14, v18, v6
    ds_read_b64_tr_b16 a[36:37], v19 offset:0
    ds_read_b64_tr_b16 a[38:39], v19 offset:1024
    ds_read_b64_tr_b16 a[100:101], v19 offset:8
    ds_read_b64_tr_b16 a[102:103], v19 offset:1032
    ds_read_b64_tr_b16 a[52:53], v14 offset:0
    ds_read_b64_tr_b16 a[54:55], v14 offset:1024
    ds_read_b64_tr_b16 a[116:117], v14 offset:8
    ds_read_b64_tr_b16 a[118:119], v14 offset:1032
    v_mfma_f32_16x16x32_bf16 v[56:59], v[172:175], a[156:159], v[56:59]
    ds_read_b128 a[164:167], v4 offset:32768
    v_cvt_pk_bf16_f32 v90, v52, v53
    v_mfma_f32_16x16x32_bf16 v[60:63], v[188:191], a[156:159], -4.0
    v_exp_f32 v54, v54
    v_mfma_f32_16x16x32_bf16 v[60:63], v[184:187], a[152:155], v[60:63]
    ds_read_b128 a[140:143], v25 offset:24576
    ds_read_b128 a[168:171], v5 offset:32768
    v_mfma_f32_16x16x32_bf16 v[60:63], v[180:183], a[148:151], v[60:63]
    v_exp_f32 v55, v55
    v_mfma_f32_16x16x32_bf16 v[60:63], v[176:179], a[144:147], v[60:63]
    ds_read_b128 a[172:175], v6 offset:32768
    v_cvt_pk_bf16_f32 v91, v54, v55
    v_mfma_f32_16x16x32_bf16 a[208:211], a[48:51], a[188:191], 0
    v_exp_f32 v56, v56
    v_mfma_f32_16x16x32_bf16 a[208:211], a[32:35], a[184:187], a[208:211]
    ds_write_b128 v3, v[88:91] offset:38912
    v_mfma_f32_16x16x32_bf16 a[208:211], a[16:19], a[180:183], a[208:211]
    v_exp_f32 v57, v57
    v_mfma_f32_16x16x32_bf16 a[208:211], a[0:3], v[92:95], a[208:211]
    ds_read_b128 a[144:147], v7 offset:28672
    ds_read_b128 a[148:151], v0 offset:28672
    v_mfma_f32_16x16x32_bf16 a[212:215], a[64:67], v[92:95], 0
    v_exp_f32 v58, v58
    v_mfma_f32_16x16x32_bf16 a[212:215], a[80:83], a[180:183], a[212:215]
    ds_read_b128 a[152:155], v15 offset:28672
    v_cvt_pk_bf16_f32 v92, v56, v57
    v_mfma_f32_16x16x32_bf16 a[212:215], a[96:99], a[184:187], a[212:215]
    v_exp_f32 v59, v59
    v_mfma_f32_16x16x32_bf16 a[212:215], a[112:115], a[188:191], a[212:215]
    ds_read_b128 a[180:183], v4 offset:33792
    v_cvt_pk_bf16_f32 v93, v58, v59
    v_smfmac_f32_16x16x64_bf16 a[196:199], a[192:195], v[80:87], v24
    s_waitcnt lgkmcnt(5)
    ds_read_b128 a[184:187], v5 offset:33792
    v_mfma_f32_16x16x32_bf16 v[48:51], v[160:163], a[128:131], -4.0
    v_exp_f32 v60, v60
    v_mfma_f32_16x16x32_bf16 v[48:51], v[164:167], a[132:135], v[48:51]
    v_mfma_f32_16x16x32_bf16 v[48:51], v[168:171], a[136:139], v[48:51]
    v_exp_f32 v61, v61
    v_mfma_f32_16x16x32_bf16 v[48:51], v[172:175], a[140:143], v[48:51]
    ds_read_b128 a[156:159], v25 offset:28672
    v_cvt_pk_bf16_f32 v94, v60, v61
    v_mfma_f32_16x16x32_bf16 v[52:55], v[188:191], a[140:143], -4.0
    v_exp_f32 v62, v62
    v_mfma_f32_16x16x32_bf16 v[52:55], v[184:187], a[136:139], v[52:55]
    v_mfma_f32_16x16x32_bf16 v[52:55], v[180:183], a[132:135], v[52:55]
    v_exp_f32 v63, v63
    v_mfma_f32_16x16x32_bf16 v[52:55], v[176:179], a[128:131], v[52:55]
    ds_read_b128 a[188:191], v6 offset:33792
    v_cvt_pk_bf16_f32 v95, v62, v63
    v_mfma_f32_16x16x32_bf16 a[216:219], a[48:51], a[172:175], 0
    v_exp_f32 v48, v48
    v_mfma_f32_16x16x32_bf16 a[216:219], a[32:35], a[168:171], a[216:219]
    ds_write_b128 v3, v[92:95] offset:39936
    v_mfma_f32_16x16x32_bf16 a[216:219], a[16:19], a[164:167], a[216:219]
    v_exp_f32 v49, v49
    v_mfma_f32_16x16x32_bf16 a[216:219], a[0:3], v[64:67], a[216:219]
    ds_read_b128 a[128:131], v7 offset:0
    ds_read_b128 a[132:135], v0 offset:0
    v_mfma_f32_16x16x32_bf16 a[220:223], a[64:67], v[64:67], 0
    v_exp_f32 v50, v50
    v_mfma_f32_16x16x32_bf16 a[220:223], a[80:83], a[164:167], a[220:223]
    ds_read_b128 a[136:139], v15 offset:0
    v_cvt_pk_bf16_f32 v64, v48, v49
    v_mfma_f32_16x16x32_bf16 a[220:223], a[96:99], a[168:171], a[220:223]
    v_exp_f32 v51, v51
    v_mfma_f32_16x16x32_bf16 a[220:223], a[112:115], a[172:175], a[220:223]
    s_waitcnt lgkmcnt(4)
    v_cvt_pk_bf16_f32 v65, v50, v51
    v_mfma_f32_16x16x32_bf16 v[56:59], v[160:163], a[144:147], -4.0
    v_exp_f32 v52, v52
    v_mfma_f32_16x16x32_bf16 v[56:59], v[164:167], a[148:151], v[56:59]
    ds_inc_u32 v9, v24 offset:4620
    v_mfma_f32_16x16x32_bf16 v[56:59], v[168:171], a[152:155], v[56:59]
    v_exp_f32 v53, v53
    v_mfma_f32_16x16x32_bf16 v[56:59], v[172:175], a[156:159], v[56:59]
    ds_read_b128 a[164:167], v4 offset:34816
    v_cvt_pk_bf16_f32 v66, v52, v53
    v_mfma_f32_16x16x32_bf16 v[60:63], v[188:191], a[156:159], -4.0
    v_exp_f32 v54, v54
    v_mfma_f32_16x16x32_bf16 v[60:63], v[184:187], a[152:155], v[60:63]
    ds_read_b128 a[140:143], v25 offset:0
    ds_read_b128 a[168:171], v5 offset:34816
    v_mfma_f32_16x16x32_bf16 v[60:63], v[180:183], a[148:151], v[60:63]
    v_exp_f32 v55, v55
    v_mfma_f32_16x16x32_bf16 v[60:63], v[176:179], a[144:147], v[60:63]
    ds_read_b128 a[172:175], v6 offset:34816
    ds_read_b32 v11, v9 offset:4620
    v_cvt_pk_bf16_f32 v67, v54, v55
    v_mfma_f32_16x16x32_bf16 a[224:227], a[48:51], a[188:191], 0
    v_exp_f32 v56, v56
    v_mfma_f32_16x16x32_bf16 a[224:227], a[32:35], a[184:187], a[224:227]
    ds_write_b128 v3, v[64:67] offset:0
    v_mfma_f32_16x16x32_bf16 a[224:227], a[16:19], a[180:183], a[224:227]
    v_exp_f32 v57, v57
    v_mfma_f32_16x16x32_bf16 a[224:227], a[0:3], v[68:71], a[224:227]
    ds_read_b128 a[144:147], v7 offset:4096
    ds_read_b128 a[148:151], v0 offset:4096
    v_mfma_f32_16x16x32_bf16 a[228:231], a[64:67], v[68:71], 0
    v_exp_f32 v58, v58
    v_mfma_f32_16x16x32_bf16 a[228:231], a[80:83], a[180:183], a[228:231]
    ds_read_b128 a[152:155], v15 offset:4096
    v_cvt_pk_bf16_f32 v68, v56, v57
    v_mfma_f32_16x16x32_bf16 a[228:231], a[96:99], a[184:187], a[228:231]
    s_waitcnt lgkmcnt(4)
    v_exp_f32 v59, v59
    v_cmp_gt_u32 vcc, 8, v11
    v_mfma_f32_16x16x32_bf16 a[228:231], a[112:115], a[188:191], a[228:231]
    ds_read_b128 a[180:183], v4 offset:35840
    v_cvt_pk_bf16_f32 v69, v58, v59
    v_smfmac_f32_16x16x64_bf16 a[160:163], a[192:195], v[88:95], v24
    ds_read_b128 a[184:187], v5 offset:35840
    v_mfma_f32_16x16x32_bf16 v[48:51], v[160:163], a[128:131], -4.0
    v_exp_f32 v60, v60
    v_mfma_f32_16x16x32_bf16 v[48:51], v[164:167], a[132:135], v[48:51]
    s_cbranch_vccnz L_wait3
L_go3:
    v_mfma_f32_16x16x32_bf16 v[48:51], v[168:171], a[136:139], v[48:51]
    v_exp_f32 v61, v61
    v_mfma_f32_16x16x32_bf16 v[48:51], v[172:175], a[140:143], v[48:51]
    ds_read_b128 a[156:159], v25 offset:4096
    v_cvt_pk_bf16_f32 v70, v60, v61
    v_mfma_f32_16x16x32_bf16 v[52:55], v[188:191], a[140:143], -4.0
    v_exp_f32 v62, v62
    v_mfma_f32_16x16x32_bf16 v[52:55], v[184:187], a[136:139], v[52:55]
    s_mov_b32 m0, s33
    s_nop 0
    buffer_load_dwordx4 v17, s[20:23], s37 offen offset:0 nt lds
    s_waitcnt vmcnt(8)
    v_lshlrev_b32 v12, 16, v192
    v_and_b32 v13, 0xffff0000, v192
    v_lshlrev_b32 v20, 16, v193
    v_and_b32 v21, 0xffff0000, v193
    v_lshlrev_b32 v22, 16, v194
    v_and_b32 v23, 0xffff0000, v194
    v_lshlrev_b32 v26, 16, v195
    v_and_b32 v27, 0xffff0000, v195
    v_pk_mul_f32 v[12:13], v[12:13], s[34:35]
    v_pk_mul_f32 v[20:21], v[20:21], s[34:35]
    v_pk_mul_f32 v[22:23], v[22:23], s[34:35]
    v_pk_mul_f32 v[26:27], v[26:27], s[34:35]
    v_cvt_pk_bf16_f32 v192, v12, v13
    v_cvt_pk_bf16_f32 v193, v20, v21
    v_cvt_pk_bf16_f32 v194, v22, v23
    v_cvt_pk_bf16_f32 v195, v26, v27
    v_mfma_f32_16x16x32_bf16 v[52:55], v[180:183], a[132:135], v[52:55]
    v_exp_f32 v63, v63
    s_mov_b32 m0, s33
    s_nop 0
    buffer_load_dwordx4 v17, s[20:23], s37 offen offset:1024 nt lds
    s_waitcnt vmcnt(8)
    v_lshlrev_b32 v12, 16, v196
    v_and_b32 v13, 0xffff0000, v196
    v_lshlrev_b32 v20, 16, v197
    v_and_b32 v21, 0xffff0000, v197
    v_lshlrev_b32 v22, 16, v198
    v_and_b32 v23, 0xffff0000, v198
    v_lshlrev_b32 v26, 16, v199
    v_and_b32 v27, 0xffff0000, v199
    v_pk_mul_f32 v[12:13], v[12:13], s[34:35]
    v_pk_mul_f32 v[20:21], v[20:21], s[34:35]
    v_pk_mul_f32 v[22:23], v[22:23], s[34:35]
    v_pk_mul_f32 v[26:27], v[26:27], s[34:35]
    v_cvt_pk_bf16_f32 v196, v12, v13
    v_cvt_pk_bf16_f32 v197, v20, v21
    v_cvt_pk_bf16_f32 v198, v22, v23
    v_cvt_pk_bf16_f32 v199, v26, v27
    v_mfma_f32_16x16x32_bf16 v[52:55], v[176:179], a[128:131], v[52:55]
    ds_read_b128 a[188:191], v6 offset:35840
    v_cvt_pk_bf16_f32 v71, v62, v63
    v_mfma_f32_16x16x32_bf16 v[112:115], a[52:55], a[172:175], v[112:115]
    v_exp_f32 v48, v48
    v_mfma_f32_16x16x32_bf16 v[112:115], a[36:39], a[168:171], v[112:115]
    ds_write_b128 v3, v[68:71] offset:1024
    v_mfma_f32_16x16x32_bf16 v[112:115], a[20:23], a[164:167], v[112:115]
    v_exp_f32 v49, v49
    s_mov_b32 m0, s33
    s_nop 0
    buffer_load_dwordx4 v17, s[20:23], s37 offen offset:2048 nt lds
    s_waitcnt vmcnt(8)
    v_lshlrev_b32 v12, 16, v200
    v_and_b32 v13, 0xffff0000, v200
    v_lshlrev_b32 v20, 16, v201
    v_and_b32 v21, 0xffff0000, v201
    v_lshlrev_b32 v22, 16, v202
    v_and_b32 v23, 0xffff0000, v202
    v_lshlrev_b32 v26, 16, v203
    v_and_b32 v27, 0xffff0000, v203
    v_pk_mul_f32 v[12:13], v[12:13], s[34:35]
    v_pk_mul_f32 v[20:21], v[20:21], s[34:35]
    v_pk_mul_f32 v[22:23], v[22:23], s[34:35]
    v_pk_mul_f32 v[26:27], v[26:27], s[34:35]
    v_cvt_pk_bf16_f32 v200, v12, v13
    v_cvt_pk_bf16_f32 v201, v20, v21
    v_cvt_pk_bf16_f32 v202, v22, v23
    v_cvt_pk_bf16_f32 v203, v26, v27
    v_mfma_f32_16x16x32_bf16 v[112:115], a[4:7], v[72:75], v[112:115]
    ds_read_b128 a[128:131], v7 offset:32768
    ds_read_b128 a[132:135], v0 offset:32768
    v_mfma_f32_16x16x32_bf16 v[116:119], a[68:71], v[72:75], v[116:119]
    v_exp_f32 v50, v50
    v_mfma_f32_16x16x32_bf16 v[116:119], a[84:87], a[164:167], v[116:119]
    ds_read_b128 a[136:139], v15 offset:32768
    v_cvt_pk_bf16_f32 v72, v48, v49
    v_mfma_f32_16x16x32_bf16 v[116:119], a[100:103], a[168:171], v[116:119]
    v_exp_f32 v51, v51
    v_mfma_f32_16x16x32_bf16 v[116:119], a[116:119], a[172:175], v[116:119]
    s_waitcnt lgkmcnt(4)
    v_cvt_pk_bf16_f32 v73, v50, v51
    v_mfma_f32_16x16x32_bf16 v[56:59], v[160:163], a[144:147], -4.0
    v_exp_f32 v52, v52
    v_mfma_f32_16x16x32_bf16 v[56:59], v[164:167], a[148:151], v[56:59]
    s_mov_b32 m0, s33
    s_nop 0
    buffer_load_dwordx4 v17, s[20:23], s37 offen offset:3072 nt lds
    s_waitcnt vmcnt(8)
    v_lshlrev_b32 v12, 16, v204
    v_and_b32 v13, 0xffff0000, v204
    v_lshlrev_b32 v20, 16, v205
    v_and_b32 v21, 0xffff0000, v205
    v_lshlrev_b32 v22, 16, v206
    v_and_b32 v23, 0xffff0000, v206
    v_lshlrev_b32 v26, 16, v207
    v_and_b32 v27, 0xffff0000, v207
    v_pk_mul_f32 v[12:13], v[12:13], s[34:35]
    v_pk_mul_f32 v[20:21], v[20:21], s[34:35]
    v_pk_mul_f32 v[22:23], v[22:23], s[34:35]
    v_pk_mul_f32 v[26:27], v[26:27], s[34:35]
    v_cvt_pk_bf16_f32 v204, v12, v13
    v_cvt_pk_bf16_f32 v205, v20, v21
    v_cvt_pk_bf16_f32 v206, v22, v23
    v_cvt_pk_bf16_f32 v207, v26, v27
    v_mfma_f32_16x16x32_bf16 v[56:59], v[168:171], a[152:155], v[56:59]
    v_exp_f32 v53, v53
    v_mfma_f32_16x16x32_bf16 v[56:59], v[172:175], a[156:159], v[56:59]
    ds_read_b128 a[164:167], v4 offset:36864
    v_cvt_pk_bf16_f32 v74, v52, v53
    s_add_u32 m0, s33, 4096
    s_nop 0
    buffer_load_dwordx4 v17, s[20:23], s41 offen offset:0 nt lds
    s_waitcnt vmcnt(8)
    v_lshlrev_b32 v12, 16, v208
    v_and_b32 v13, 0xffff0000, v208
    v_lshlrev_b32 v20, 16, v209
    v_and_b32 v21, 0xffff0000, v209
    v_lshlrev_b32 v22, 16, v210
    v_and_b32 v23, 0xffff0000, v210
    v_lshlrev_b32 v26, 16, v211
    v_and_b32 v27, 0xffff0000, v211
    v_pk_mul_f32 v[12:13], v[12:13], s[34:35]
    v_pk_mul_f32 v[20:21], v[20:21], s[34:35]
    v_pk_mul_f32 v[22:23], v[22:23], s[34:35]
    v_pk_mul_f32 v[26:27], v[26:27], s[34:35]
    v_cvt_pk_bf16_f32 v208, v12, v13
    v_cvt_pk_bf16_f32 v209, v20, v21
    v_cvt_pk_bf16_f32 v210, v22, v23
    v_cvt_pk_bf16_f32 v211, v26, v27
    v_mfma_f32_16x16x32_bf16 v[60:63], v[188:191], a[156:159], -4.0
    v_exp_f32 v54, v54
    v_mfma_f32_16x16x32_bf16 v[60:63], v[184:187], a[152:155], v[60:63]
    ds_read_b128 a[140:143], v25 offset:32768
    ds_read_b128 a[168:171], v5 offset:36864
    v_mfma_f32_16x16x32_bf16 v[60:63], v[180:183], a[148:151], v[60:63]
    v_exp_f32 v55, v55
    v_mfma_f32_16x16x32_bf16 v[60:63], v[176:179], a[144:147], v[60:63]
    ds_read_b128 a[172:175], v6 offset:36864
    v_cvt_pk_bf16_f32 v75, v54, v55
    s_add_u32 m0, s33, 4096
    s_nop 0
    buffer_load_dwordx4 v17, s[20:23], s41 offen offset:1024 nt lds
    s_waitcnt vmcnt(8)
    v_lshlrev_b32 v12, 16, v212
    v_and_b32 v13, 0xffff0000, v212
    v_lshlrev_b32 v20, 16, v213
    v_and_b32 v21, 0xffff0000, v213
    v_lshlrev_b32 v22, 16, v214
    v_and_b32 v23, 0xffff0000, v214
    v_lshlrev_b32 v26, 16, v215
    v_and_b32 v27, 0xffff0000, v215
    v_pk_mul_f32 v[12:13], v[12:13], s[34:35]
    v_pk_mul_f32 v[20:21], v[20:21], s[34:35]
    v_pk_mul_f32 v[22:23], v[22:23], s[34:35]
    v_pk_mul_f32 v[26:27], v[26:27], s[34:35]
    v_cvt_pk_bf16_f32 v212, v12, v13
    v_cvt_pk_bf16_f32 v213, v20, v21
    v_cvt_pk_bf16_f32 v214, v22, v23
    v_cvt_pk_bf16_f32 v215, v26, v27
    v_mfma_f32_16x16x32_bf16 v[120:123], a[52:55], a[188:191], v[120:123]
    v_exp_f32 v56, v56
    v_mfma_f32_16x16x32_bf16 v[120:123], a[36:39], a[184:187], v[120:123]
    ds_write_b128 v3, v[72:75] offset:2048
    v_mfma_f32_16x16x32_bf16 v[120:123], a[20:23], a[180:183], v[120:123]
    v_exp_f32 v57, v57
    v_mfma_f32_16x16x32_bf16 v[120:123], a[4:7], v[76:79], v[120:123]
    ds_read_b128 a[144:147], v7 offset:36864
    ds_read_b128 a[148:151], v0 offset:36864
    s_add_u32 m0, s33, 4096
    s_nop 0
    buffer_load_dwordx4 v17, s[20:23], s41 offen offset:2048 nt lds
    s_waitcnt vmcnt(8)
    v_lshlrev_b32 v12, 16, v216
    v_and_b32 v13, 0xffff0000, v216
    v_lshlrev_b32 v20, 16, v217
    v_and_b32 v21, 0xffff0000, v217
    v_lshlrev_b32 v22, 16, v218
    v_and_b32 v23, 0xffff0000, v218
    v_lshlrev_b32 v26, 16, v219
    v_and_b32 v27, 0xffff0000, v219
    v_pk_mul_f32 v[12:13], v[12:13], s[34:35]
    v_pk_mul_f32 v[20:21], v[20:21], s[34:35]
    v_pk_mul_f32 v[22:23], v[22:23], s[34:35]
    v_pk_mul_f32 v[26:27], v[26:27], s[34:35]
    v_cvt_pk_bf16_f32 v216, v12, v13
    v_cvt_pk_bf16_f32 v217, v20, v21
    v_cvt_pk_bf16_f32 v218, v22, v23
    v_cvt_pk_bf16_f32 v219, v26, v27
    v_mfma_f32_16x16x32_bf16 v[124:127], a[68:71], v[76:79], v[124:127]
    v_exp_f32 v58, v58
    v_mfma_f32_16x16x32_bf16 v[124:127], a[84:87], a[180:183], v[124:127]
    ds_read_b128 a[152:155], v15 offset:36864
    v_cvt_pk_bf16_f32 v76, v56, v57
    v_mfma_f32_16x16x32_bf16 v[124:127], a[100:103], a[184:187], v[124:127]
    v_exp_f32 v59, v59
    v_mfma_f32_16x16x32_bf16 v[124:127], a[116:119], a[188:191], v[124:127]
    ds_read_b128 a[180:183], v4 offset:37888
    v_cvt_pk_bf16_f32 v77, v58, v59
    v_smfmac_f32_16x16x64_bf16 a[176:179], a[192:195], v[64:71], v24
    s_waitcnt lgkmcnt(5)
    ds_read_b128 a[184:187], v5 offset:37888
    s_add_u32 m0, s33, 4096
    s_nop 0
    buffer_load_dwordx4 v17, s[20:23], s41 offen offset:3072 nt lds
    s_waitcnt vmcnt(8)
    v_lshlrev_b32 v12, 16, v220
    v_and_b32 v13, 0xffff0000, v220
    v_lshlrev_b32 v20, 16, v221
    v_and_b32 v21, 0xffff0000, v221
    v_lshlrev_b32 v22, 16, v222
    v_and_b32 v23, 0xffff0000, v222
    v_lshlrev_b32 v26, 16, v223
    v_and_b32 v27, 0xffff0000, v223
    v_pk_mul_f32 v[12:13], v[12:13], s[34:35]
    v_pk_mul_f32 v[20:21], v[20:21], s[34:35]
    v_pk_mul_f32 v[22:23], v[22:23], s[34:35]
    v_pk_mul_f32 v[26:27], v[26:27], s[34:35]
    v_cvt_pk_bf16_f32 v220, v12, v13
    v_cvt_pk_bf16_f32 v221, v20, v21
    v_cvt_pk_bf16_f32 v222, v22, v23
    v_cvt_pk_bf16_f32 v223, v26, v27
    v_mfma_f32_16x16x32_bf16 v[48:51], v[192:195], a[128:131], -4.0
    v_exp_f32 v60, v60
    v_mfma_f32_16x16x32_bf16 v[48:51], v[196:199], a[132:135], v[48:51]
    buffer_load_dwordx4 v[224:227], v16, s[16:19], s38 offen offset:0 nt
    buffer_load_dwordx4 v[228:231], v16, s[16:19], s38 offen offset:64 nt
    v_mfma_f32_16x16x32_bf16 v[48:51], v[200:203], a[136:139], v[48:51]
    v_exp_f32 v61, v61
    v_mfma_f32_16x16x32_bf16 v[48:51], v[204:207], a[140:143], v[48:51]
    ds_read_b128 a[156:159], v25 offset:36864
    v_cvt_pk_bf16_f32 v78, v60, v61
    v_mfma_f32_16x16x32_bf16 v[52:55], v[220:223], a[140:143], -4.0
    v_exp_f32 v62, v62
    v_mfma_f32_16x16x32_bf16 v[52:55], v[216:219], a[136:139], v[52:55]
    v_mfma_f32_16x16x32_bf16 v[52:55], v[212:215], a[132:135], v[52:55]
    v_exp_f32 v63, v63
    v_mfma_f32_16x16x32_bf16 v[52:55], v[208:211], a[128:131], v[52:55]
    ds_read_b128 a[188:191], v6 offset:37888
    v_cvt_pk_bf16_f32 v79, v62, v63
    v_mfma_f32_16x16x32_bf16 v[96:99], a[52:55], a[172:175], v[96:99]
    v_exp_f32 v48, v48
    v_mfma_f32_16x16x32_bf16 v[96:99], a[36:39], a[168:171], v[96:99]
    ds_write_b128 v3, v[76:79] offset:3072
    v_mfma_f32_16x16x32_bf16 v[96:99], a[20:23], a[164:167], v[96:99]
    v_exp_f32 v49, v49
    v_mfma_f32_16x16x32_bf16 v[96:99], a[4:7], v[80:83], v[96:99]
    ds_read_b128 a[128:131], v7 offset:40960
    ds_read_b128 a[132:135], v0 offset:40960
    v_mfma_f32_16x16x32_bf16 v[100:103], a[68:71], v[80:83], v[100:103]
    v_exp_f32 v50, v50
    v_mfma_f32_16x16x32_bf16 v[100:103], a[84:87], a[164:167], v[100:103]
    ds_read_b128 a[136:139], v15 offset:40960
    v_cvt_pk_bf16_f32 v80, v48, v49
    v_mfma_f32_16x16x32_bf16 v[100:103], a[100:103], a[168:171], v[100:103]
    v_exp_f32 v51, v51
    v_mfma_f32_16x16x32_bf16 v[100:103], a[116:119], a[172:175], v[100:103]
    s_waitcnt lgkmcnt(4)
    v_cvt_pk_bf16_f32 v81, v50, v51
    v_mfma_f32_16x16x32_bf16 v[56:59], v[192:195], a[144:147], -4.0
    v_exp_f32 v52, v52
    v_mfma_f32_16x16x32_bf16 v[56:59], v[196:199], a[148:151], v[56:59]
    ds_inc_u32 v9, v24 offset:5120
    v_mfma_f32_16x16x32_bf16 v[56:59], v[200:203], a[152:155], v[56:59]
    v_exp_f32 v53, v53
    v_mfma_f32_16x16x32_bf16 v[56:59], v[204:207], a[156:159], v[56:59]
    ds_read_b128 a[164:167], v4 offset:38912
    v_cvt_pk_bf16_f32 v82, v52, v53
    v_mfma_f32_16x16x32_bf16 v[60:63], v[220:223], a[156:159], -4.0
    v_exp_f32 v54, v54
    v_mfma_f32_16x16x32_bf16 v[60:63], v[216:219], a[152:155], v[60:63]
    ds_read_b128 a[140:143], v25 offset:40960
    ds_read_b128 a[168:171], v5 offset:38912
    v_mfma_f32_16x16x32_bf16 v[60:63], v[212:215], a[148:151], v[60:63]
    v_exp_f32 v55, v55
    v_mfma_f32_16x16x32_bf16 v[60:63], v[208:211], a[144:147], v[60:63]
    ds_read_b128 a[172:175], v6 offset:38912
    v_cvt_pk_bf16_f32 v83, v54, v55
    v_mfma_f32_16x16x32_bf16 v[104:107], a[52:55], a[188:191], v[104:107]
    v_exp_f32 v56, v56
    v_mfma_f32_16x16x32_bf16 v[104:107], a[36:39], a[184:187], v[104:107]
    ds_write_b128 v3, v[80:83] offset:4096
    v_mfma_f32_16x16x32_bf16 v[104:107], a[20:23], a[180:183], v[104:107]
    v_exp_f32 v57, v57
    v_mfma_f32_16x16x32_bf16 v[104:107], a[4:7], v[84:87], v[104:107]
    ds_read_b128 a[144:147], v7 offset:45056
    ds_read_b128 a[148:151], v0 offset:45056
    v_mfma_f32_16x16x32_bf16 v[108:111], a[68:71], v[84:87], v[108:111]
    v_exp_f32 v58, v58
    v_mfma_f32_16x16x32_bf16 v[108:111], a[84:87], a[180:183], v[108:111]
    ds_read_b128 a[152:155], v15 offset:45056
    v_cvt_pk_bf16_f32 v84, v56, v57
    v_mfma_f32_16x16x32_bf16 v[108:111], a[100:103], a[184:187], v[108:111]
    v_exp_f32 v59, v59
    v_mfma_f32_16x16x32_bf16 v[108:111], a[116:119], a[188:191], v[108:111]
    ds_read_b128 a[180:183], v4 offset:39936
    v_cvt_pk_bf16_f32 v85, v58, v59
    v_smfmac_f32_16x16x64_bf16 a[248:251], a[192:195], v[72:79], v24
    s_waitcnt lgkmcnt(5)
    ds_read_b128 a[184:187], v5 offset:39936
    v_mfma_f32_16x16x32_bf16 v[48:51], v[192:195], a[128:131], -4.0
    v_exp_f32 v60, v60
    v_mfma_f32_16x16x32_bf16 v[48:51], v[196:199], a[132:135], v[48:51]
    buffer_load_dwordx4 v[232:235], v16, s[16:19], s38 offen offset:128 nt
    buffer_load_dwordx4 v[236:239], v16, s[16:19], s38 offen offset:192 nt
    v_mfma_f32_16x16x32_bf16 v[48:51], v[200:203], a[136:139], v[48:51]
    v_exp_f32 v61, v61
    v_mfma_f32_16x16x32_bf16 v[48:51], v[204:207], a[140:143], v[48:51]
    ds_read_b128 a[156:159], v25 offset:45056
    v_cvt_pk_bf16_f32 v86, v60, v61
    v_mfma_f32_16x16x32_bf16 v[52:55], v[220:223], a[140:143], -4.0
    v_exp_f32 v62, v62
    v_mfma_f32_16x16x32_bf16 v[52:55], v[216:219], a[136:139], v[52:55]
    v_mfma_f32_16x16x32_bf16 v[52:55], v[212:215], a[132:135], v[52:55]
    ds_read_b32 v11, v9 offset:5120
    v_exp_f32 v63, v63
    v_mfma_f32_16x16x32_bf16 v[52:55], v[208:211], a[128:131], v[52:55]
    ds_read_b128 a[188:191], v6 offset:39936
    v_cvt_pk_bf16_f32 v87, v62, v63
    v_mfma_f32_16x16x32_bf16 v[32:35], a[52:55], a[172:175], v[32:35]
    v_exp_f32 v48, v48
    v_mfma_f32_16x16x32_bf16 v[32:35], a[36:39], a[168:171], v[32:35]
    ds_write_b128 v3, v[84:87] offset:5120
    v_mfma_f32_16x16x32_bf16 v[32:35], a[20:23], a[164:167], v[32:35]
    v_exp_f32 v49, v49
    v_mfma_f32_16x16x32_bf16 v[32:35], a[4:7], v[88:91], v[32:35]
    ds_read_b128 a[128:131], v7 offset:49152
    ds_read_b128 a[132:135], v0 offset:49152
    v_mfma_f32_16x16x32_bf16 v[36:39], a[68:71], v[88:91], v[36:39]
    v_exp_f32 v50, v50
    v_mfma_f32_16x16x32_bf16 v[36:39], a[84:87], a[164:167], v[36:39]
    s_waitcnt lgkmcnt(4)
    ds_read_b128 a[136:139], v15 offset:49152
    v_cvt_pk_bf16_f32 v88, v48, v49
    v_cmp_gt_u32 vcc, 8, v11
    v_mfma_f32_16x16x32_bf16 v[36:39], a[100:103], a[168:171], v[36:39]
    v_exp_f32 v51, v51
    v_mfma_f32_16x16x32_bf16 v[36:39], a[116:119], a[172:175], v[36:39]
    v_cvt_pk_bf16_f32 v89, v50, v51
    v_mfma_f32_16x16x32_bf16 v[56:59], v[192:195], a[144:147], -4.0
    v_exp_f32 v52, v52
    v_mfma_f32_16x16x32_bf16 v[56:59], v[196:199], a[148:151], v[56:59]
    s_cbranch_vccnz L_wait4
L_go4:
    v_mfma_f32_16x16x32_bf16 v[56:59], v[200:203], a[152:155], v[56:59]
    v_exp_f32 v53, v53
    v_mfma_f32_16x16x32_bf16 v[56:59], v[204:207], a[156:159], v[56:59]
    ds_read_b128 a[164:167], v4 offset:0
    v_cvt_pk_bf16_f32 v90, v52, v53
    v_mfma_f32_16x16x32_bf16 v[60:63], v[220:223], a[156:159], -4.0
    v_exp_f32 v54, v54
    v_mfma_f32_16x16x32_bf16 v[60:63], v[216:219], a[152:155], v[60:63]
    ds_read_b128 a[140:143], v25 offset:49152
    ds_read_b128 a[168:171], v5 offset:0
    v_mfma_f32_16x16x32_bf16 v[60:63], v[212:215], a[148:151], v[60:63]
    v_exp_f32 v55, v55
    v_mfma_f32_16x16x32_bf16 v[60:63], v[208:211], a[144:147], v[60:63]
    s_waitcnt lgkmcnt(3)
    ds_read_b128 a[172:175], v6 offset:0
    v_cvt_pk_bf16_f32 v91, v54, v55
    v_mfma_f32_16x16x32_bf16 v[40:43], a[52:55], a[188:191], v[40:43]
    v_exp_f32 v56, v56
    v_mfma_f32_16x16x32_bf16 v[40:43], a[36:39], a[184:187], v[40:43]
    ds_write_b128 v3, v[88:91] offset:6144
    v_mfma_f32_16x16x32_bf16 v[40:43], a[20:23], a[180:183], v[40:43]
    v_exp_f32 v57, v57
    v_mfma_f32_16x16x32_bf16 v[40:43], a[4:7], v[92:95], v[40:43]
    ds_read_b128 a[144:147], v7 offset:53248
    ds_read_b128 a[148:151], v0 offset:53248
    v_mfma_f32_16x16x32_bf16 v[44:47], a[68:71], v[92:95], v[44:47]
    v_exp_f32 v58, v58
    v_mfma_f32_16x16x32_bf16 v[44:47], a[84:87], a[180:183], v[44:47]
    ds_read_b128 a[152:155], v15 offset:53248
    v_cvt_pk_bf16_f32 v92, v56, v57
    v_mfma_f32_16x16x32_bf16 v[44:47], a[100:103], a[184:187], v[44:47]
    v_exp_f32 v59, v59
    v_mfma_f32_16x16x32_bf16 v[44:47], a[116:119], a[188:191], v[44:47]
    ds_read_b128 a[180:183], v4 offset:1024
    v_cvt_pk_bf16_f32 v93, v58, v59
    v_smfmac_f32_16x16x64_bf16 v[28:31], a[192:195], v[80:87], v24
    ds_read_b128 a[184:187], v5 offset:1024
    v_mfma_f32_16x16x32_bf16 v[48:51], v[192:195], a[128:131], -4.0
    v_exp_f32 v60, v60
    v_mfma_f32_16x16x32_bf16 v[48:51], v[196:199], a[132:135], v[48:51]
    buffer_load_dwordx4 v[240:243], v16, s[16:19], s38 offen offset:1024 nt
    buffer_load_dwordx4 v[244:247], v16, s[16:19], s38 offen offset:1088 nt
    v_mfma_f32_16x16x32_bf16 v[48:51], v[200:203], a[136:139], v[48:51]
    s_waitcnt lgkmcnt(3)
    v_exp_f32 v61, v61
    v_mfma_f32_16x16x32_bf16 v[48:51], v[204:207], a[140:143], v[48:51]
    ds_read_b128 a[156:159], v25 offset:53248
    v_cvt_pk_bf16_f32 v94, v60, v61
    v_mfma_f32_16x16x32_bf16 v[52:55], v[220:223], a[140:143], -4.0
    v_exp_f32 v62, v62
    buffer_load_dwordx4 v[248:251], v16, s[16:19], s38 offen offset:1152 nt
    buffer_load_dwordx4 v[252:255], v16, s[16:19], s38 offen offset:1216 nt
    v_mfma_f32_16x16x32_bf16 v[52:55], v[216:219], a[136:139], v[52:55]
    v_mfma_f32_16x16x32_bf16 v[52:55], v[212:215], a[132:135], v[52:55]
    v_exp_f32 v63, v63
    v_mfma_f32_16x16x32_bf16 v[52:55], v[208:211], a[128:131], v[52:55]
    ds_read_b128 a[188:191], v6 offset:1024
    v_cvt_pk_bf16_f32 v95, v62, v63
    v_mfma_f32_16x16x32_bf16 a[200:203], a[52:55], a[172:175], a[200:203]
    v_exp_f32 v48, v48
    v_mfma_f32_16x16x32_bf16 a[200:203], a[36:39], a[168:171], a[200:203]
    ds_write_b128 v3, v[92:95] offset:7168
    v_mfma_f32_16x16x32_bf16 a[200:203], a[20:23], a[164:167], a[200:203]
    v_exp_f32 v49, v49
    v_mfma_f32_16x16x32_bf16 a[200:203], a[4:7], v[64:67], a[200:203]
    ds_read_b128 a[128:131], v7 offset:24576
    ds_read_b128 a[132:135], v0 offset:24576
    v_mfma_f32_16x16x32_bf16 a[204:207], a[68:71], v[64:67], a[204:207]
    v_exp_f32 v50, v50
    v_mfma_f32_16x16x32_bf16 a[204:207], a[84:87], a[164:167], a[204:207]
    ds_read_b128 a[136:139], v15 offset:24576
    v_cvt_pk_bf16_f32 v64, v48, v49
    v_mfma_f32_16x16x32_bf16 a[204:207], a[100:103], a[168:171], a[204:207]
    v_exp_f32 v51, v51
    v_mfma_f32_16x16x32_bf16 a[204:207], a[116:119], a[172:175], a[204:207]
    v_cvt_pk_bf16_f32 v65, v50, v51
    v_mfma_f32_16x16x32_bf16 v[56:59], v[192:195], a[144:147], -4.0
    v_exp_f32 v52, v52
    v_mfma_f32_16x16x32_bf16 v[56:59], v[196:199], a[148:151], v[56:59]
    s_waitcnt lgkmcnt(4)
    v_mfma_f32_16x16x32_bf16 v[56:59], v[200:203], a[152:155], v[56:59]
    v_exp_f32 v53, v53
    v_mfma_f32_16x16x32_bf16 v[56:59], v[204:207], a[156:159], v[56:59]
    ds_read_b128 a[164:167], v4 offset:2048
    v_cvt_pk_bf16_f32 v66, v52, v53
    v_mfma_f32_16x16x32_bf16 v[60:63], v[220:223], a[156:159], -4.0
    v_exp_f32 v54, v54
    v_mfma_f32_16x16x32_bf16 v[60:63], v[216:219], a[152:155], v[60:63]
    ds_read_b128 a[140:143], v25 offset:24576
    ds_read_b128 a[168:171], v5 offset:2048
    v_mfma_f32_16x16x32_bf16 v[60:63], v[212:215], a[148:151], v[60:63]
    v_exp_f32 v55, v55
    v_mfma_f32_16x16x32_bf16 v[60:63], v[208:211], a[144:147], v[60:63]
    ds_read_b128 a[172:175], v6 offset:2048
    v_cvt_pk_bf16_f32 v67, v54, v55
    v_mfma_f32_16x16x32_bf16 a[208:211], a[52:55], a[188:191], a[208:211]
    v_exp_f32 v56, v56
    v_mfma_f32_16x16x32_bf16 a[208:211], a[36:39], a[184:187], a[208:211]
    ds_write_b128 v3, v[64:67] offset:32768
    v_mfma_f32_16x16x32_bf16 a[208:211], a[20:23], a[180:183], a[208:211]
    v_exp_f32 v57, v57
    v_mfma_f32_16x16x32_bf16 a[208:211], a[4:7], v[68:71], a[208:211]
    ds_read_b128 a[144:147], v7 offset:28672
    ds_read_b128 a[148:151], v0 offset:28672
    v_mfma_f32_16x16x32_bf16 a[212:215], a[68:71], v[68:71], a[212:215]
    v_exp_f32 v58, v58
    v_mfma_f32_16x16x32_bf16 a[212:215], a[84:87], a[180:183], a[212:215]
    ds_read_b128 a[152:155], v15 offset:28672
    v_cvt_pk_bf16_f32 v68, v56, v57
    v_mfma_f32_16x16x32_bf16 a[212:215], a[100:103], a[184:187], a[212:215]
    v_exp_f32 v59, v59
    v_mfma_f32_16x16x32_bf16 a[212:215], a[116:119], a[188:191], a[212:215]
    ds_read_b128 a[180:183], v4 offset:3072
    v_cvt_pk_bf16_f32 v69, v58, v59
    v_smfmac_f32_16x16x64_bf16 a[196:199], a[192:195], v[88:95], v24
    s_waitcnt lgkmcnt(5)
    ds_read_b128 a[184:187], v5 offset:3072
    v_mfma_f32_16x16x32_bf16 v[48:51], v[192:195], a[128:131], -4.0
    v_exp_f32 v60, v60
    v_mfma_f32_16x16x32_bf16 v[48:51], v[196:199], a[132:135], v[48:51]
    s_waitcnt vmcnt(8)
    ds_inc_u32 v9, v24 offset:5124
    v_mfma_f32_16x16x32_bf16 v[48:51], v[200:203], a[136:139], v[48:51]
    v_exp_f32 v61, v61
    v_mfma_f32_16x16x32_bf16 v[48:51], v[204:207], a[140:143], v[48:51]
    ds_read_b128 a[156:159], v25 offset:28672
    v_cvt_pk_bf16_f32 v70, v60, v61
    v_mfma_f32_16x16x32_bf16 v[52:55], v[220:223], a[140:143], -4.0
    v_exp_f32 v62, v62
    v_mfma_f32_16x16x32_bf16 v[52:55], v[216:219], a[136:139], v[52:55]
    v_mfma_f32_16x16x32_bf16 v[52:55], v[212:215], a[132:135], v[52:55]
    v_exp_f32 v63, v63
    v_mfma_f32_16x16x32_bf16 v[52:55], v[208:211], a[128:131], v[52:55]
    ds_read_b128 a[188:191], v6 offset:3072
    v_cvt_pk_bf16_f32 v71, v62, v63
    v_mfma_f32_16x16x32_bf16 a[216:219], a[52:55], a[172:175], a[216:219]
    ds_read_b32 v11, v9 offset:5124
    v_exp_f32 v48, v48
    v_mfma_f32_16x16x32_bf16 a[216:219], a[36:39], a[168:171], a[216:219]
    ds_write_b128 v3, v[68:71] offset:33792
    v_mfma_f32_16x16x32_bf16 a[216:219], a[20:23], a[164:167], a[216:219]
    v_exp_f32 v49, v49
    v_mfma_f32_16x16x32_bf16 a[216:219], a[4:7], v[72:75], a[216:219]
    ds_read_b128 a[128:131], v7 offset:0
    ds_read_b128 a[132:135], v0 offset:0
    v_mfma_f32_16x16x32_bf16 a[220:223], a[68:71], v[72:75], a[220:223]
    v_exp_f32 v50, v50
    v_mfma_f32_16x16x32_bf16 a[220:223], a[84:87], a[164:167], a[220:223]
    ds_read_b128 a[136:139], v15 offset:0
    v_cvt_pk_bf16_f32 v72, v48, v49
    v_mfma_f32_16x16x32_bf16 a[220:223], a[100:103], a[168:171], a[220:223]
    v_exp_f32 v51, v51
    v_mfma_f32_16x16x32_bf16 a[220:223], a[116:119], a[172:175], a[220:223]
    s_waitcnt lgkmcnt(4)
    v_cvt_pk_bf16_f32 v73, v50, v51
    v_cmp_gt_u32 vcc, 8, v11
    v_mfma_f32_16x16x32_bf16 v[56:59], v[192:195], a[144:147], -4.0
    v_exp_f32 v52, v52
    v_mfma_f32_16x16x32_bf16 v[56:59], v[196:199], a[148:151], v[56:59]
    v_mfma_f32_16x16x32_bf16 v[56:59], v[200:203], a[152:155], v[56:59]
    v_exp_f32 v53, v53
    v_mfma_f32_16x16x32_bf16 v[56:59], v[204:207], a[156:159], v[56:59]
    s_cbranch_vccnz L_wait5
L_go5:
    ds_read_b128 a[164:167], v4 offset:4096
    v_cvt_pk_bf16_f32 v74, v52, v53
    v_add_u32 v19, v18, v3
    v_add_u32 v14, v18, v4
    ds_read_b64_tr_b16 a[8:9], v19 offset:0
    ds_read_b64_tr_b16 a[10:11], v19 offset:1024
    ds_read_b64_tr_b16 a[72:73], v19 offset:8
    ds_read_b64_tr_b16 a[74:75], v19 offset:1032
    ds_read_b64_tr_b16 a[24:25], v14 offset:0
    ds_read_b64_tr_b16 a[26:27], v14 offset:1024
    ds_read_b64_tr_b16 a[88:89], v14 offset:8
    ds_read_b64_tr_b16 a[90:91], v14 offset:1032
    v_add_u32 v19, v18, v5
    v_add_u32 v14, v18, v6
    ds_read_b64_tr_b16 a[40:41], v19 offset:0
    ds_read_b64_tr_b16 a[42:43], v19 offset:1024
    ds_read_b64_tr_b16 a[104:105], v19 offset:8
    ds_read_b64_tr_b16 a[106:107], v19 offset:1032
    ds_read_b64_tr_b16 a[56:57], v14 offset:0
    ds_read_b64_tr_b16 a[58:59], v14 offset:1024
    ds_read_b64_tr_b16 a[120:121], v14 offset:8
    ds_read_b64_tr_b16 a[122:123], v14 offset:1032
    ds_inc_u32 v9, v24 offset:5128
    v_mfma_f32_16x16x32_bf16 v[60:63], v[220:223], a[156:159], -4.0
    v_exp_f32 v54, v54
    v_mfma_f32_16x16x32_bf16 v[60:63], v[216:219], a[152:155], v[60:63]
    ds_read_b128 a[140:143], v25 offset:0
    ds_read_b128 a[168:171], v5 offset:4096
    v_mfma_f32_16x16x32_bf16 v[60:63], v[212:215], a[148:151], v[60:63]
    v_exp_f32 v55, v55
    v_mfma_f32_16x16x32_bf16 v[60:63], v[208:211], a[144:147], v[60:63]
    ds_read_b128 a[172:175], v6 offset:4096
    v_cvt_pk_bf16_f32 v75, v54, v55
    v_mfma_f32_16x16x32_bf16 a[224:227], a[52:55], a[188:191], a[224:227]
    v_exp_f32 v56, v56
    v_mfma_f32_16x16x32_bf16 a[224:227], a[36:39], a[184:187], a[224:227]
    ds_write_b128 v3, v[72:75] offset:34816
    v_mfma_f32_16x16x32_bf16 a[224:227], a[20:23], a[180:183], a[224:227]
    v_exp_f32 v57, v57
    v_mfma_f32_16x16x32_bf16 a[224:227], a[4:7], v[76:79], a[224:227]
    ds_read_b128 a[144:147], v7 offset:4096
    ds_read_b128 a[148:151], v0 offset:4096
    v_mfma_f32_16x16x32_bf16 a[228:231], a[68:71], v[76:79], a[228:231]
    ds_read_b32 v11, v9 offset:5128
    v_exp_f32 v58, v58
    v_mfma_f32_16x16x32_bf16 a[228:231], a[84:87], a[180:183], a[228:231]
    ds_read_b128 a[152:155], v15 offset:4096
    v_cvt_pk_bf16_f32 v76, v56, v57
    v_mfma_f32_16x16x32_bf16 a[228:231], a[100:103], a[184:187], a[228:231]
    v_exp_f32 v59, v59
    v_mfma_f32_16x16x32_bf16 a[228:231], a[116:119], a[188:191], a[228:231]
    ds_read_b128 a[180:183], v4 offset:5120
    v_cvt_pk_bf16_f32 v77, v58, v59
    v_smfmac_f32_16x16x64_bf16 a[160:163], a[192:195], v[64:71], v24
    s_waitcnt lgkmcnt(6)
    ds_read_b128 a[184:187], v5 offset:5120
    v_mfma_f32_16x16x32_bf16 v[48:51], v[192:195], a[128:131], -4.0
    v_exp_f32 v60, v60
    v_mfma_f32_16x16x32_bf16 v[48:51], v[196:199], a[132:135], v[48:51]
    v_mfma_f32_16x16x32_bf16 v[48:51], v[200:203], a[136:139], v[48:51]
    s_waitcnt lgkmcnt(3)
    v_exp_f32 v61, v61
    v_cmp_gt_u32 vcc, 8, v11
    v_mfma_f32_16x16x32_bf16 v[48:51], v[204:207], a[140:143], v[48:51]
    ds_read_b128 a[156:159], v25 offset:4096
    v_cvt_pk_bf16_f32 v78, v60, v61
    v_mfma_f32_16x16x32_bf16 v[52:55], v[220:223], a[140:143], -4.0
    v_exp_f32 v62, v62
    v_mfma_f32_16x16x32_bf16 v[52:55], v[216:219], a[136:139], v[52:55]
    v_mfma_f32_16x16x32_bf16 v[52:55], v[212:215], a[132:135], v[52:55]
    s_cbranch_vccnz L_wait6
L_go6:
    v_exp_f32 v63, v63
    v_mfma_f32_16x16x32_bf16 v[52:55], v[208:211], a[128:131], v[52:55]
    ds_read_b128 a[188:191], v6 offset:5120
    v_cvt_pk_bf16_f32 v79, v62, v63
    s_mov_b32 m0, s33
    s_nop 0
    buffer_load_dwordx4 v17, s[20:23], s38 offen offset:0 nt lds
    s_waitcnt vmcnt(8)
    v_lshlrev_b32 v12, 16, v224
    v_and_b32 v13, 0xffff0000, v224
    v_lshlrev_b32 v20, 16, v225
    v_and_b32 v21, 0xffff0000, v225
    v_lshlrev_b32 v22, 16, v226
    v_and_b32 v23, 0xffff0000, v226
    v_lshlrev_b32 v26, 16, v227
    v_and_b32 v27, 0xffff0000, v227
    v_pk_mul_f32 v[12:13], v[12:13], s[34:35]
    v_pk_mul_f32 v[20:21], v[20:21], s[34:35]
    v_pk_mul_f32 v[22:23], v[22:23], s[34:35]
    v_pk_mul_f32 v[26:27], v[26:27], s[34:35]
    v_cvt_pk_bf16_f32 v224, v12, v13
    v_cvt_pk_bf16_f32 v225, v20, v21
    v_cvt_pk_bf16_f32 v226, v22, v23
    v_cvt_pk_bf16_f32 v227, v26, v27
    v_mfma_f32_16x16x32_bf16 v[112:115], a[56:59], a[172:175], v[112:115]
    v_exp_f32 v48, v48
    v_mfma_f32_16x16x32_bf16 v[112:115], a[40:43], a[168:171], v[112:115]
    ds_write_b128 v3, v[76:79] offset:35840
    v_mfma_f32_16x16x32_bf16 v[112:115], a[24:27], a[164:167], v[112:115]
    v_exp_f32 v49, v49
    s_mov_b32 m0, s33
    s_nop 0
    buffer_load_dwordx4 v17, s[20:23], s38 offen offset:1024 nt lds
    s_waitcnt vmcnt(8)
    v_lshlrev_b32 v12, 16, v228
    v_and_b32 v13, 0xffff0000, v228
    v_lshlrev_b32 v20, 16, v229
    v_and_b32 v21, 0xffff0000, v229
    v_lshlrev_b32 v22, 16, v230
    v_and_b32 v23, 0xffff0000, v230
    v_lshlrev_b32 v26, 16, v231
    v_and_b32 v27, 0xffff0000, v231
    v_pk_mul_f32 v[12:13], v[12:13], s[34:35]
    v_pk_mul_f32 v[20:21], v[20:21], s[34:35]
    v_pk_mul_f32 v[22:23], v[22:23], s[34:35]
    v_pk_mul_f32 v[26:27], v[26:27], s[34:35]
    v_cvt_pk_bf16_f32 v228, v12, v13
    v_cvt_pk_bf16_f32 v229, v20, v21
    v_cvt_pk_bf16_f32 v230, v22, v23
    v_cvt_pk_bf16_f32 v231, v26, v27
    v_mfma_f32_16x16x32_bf16 v[112:115], a[8:11], v[80:83], v[112:115]
    ds_read_b128 a[128:131], v7 offset:32768
    ds_read_b128 a[132:135], v0 offset:32768
    v_mfma_f32_16x16x32_bf16 v[116:119], a[72:75], v[80:83], v[116:119]
    v_exp_f32 v50, v50
    v_mfma_f32_16x16x32_bf16 v[116:119], a[88:91], a[164:167], v[116:119]
    ds_read_b128 a[136:139], v15 offset:32768
    v_cvt_pk_bf16_f32 v80, v48, v49
    v_mfma_f32_16x16x32_bf16 v[116:119], a[104:107], a[168:171], v[116:119]
    v_exp_f32 v51, v51
    s_mov_b32 m0, s33
    s_nop 0
    buffer_load_dwordx4 v17, s[20:23], s38 offen offset:2048 nt lds
    s_waitcnt vmcnt(8)
    v_lshlrev_b32 v12, 16, v232
    v_and_b32 v13, 0xffff0000, v232
    v_lshlrev_b32 v20, 16, v233
    v_and_b32 v21, 0xffff0000, v233
    v_lshlrev_b32 v22, 16, v234
    v_and_b32 v23, 0xffff0000, v234
    v_lshlrev_b32 v26, 16, v235
    v_and_b32 v27, 0xffff0000, v235
    v_pk_mul_f32 v[12:13], v[12:13], s[34:35]
    v_pk_mul_f32 v[20:21], v[20:21], s[34:35]
    v_pk_mul_f32 v[22:23], v[22:23], s[34:35]
    v_pk_mul_f32 v[26:27], v[26:27], s[34:35]
    v_cvt_pk_bf16_f32 v232, v12, v13
    v_cvt_pk_bf16_f32 v233, v20, v21
    v_cvt_pk_bf16_f32 v234, v22, v23
    v_cvt_pk_bf16_f32 v235, v26, v27
    v_mfma_f32_16x16x32_bf16 v[116:119], a[120:123], a[172:175], v[116:119]
    v_cvt_pk_bf16_f32 v81, v50, v51
    v_mfma_f32_16x16x32_bf16 v[56:59], v[192:195], a[144:147], -4.0
    v_exp_f32 v52, v52
    v_mfma_f32_16x16x32_bf16 v[56:59], v[196:199], a[148:151], v[56:59]
    s_waitcnt lgkmcnt(4)
    ds_inc_u32 v9, v24 offset:5132
    s_mov_b32 m0, s33
    s_nop 0
    buffer_load_dwordx4 v17, s[20:23], s38 offen offset:3072 nt lds
    s_waitcnt vmcnt(8)
    v_lshlrev_b32 v12, 16, v236
    v_and_b32 v13, 0xffff0000, v236
    v_lshlrev_b32 v20, 16, v237
    v_and_b32 v21, 0xffff0000, v237
    v_lshlrev_b32 v22, 16, v238
    v_and_b32 v23, 0xffff0000, v238
    v_lshlrev_b32 v26, 16, v239
    v_and_b32 v27, 0xffff0000, v239
    v_pk_mul_f32 v[12:13], v[12:13], s[34:35]
    v_pk_mul_f32 v[20:21], v[20:21], s[34:35]
    v_pk_mul_f32 v[22:23], v[22:23], s[34:35]
    v_pk_mul_f32 v[26:27], v[26:27], s[34:35]
    v_cvt_pk_bf16_f32 v236, v12, v13
    v_cvt_pk_bf16_f32 v237, v20, v21
    v_cvt_pk_bf16_f32 v238, v22, v23
    v_cvt_pk_bf16_f32 v239, v26, v27
    v_mfma_f32_16x16x32_bf16 v[56:59], v[200:203], a[152:155], v[56:59]
    v_exp_f32 v53, v53
    v_mfma_f32_16x16x32_bf16 v[56:59], v[204:207], a[156:159], v[56:59]
    ds_read_b128 a[164:167], v4 offset:6144
    v_cvt_pk_bf16_f32 v82, v52, v53
    v_mfma_f32_16x16x32_bf16 v[60:63], v[220:223], a[156:159], -4.0
    v_exp_f32 v54, v54
    v_mfma_f32_16x16x32_bf16 v[60:63], v[216:219], a[152:155], v[60:63]
    ds_read_b128 a[140:143], v25 offset:32768
    ds_read_b128 a[168:171], v5 offset:6144
    s_add_u32 m0, s33, 4096
    s_nop 0
    buffer_load_dwordx4 v17, s[20:23], s42 offen offset:0 nt lds
    s_waitcnt vmcnt(8)
    v_lshlrev_b32 v12, 16, v240
    v_and_b32 v13, 0xffff0000, v240
    v_lshlrev_b32 v20, 16, v241
    v_and_b32 v21, 0xffff0000, v241
    v_lshlrev_b32 v22, 16, v242
    v_and_b32 v23, 0xffff0000, v242
    v_lshlrev_b32 v26, 16, v243
    v_and_b32 v27, 0xffff0000, v243
    v_pk_mul_f32 v[12:13], v[12:13], s[34:35]
    v_pk_mul_f32 v[20:21], v[20:21], s[34:35]
    v_pk_mul_f32 v[22:23], v[22:23], s[34:35]
    v_pk_mul_f32 v[26:27], v[26:27], s[34:35]
    v_cvt_pk_bf16_f32 v240, v12, v13
    v_cvt_pk_bf16_f32 v241, v20, v21
    v_cvt_pk_bf16_f32 v242, v22, v23
    v_cvt_pk_bf16_f32 v243, v26, v27
    v_mfma_f32_16x16x32_bf16 v[60:63], v[212:215], a[148:151], v[60:63]
    v_exp_f32 v55, v55
    v_mfma_f32_16x16x32_bf16 v[60:63], v[208:211], a[144:147], v[60:63]
    ds_read_b128 a[172:175], v6 offset:6144
    v_cvt_pk_bf16_f32 v83, v54, v55
    v_mfma_f32_16x16x32_bf16 v[120:123], a[56:59], a[188:191], v[120:123]
    v_exp_f32 v56, v56
    s_add_u32 m0, s33, 4096
    s_nop 0
    buffer_load_dwordx4 v17, s[20:23], s42 offen offset:1024 nt lds
    s_waitcnt vmcnt(8)
    v_lshlrev_b32 v12, 16, v244
    v_and_b32 v13, 0xffff0000, v244
    v_lshlrev_b32 v20, 16, v245
    v_and_b32 v21, 0xffff0000, v245
    v_lshlrev_b32 v22, 16, v246
    v_and_b32 v23, 0xffff0000, v246
    v_lshlrev_b32 v26, 16, v247
    v_and_b32 v27, 0xffff0000, v247
    v_pk_mul_f32 v[12:13], v[12:13], s[34:35]
    v_pk_mul_f32 v[20:21], v[20:21], s[34:35]
    v_pk_mul_f32 v[22:23], v[22:23], s[34:35]
    v_pk_mul_f32 v[26:27], v[26:27], s[34:35]
    v_cvt_pk_bf16_f32 v244, v12, v13
    v_cvt_pk_bf16_f32 v245, v20, v21
    v_cvt_pk_bf16_f32 v246, v22, v23
    v_cvt_pk_bf16_f32 v247, v26, v27
    v_mfma_f32_16x16x32_bf16 v[120:123], a[40:43], a[184:187], v[120:123]
    ds_write_b128 v3, v[80:83] offset:36864
    v_mfma_f32_16x16x32_bf16 v[120:123], a[24:27], a[180:183], v[120:123]
    v_exp_f32 v57, v57
    v_mfma_f32_16x16x32_bf16 v[120:123], a[8:11], v[84:87], v[120:123]
    ds_read_b128 a[144:147], v7 offset:36864
    ds_read_b128 a[148:151], v0 offset:36864
    v_mfma_f32_16x16x32_bf16 v[124:127], a[72:75], v[84:87], v[124:127]
    v_exp_f32 v58, v58
    s_add_u32 m0, s33, 4096
    s_nop 0
    buffer_load_dwordx4 v17, s[20:23], s42 offen offset:2048 nt lds
    s_waitcnt vmcnt(8)
    v_lshlrev_b32 v12, 16, v248
    v_and_b32 v13, 0xffff0000, v248
    v_lshlrev_b32 v20, 16, v249
    v_and_b32 v21, 0xffff0000, v249
    v_lshlrev_b32 v22, 16, v250
    v_and_b32 v23, 0xffff0000, v250
    v_lshlrev_b32 v26, 16, v251
    v_and_b32 v27, 0xffff0000, v251
    v_pk_mul_f32 v[12:13], v[12:13], s[34:35]
    v_pk_mul_f32 v[20:21], v[20:21], s[34:35]
    v_pk_mul_f32 v[22:23], v[22:23], s[34:35]
    v_pk_mul_f32 v[26:27], v[26:27], s[34:35]
    v_cvt_pk_bf16_f32 v248, v12, v13
    v_cvt_pk_bf16_f32 v249, v20, v21
    v_cvt_pk_bf16_f32 v250, v22, v23
    v_cvt_pk_bf16_f32 v251, v26, v27
    v_mfma_f32_16x16x32_bf16 v[124:127], a[88:91], a[180:183], v[124:127]
    ds_read_b128 a[152:155], v15 offset:36864
    v_cvt_pk_bf16_f32 v84, v56, v57
    v_mfma_f32_16x16x32_bf16 v[124:127], a[104:107], a[184:187], v[124:127]
    v_exp_f32 v59, v59
    v_mfma_f32_16x16x32_bf16 v[124:127], a[120:123], a[188:191], v[124:127]
    ds_read_b128 a[180:183], v4 offset:7168
    v_cvt_pk_bf16_f32 v85, v58, v59
    v_smfmac_f32_16x16x64_bf16 a[176:179], a[192:195], v[72:79], v24
    s_waitcnt lgkmcnt(5)
    ds_read_b128 a[184:187], v5 offset:7168
    s_add_u32 m0, s33, 4096
    s_nop 0
    buffer_load_dwordx4 v17, s[20:23], s42 offen offset:3072 nt lds
    s_waitcnt vmcnt(8)
    v_lshlrev_b32 v12, 16, v252
    v_and_b32 v13, 0xffff0000, v252
    v_lshlrev_b32 v20, 16, v253
    v_and_b32 v21, 0xffff0000, v253
    v_lshlrev_b32 v22, 16, v254
    v_and_b32 v23, 0xffff0000, v254
    v_lshlrev_b32 v26, 16, v255
    v_and_b32 v27, 0xffff0000, v255
    v_pk_mul_f32 v[12:13], v[12:13], s[34:35]
    v_pk_mul_f32 v[20:21], v[20:21], s[34:35]
    v_pk_mul_f32 v[22:23], v[22:23], s[34:35]
    v_pk_mul_f32 v[26:27], v[26:27], s[34:35]
    v_cvt_pk_bf16_f32 v252, v12, v13
    v_cvt_pk_bf16_f32 v253, v20, v21
    v_cvt_pk_bf16_f32 v254, v22, v23
    v_cvt_pk_bf16_f32 v255, v26, v27
    v_mfma_f32_16x16x32_bf16 v[48:51], v[224:227], a[128:131], -4.0
    v_exp_f32 v60, v60
    v_mfma_f32_16x16x32_bf16 v[48:51], v[228:231], a[132:135], v[48:51]
    s_add_u32 m0, s32, 8192
    s_mov_b32 s43, 40960
    buffer_load_dwordx4 v1, s[12:15], s43 offen lds
    v_mfma_f32_16x16x32_bf16 v[48:51], v[232:235], a[136:139], v[48:51]
    v_exp_f32 v61, v61
    v_mfma_f32_16x16x32_bf16 v[48:51], v[236:239], a[140:143], v[48:51]
    ds_read_b128 a[156:159], v25 offset:36864
    v_cvt_pk_bf16_f32 v86, v60, v61
    v_mfma_f32_16x16x32_bf16 v[52:55], v[252:255], a[140:143], -4.0
    v_exp_f32 v62, v62
    v_mfma_f32_16x16x32_bf16 v[52:55], v[248:251], a[136:139], v[52:55]
    v_mfma_f32_16x16x32_bf16 v[52:55], v[244:247], a[132:135], v[52:55]
    ds_read_b32 v11, v9 offset:5132
    v_exp_f32 v63, v63
    v_mfma_f32_16x16x32_bf16 v[52:55], v[240:243], a[128:131], v[52:55]
    ds_read_b128 a[188:191], v6 offset:7168
    v_cvt_pk_bf16_f32 v87, v62, v63
    v_mfma_f32_16x16x32_bf16 v[96:99], a[56:59], a[172:175], v[96:99]
    v_exp_f32 v48, v48
    v_mfma_f32_16x16x32_bf16 v[96:99], a[40:43], a[168:171], v[96:99]
    ds_write_b128 v3, v[84:87] offset:37888
    v_mfma_f32_16x16x32_bf16 v[96:99], a[24:27], a[164:167], v[96:99]
    v_exp_f32 v49, v49
    v_mfma_f32_16x16x32_bf16 v[96:99], a[8:11], v[88:91], v[96:99]
    ds_read_b128 a[128:131], v7 offset:40960
    ds_read_b128 a[132:135], v0 offset:40960
    v_mfma_f32_16x16x32_bf16 v[100:103], a[72:75], v[88:91], v[100:103]
    v_exp_f32 v50, v50
    v_mfma_f32_16x16x32_bf16 v[100:103], a[88:91], a[164:167], v[100:103]
    s_waitcnt lgkmcnt(4)
    ds_read_b128 a[136:139], v15 offset:40960
    v_cvt_pk_bf16_f32 v88, v48, v49
    v_cmp_gt_u32 vcc, 8, v11
    v_mfma_f32_16x16x32_bf16 v[100:103], a[104:107], a[168:171], v[100:103]
    v_exp_f32 v51, v51
    s_add_u32 m0, s32, 12288
    s_mov_b32 s43, 45056
    buffer_load_dwordx4 v1, s[12:15], s43 offen lds
    v_mfma_f32_16x16x32_bf16 v[100:103], a[120:123], a[172:175], v[100:103]
    v_cvt_pk_bf16_f32 v89, v50, v51
    v_mfma_f32_16x16x32_bf16 v[56:59], v[224:227], a[144:147], -4.0
    v_exp_f32 v52, v52
    v_mfma_f32_16x16x32_bf16 v[56:59], v[228:231], a[148:151], v[56:59]
    s_cbranch_vccnz L_wait7
L_go7:
    v_mfma_f32_16x16x32_bf16 v[56:59], v[232:235], a[152:155], v[56:59]
    v_exp_f32 v53, v53
    v_mfma_f32_16x16x32_bf16 v[56:59], v[236:239], a[156:159], v[56:59]
    ds_read_b128 a[164:167], v4 offset:32768
    v_cvt_pk_bf16_f32 v90, v52, v53
    v_mfma_f32_16x16x32_bf16 v[60:63], v[252:255], a[156:159], -4.0
    v_exp_f32 v54, v54
    v_mfma_f32_16x16x32_bf16 v[60:63], v[248:251], a[152:155], v[60:63]
    ds_read_b128 a[140:143], v25 offset:40960
    ds_read_b128 a[168:171], v5 offset:32768
    v_mfma_f32_16x16x32_bf16 v[60:63], v[244:247], a[148:151], v[60:63]
    v_exp_f32 v55, v55
    v_mfma_f32_16x16x32_bf16 v[60:63], v[240:243], a[144:147], v[60:63]
    s_waitcnt lgkmcnt(3)
    ds_read_b128 a[172:175], v6 offset:32768
    v_cvt_pk_bf16_f32 v91, v54, v55
    v_mfma_f32_16x16x32_bf16 v[104:107], a[56:59], a[188:191], v[104:107]
    v_exp_f32 v56, v56
    v_mfma_f32_16x16x32_bf16 v[104:107], a[40:43], a[184:187], v[104:107]
    ds_write_b128 v3, v[88:91] offset:38912
    v_mfma_f32_16x16x32_bf16 v[104:107], a[24:27], a[180:183], v[104:107]
    v_exp_f32 v57, v57
    v_mfma_f32_16x16x32_bf16 v[104:107], a[8:11], v[92:95], v[104:107]
    ds_read_b128 a[144:147], v7 offset:45056
    ds_read_b128 a[148:151], v0 offset:45056
    v_mfma_f32_16x16x32_bf16 v[108:111], a[72:75], v[92:95], v[108:111]
    v_exp_f32 v58, v58
    v_mfma_f32_16x16x32_bf16 v[108:111], a[88:91], a[180:183], v[108:111]
    ds_read_b128 a[152:155], v15 offset:45056
    v_cvt_pk_bf16_f32 v92, v56, v57
    v_mfma_f32_16x16x32_bf16 v[108:111], a[104:107], a[184:187], v[108:111]
    v_exp_f32 v59, v59
    v_mfma_f32_16x16x32_bf16 v[108:111], a[120:123], a[188:191], v[108:111]
    ds_read_b128 a[180:183], v4 offset:33792
    v_cvt_pk_bf16_f32 v93, v58, v59
    v_smfmac_f32_16x16x64_bf16 a[248:251], a[192:195], v[80:87], v24
    ds_read_b128 a[184:187], v5 offset:33792
    v_mfma_f32_16x16x32_bf16 v[48:51], v[224:227], a[128:131], -4.0
    v_exp_f32 v60, v60
    v_mfma_f32_16x16x32_bf16 v[48:51], v[228:231], a[132:135], v[48:51]
    s_add_u32 m0, s32, 16384
    s_mov_b32 s43, 49152
    buffer_load_dwordx4 v1, s[12:15], s43 offen lds
    v_mfma_f32_16x16x32_bf16 v[48:51], v[232:235], a[136:139], v[48:51]
    s_waitcnt lgkmcnt(3)
    v_exp_f32 v61, v61
    v_mfma_f32_16x16x32_bf16 v[48:51], v[236:239], a[140:143], v[48:51]
    ds_read_b128 a[156:159], v25 offset:45056
    v_cvt_pk_bf16_f32 v94, v60, v61
    v_mfma_f32_16x16x32_bf16 v[52:55], v[252:255], a[140:143], -4.0
    v_exp_f32 v62, v62
    v_mfma_f32_16x16x32_bf16 v[52:55], v[248:251], a[136:139], v[52:55]
    v_mfma_f32_16x16x32_bf16 v[52:55], v[244:247], a[132:135], v[52:55]
    v_exp_f32 v63, v63
    v_mfma_f32_16x16x32_bf16 v[52:55], v[240:243], a[128:131], v[52:55]
    ds_read_b128 a[188:191], v6 offset:33792
    v_cvt_pk_bf16_f32 v95, v62, v63
    s_add_u32 m0, s32, 20480
    s_mov_b32 s43, 53248
    buffer_load_dwordx4 v1, s[12:15], s43 offen lds
    v_mfma_f32_16x16x32_bf16 v[32:35], a[56:59], a[172:175], v[32:35]
    v_exp_f32 v48, v48
    v_mfma_f32_16x16x32_bf16 v[32:35], a[40:43], a[168:171], v[32:35]
    ds_write_b128 v3, v[92:95] offset:39936
    v_mfma_f32_16x16x32_bf16 v[32:35], a[24:27], a[164:167], v[32:35]
    v_exp_f32 v49, v49
    v_mfma_f32_16x16x32_bf16 v[32:35], a[8:11], v[64:67], v[32:35]
    ds_read_b128 a[128:131], v7 offset:49152
    ds_read_b128 a[132:135], v0 offset:49152
    v_mfma_f32_16x16x32_bf16 v[36:39], a[72:75], v[64:67], v[36:39]
    v_exp_f32 v50, v50
    v_mfma_f32_16x16x32_bf16 v[36:39], a[88:91], a[164:167], v[36:39]
    ds_read_b128 a[136:139], v15 offset:49152
    v_cvt_pk_bf16_f32 v64, v48, v49
    v_mfma_f32_16x16x32_bf16 v[36:39], a[104:107], a[168:171], v[36:39]
    v_exp_f32 v51, v51
    v_mfma_f32_16x16x32_bf16 v[36:39], a[120:123], a[172:175], v[36:39]
    v_cvt_pk_bf16_f32 v65, v50, v51
    v_mfma_f32_16x16x32_bf16 v[56:59], v[224:227], a[144:147], -4.0
    v_exp_f32 v52, v52
    v_mfma_f32_16x16x32_bf16 v[56:59], v[228:231], a[148:151], v[56:59]
    s_waitcnt lgkmcnt(4)
    ds_inc_u32 v9, v24 offset:5632
    v_mfma_f32_16x16x32_bf16 v[56:59], v[232:235], a[152:155], v[56:59]
    v_exp_f32 v53, v53
    v_mfma_f32_16x16x32_bf16 v[56:59], v[236:239], a[156:159], v[56:59]
    ds_read_b128 a[164:167], v4 offset:34816
    v_cvt_pk_bf16_f32 v66, v52, v53
    v_mfma_f32_16x16x32_bf16 v[60:63], v[252:255], a[156:159], -4.0
    v_exp_f32 v54, v54
    v_mfma_f32_16x16x32_bf16 v[60:63], v[248:251], a[152:155], v[60:63]
    ds_read_b128 a[140:143], v25 offset:49152
    ds_read_b128 a[168:171], v5 offset:34816
    v_mfma_f32_16x16x32_bf16 v[60:63], v[244:247], a[148:151], v[60:63]
    v_exp_f32 v55, v55
    v_mfma_f32_16x16x32_bf16 v[60:63], v[240:243], a[144:147], v[60:63]
    ds_read_b128 a[172:175], v6 offset:34816
    v_cvt_pk_bf16_f32 v67, v54, v55
    v_mfma_f32_16x16x32_bf16 v[40:43], a[56:59], a[188:191], v[40:43]
    v_exp_f32 v56, v56
    v_mfma_f32_16x16x32_bf16 v[40:43], a[40:43], a[184:187], v[40:43]
    ds_write_b128 v3, v[64:67] offset:0
    v_mfma_f32_16x16x32_bf16 v[40:43], a[24:27], a[180:183], v[40:43]
    v_exp_f32 v57, v57
    v_mfma_f32_16x16x32_bf16 v[40:43], a[8:11], v[68:71], v[40:43]
    ds_read_b128 a[144:147], v7 offset:53248
    ds_read_b128 a[148:151], v0 offset:53248
    v_mfma_f32_16x16x32_bf16 v[44:47], a[72:75], v[68:71], v[44:47]
    v_exp_f32 v58, v58
    v_mfma_f32_16x16x32_bf16 v[44:47], a[88:91], a[180:183], v[44:47]
    ds_read_b128 a[152:155], v15 offset:53248
    v_cvt_pk_bf16_f32 v68, v56, v57
    v_mfma_f32_16x16x32_bf16 v[44:47], a[104:107], a[184:187], v[44:47]
    v_exp_f32 v59, v59
    v_mfma_f32_16x16x32_bf16 v[44:47], a[120:123], a[188:191], v[44:47]
    ds_read_b128 a[180:183], v4 offset:35840
    v_cvt_pk_bf16_f32 v69, v58, v59
    v_smfmac_f32_16x16x64_bf16 v[28:31], a[192:195], v[88:95], v24
    s_waitcnt lgkmcnt(5)
    ds_read_b128 a[184:187], v5 offset:35840
    v_mfma_f32_16x16x32_bf16 v[48:51], v[224:227], a[128:131], -4.0
    v_exp_f32 v60, v60
    v_mfma_f32_16x16x32_bf16 v[48:51], v[228:231], a[132:135], v[48:51]
    v_mfma_f32_16x16x32_bf16 v[48:51], v[232:235], a[136:139], v[48:51]
    v_exp_f32 v61, v61
    v_mfma_f32_16x16x32_bf16 v[48:51], v[236:239], a[140:143], v[48:51]
    ds_read_b128 a[156:159], v25 offset:53248
    v_cvt_pk_bf16_f32 v70, v60, v61
    v_mfma_f32_16x16x32_bf16 v[52:55], v[252:255], a[140:143], -4.0
    v_exp_f32 v62, v62
    v_mfma_f32_16x16x32_bf16 v[52:55], v[248:251], a[136:139], v[52:55]
    v_add_f32 v26, v28, v29
    v_mov_b64 v[28:29], 0
    v_mfma_f32_16x16x32_bf16 v[52:55], v[244:247], a[132:135], v[52:55]
    ds_read_b32 v11, v9 offset:5632
    v_exp_f32 v63, v63
    v_mfma_f32_16x16x32_bf16 v[52:55], v[240:243], a[128:131], v[52:55]
    ds_read_b128 a[188:191], v6 offset:35840
    v_cvt_pk_bf16_f32 v71, v62, v63
    v_mfma_f32_16x16x32_bf16 a[200:203], a[56:59], a[172:175], a[200:203]
    v_exp_f32 v48, v48
    v_mfma_f32_16x16x32_bf16 a[200:203], a[40:43], a[168:171], a[200:203]
    ds_write_b128 v3, v[68:71] offset:1024
    v_mfma_f32_16x16x32_bf16 a[200:203], a[24:27], a[164:167], a[200:203]
    v_exp_f32 v49, v49
    v_mfma_f32_16x16x32_bf16 a[200:203], a[8:11], v[72:75], a[200:203]
    ds_read_b128 a[128:131], v7 offset:24576
    ds_read_b128 a[132:135], v0 offset:24576
    v_mfma_f32_16x16x32_bf16 a[204:207], a[72:75], v[72:75], a[204:207]
    v_exp_f32 v50, v50
    v_mfma_f32_16x16x32_bf16 a[204:207], a[88:91], a[164:167], a[204:207]
    s_waitcnt lgkmcnt(4)
    ds_read_b128 a[136:139], v15 offset:24576
    v_cvt_pk_bf16_f32 v72, v48, v49
    v_cmp_gt_u32 vcc, 8, v11
    v_mfma_f32_16x16x32_bf16 a[204:207], a[104:107], a[168:171], a[204:207]
    v_exp_f32 v51, v51
    v_mfma_f32_16x16x32_bf16 a[204:207], a[120:123], a[172:175], a[204:207]
    v_cvt_pk_bf16_f32 v73, v50, v51
    v_mfma_f32_16x16x32_bf16 v[56:59], v[224:227], a[144:147], -4.0
    v_exp_f32 v52, v52
    v_mfma_f32_16x16x32_bf16 v[56:59], v[228:231], a[148:151], v[56:59]
    s_cbranch_vccnz L_wait8
L_go8:
    ds_write_b32 v8, v26 offset:1024
    v_mfma_f32_16x16x32_bf16 v[56:59], v[232:235], a[152:155], v[56:59]
    v_exp_f32 v53, v53
    v_mfma_f32_16x16x32_bf16 v[56:59], v[236:239], a[156:159], v[56:59]
    ds_read_b128 a[164:167], v4 offset:36864
    v_cvt_pk_bf16_f32 v74, v52, v53
    v_mfma_f32_16x16x32_bf16 v[60:63], v[252:255], a[156:159], -4.0
    v_exp_f32 v54, v54
    v_mfma_f32_16x16x32_bf16 v[60:63], v[248:251], a[152:155], v[60:63]
    ds_read_b128 a[140:143], v25 offset:24576
    ds_read_b128 a[168:171], v5 offset:36864
    v_mfma_f32_16x16x32_bf16 v[60:63], v[244:247], a[148:151], v[60:63]
    v_exp_f32 v55, v55
    v_mfma_f32_16x16x32_bf16 v[60:63], v[240:243], a[144:147], v[60:63]
    s_waitcnt lgkmcnt(4)
    ds_read_b128 a[172:175], v6 offset:36864
    v_cvt_pk_bf16_f32 v75, v54, v55
    v_mfma_f32_16x16x32_bf16 a[208:211], a[56:59], a[188:191], a[208:211]
    v_exp_f32 v56, v56
    v_mfma_f32_16x16x32_bf16 a[208:211], a[40:43], a[184:187], a[208:211]
    ds_write_b128 v3, v[72:75] offset:2048
    v_mfma_f32_16x16x32_bf16 a[208:211], a[24:27], a[180:183], a[208:211]
    v_exp_f32 v57, v57
    v_mfma_f32_16x16x32_bf16 a[208:211], a[8:11], v[76:79], a[208:211]
    ds_read_b128 a[144:147], v7 offset:28672
    ds_read_b128 a[148:151], v0 offset:28672
    v_mfma_f32_16x16x32_bf16 a[212:215], a[72:75], v[76:79], a[212:215]
    v_exp_f32 v58, v58
    v_mfma_f32_16x16x32_bf16 a[212:215], a[88:91], a[180:183], a[212:215]
    ds_read_b128 a[152:155], v15 offset:28672
    v_cvt_pk_bf16_f32 v76, v56, v57
    v_mfma_f32_16x16x32_bf16 a[212:215], a[104:107], a[184:187], a[212:215]
    v_exp_f32 v59, v59
    v_mfma_f32_16x16x32_bf16 a[212:215], a[120:123], a[188:191], a[212:215]
    ds_read_b128 a[180:183], v4 offset:37888
    v_cvt_pk_bf16_f32 v77, v58, v59
    v_smfmac_f32_16x16x64_bf16 a[196:199], a[192:195], v[64:71], v24
    ds_read_b128 a[184:187], v5 offset:37888
    v_mfma_f32_16x16x32_bf16 v[48:51], v[224:227], a[128:131], -4.0
    v_exp_f32 v60, v60
    v_mfma_f32_16x16x32_bf16 v[48:51], v[228:231], a[132:135], v[48:51]
    v_mfma_f32_16x16x32_bf16 v[48:51], v[232:235], a[136:139], v[48:51]
    s_waitcnt lgkmcnt(3)
    v_exp_f32 v61, v61
    v_mfma_f32_16x16x32_bf16 v[48:51], v[236:239], a[140:143], v[48:51]
    ds_read_b128 a[156:159], v25 offset:28672
    v_cvt_pk_bf16_f32 v78, v60, v61
    v_mfma_f32_16x16x32_bf16 v[52:55], v[252:255], a[140:143], -4.0
    v_exp_f32 v62, v62
    v_mfma_f32_16x16x32_bf16 v[52:55], v[248:251], a[136:139], v[52:55]
    v_accvgpr_read_b32 v26, a196
    v_accvgpr_read_b32 v27, a197
    v_mfma_f32_16x16x32_bf16 v[52:55], v[244:247], a[132:135], v[52:55]
    v_exp_f32 v63, v63
    v_mfma_f32_16x16x32_bf16 v[52:55], v[240:243], a[128:131], v[52:55]
    ds_read_b128 a[188:191], v6 offset:37888
    v_cvt_pk_bf16_f32 v79, v62, v63
    v_mfma_f32_16x16x32_bf16 a[216:219], a[56:59], a[172:175], a[216:219]
    v_exp_f32 v48, v48
    v_mfma_f32_16x16x32_bf16 a[216:219], a[40:43], a[168:171], a[216:219]
    ds_write_b128 v3, v[76:79] offset:3072
    v_mfma_f32_16x16x32_bf16 a[216:219], a[24:27], a[164:167], a[216:219]
    v_exp_f32 v49, v49
    v_mfma_f32_16x16x32_bf16 a[216:219], a[8:11], v[80:83], a[216:219]
    ds_read_b128 a[128:131], v7 offset:0
    ds_read_b128 a[132:135], v0 offset:0
    s_waitcnt vmcnt(2)
    ds_inc_u32 v9, v24 offset:5636
    v_mfma_f32_16x16x32_bf16 a[220:223], a[72:75], v[80:83], a[220:223]
    v_exp_f32 v50, v50
    v_mfma_f32_16x16x32_bf16 a[220:223], a[88:91], a[164:167], a[220:223]
    ds_read_b128 a[136:139], v15 offset:0
    v_cvt_pk_bf16_f32 v80, v48, v49
    v_mfma_f32_16x16x32_bf16 a[220:223], a[104:107], a[168:171], a[220:223]
    v_exp_f32 v51, v51
    v_mfma_f32_16x16x32_bf16 a[220:223], a[120:123], a[172:175], a[220:223]
    v_cvt_pk_bf16_f32 v81, v50, v51
    v_add_f32 v26, v26, v27
    v_mfma_f32_16x16x32_bf16 v[56:59], v[224:227], a[144:147], -4.0
    v_exp_f32 v52, v52
    v_mfma_f32_16x16x32_bf16 v[56:59], v[228:231], a[148:151], v[56:59]
    s_waitcnt lgkmcnt(5)
    ds_write_b32 v8, v26 offset:1536
    v_mfma_f32_16x16x32_bf16 v[56:59], v[232:235], a[152:155], v[56:59]
    v_exp_f32 v53, v53
    v_mfma_f32_16x16x32_bf16 v[56:59], v[236:239], a[156:159], v[56:59]
    ds_read_b128 a[164:167], v4 offset:38912
    ds_read_b32 v11, v9 offset:5636
    v_cvt_pk_bf16_f32 v82, v52, v53
    v_mfma_f32_16x16x32_bf16 v[60:63], v[252:255], a[156:159], -4.0
    v_exp_f32 v54, v54
    v_mfma_f32_16x16x32_bf16 v[60:63], v[248:251], a[152:155], v[60:63]
    ds_read_b128 a[140:143], v25 offset:0
    ds_read_b128 a[168:171], v5 offset:38912
    v_mfma_f32_16x16x32_bf16 v[60:63], v[244:247], a[148:151], v[60:63]
    v_exp_f32 v55, v55
    v_mfma_f32_16x16x32_bf16 v[60:63], v[240:243], a[144:147], v[60:63]
    ds_read_b128 a[172:175], v6 offset:38912
    v_cvt_pk_bf16_f32 v83, v54, v55
    v_mfma_f32_16x16x32_bf16 a[224:227], a[56:59], a[188:191], a[224:227]
    v_exp_f32 v56, v56
    v_mfma_f32_16x16x32_bf16 a[224:227], a[40:43], a[184:187], a[224:227]
    ds_write_b128 v3, v[80:83] offset:4096
    v_mfma_f32_16x16x32_bf16 a[224:227], a[24:27], a[180:183], a[224:227]
    s_waitcnt lgkmcnt(4)
    v_exp_f32 v57, v57
    v_cmp_gt_u32 vcc, 8, v11
    v_mfma_f32_16x16x32_bf16 a[224:227], a[8:11], v[84:87], a[224:227]
    ds_read_b128 a[144:147], v7 offset:4096
    ds_read_b128 a[148:151], v0 offset:4096
    v_mfma_f32_16x16x32_bf16 a[228:231], a[72:75], v[84:87], a[228:231]
    v_exp_f32 v58, v58
    v_mfma_f32_16x16x32_bf16 a[228:231], a[88:91], a[180:183], a[228:231]
    ds_read_b128 a[152:155], v15 offset:4096
    v_cvt_pk_bf16_f32 v84, v56, v57
    v_mfma_f32_16x16x32_bf16 a[228:231], a[104:107], a[184:187], a[228:231]
    s_cbranch_vccnz L_wait9
L_go9:
    v_exp_f32 v59, v59
    v_add_u32 v19, v18, v3
    v_add_u32 v14, v18, v4
    ds_read_b64_tr_b16 a[12:13], v19 offset:0
    ds_read_b64_tr_b16 a[14:15], v19 offset:1024
    ds_read_b64_tr_b16 a[76:77], v19 offset:8
    ds_read_b64_tr_b16 a[78:79], v19 offset:1032
    ds_read_b64_tr_b16 a[28:29], v14 offset:0
    ds_read_b64_tr_b16 a[30:31], v14 offset:1024
    ds_read_b64_tr_b16 a[92:93], v14 offset:8
    ds_read_b64_tr_b16 a[94:95], v14 offset:1032
    v_add_u32 v19, v18, v5
    v_add_u32 v14, v18, v6
    ds_read_b64_tr_b16 a[44:45], v19 offset:0
    ds_read_b64_tr_b16 a[46:47], v19 offset:1024
    ds_read_b64_tr_b16 a[108:109], v19 offset:8
    ds_read_b64_tr_b16 a[110:111], v19 offset:1032
    ds_read_b64_tr_b16 a[60:61], v14 offset:0
    ds_read_b64_tr_b16 a[62:63], v14 offset:1024
    ds_read_b64_tr_b16 a[124:125], v14 offset:8
    ds_read_b64_tr_b16 a[126:127], v14 offset:1032
    v_mfma_f32_16x16x32_bf16 a[228:231], a[120:123], a[188:191], a[228:231]
    ds_read_b128 a[180:183], v4 offset:39936
    v_cvt_pk_bf16_f32 v85, v58, v59
    v_smfmac_f32_16x16x64_bf16 a[160:163], a[192:195], v[72:79], v24
    ds_read_b128 a[184:187], v5 offset:39936
    v_mfma_f32_16x16x32_bf16 v[48:51], v[224:227], a[128:131], -4.0
    v_exp_f32 v60, v60
    v_mfma_f32_16x16x32_bf16 v[48:51], v[228:231], a[132:135], v[48:51]
    v_mfma_f32_16x16x32_bf16 v[48:51], v[232:235], a[136:139], v[48:51]
    s_waitcnt lgkmcnt(15)
    v_exp_f32 v61, v61
    v_mfma_f32_16x16x32_bf16 v[48:51], v[236:239], a[140:143], v[48:51]
    ds_read_b128 a[156:159], v25 offset:4096
    v_cvt_pk_bf16_f32 v86, v60, v61
    v_mfma_f32_16x16x32_bf16 v[52:55], v[252:255], a[140:143], -4.0
    v_exp_f32 v62, v62
    v_mfma_f32_16x16x32_bf16 v[52:55], v[248:251], a[136:139], v[52:55]
    v_accvgpr_read_b32 v26, a160
    v_accvgpr_read_b32 v27, a161
    v_mfma_f32_16x16x32_bf16 v[52:55], v[244:247], a[132:135], v[52:55]
    v_exp_f32 v63, v63
    v_mfma_f32_16x16x32_bf16 v[52:55], v[240:243], a[128:131], v[52:55]
    s_waitcnt lgkmcnt(1)
    ds_read_b128 a[188:191], v6 offset:39936
    v_cvt_pk_bf16_f32 v87, v62, v63
    v_mfma_f32_16x16x32_bf16 v[112:115], a[60:63], a[172:175], v[112:115]
    v_exp_f32 v48, v48
    v_mfma_f32_16x16x32_bf16 v[112:115], a[44:47], a[168:171], v[112:115]
    ds_write_b128 v3, v[84:87] offset:5120
    v_mfma_f32_16x16x32_bf16 v[112:115], a[28:31], a[164:167], v[112:115]
    v_exp_f32 v49, v49
    v_mfma_f32_16x16x32_bf16 v[112:115], a[12:15], v[88:91], v[112:115]
    ds_read_b128 a[128:131], v7 offset:8192
    ds_read_b128 a[132:135], v0 offset:8192
    v_mfma_f32_16x16x32_bf16 v[116:119], a[76:79], v[88:91], v[116:119]
    v_exp_f32 v50, v50
    v_mfma_f32_16x16x32_bf16 v[116:119], a[92:95], a[164:167], v[116:119]
    ds_read_b128 a[136:139], v15 offset:8192
    v_cvt_pk_bf16_f32 v88, v48, v49
    v_mfma_f32_16x16x32_bf16 v[116:119], a[108:111], a[168:171], v[116:119]
    v_exp_f32 v51, v51
    v_mfma_f32_16x16x32_bf16 v[116:119], a[124:127], a[172:175], v[116:119]
    v_cvt_pk_bf16_f32 v89, v50, v51
    v_add_f32 v26, v26, v27
    v_mfma_f32_16x16x32_bf16 v[56:59], v[224:227], a[144:147], -4.0
    v_exp_f32 v52, v52
    v_mfma_f32_16x16x32_bf16 v[56:59], v[228:231], a[148:151], v[56:59]
    ds_write_b32 v8, v26 offset:2048
    v_mfma_f32_16x16x32_bf16 v[56:59], v[232:235], a[152:155], v[56:59]
    s_waitcnt lgkmcnt(5)
    v_exp_f32 v53, v53
    v_mfma_f32_16x16x32_bf16 v[56:59], v[236:239], a[156:159], v[56:59]
    ds_read_b128 a[164:167], v4 offset:0
    v_cvt_pk_bf16_f32 v90, v52, v53
    v_mfma_f32_16x16x32_bf16 v[60:63], v[252:255], a[156:159], -4.0
    v_exp_f32 v54, v54
    v_mfma_f32_16x16x32_bf16 v[60:63], v[248:251], a[152:155], v[60:63]
    ds_read_b128 a[140:143], v25 offset:8192
    ds_read_b128 a[168:171], v5 offset:0
    v_mfma_f32_16x16x32_bf16 v[60:63], v[244:247], a[148:151], v[60:63]
    v_exp_f32 v55, v55
    v_mfma_f32_16x16x32_bf16 v[60:63], v[240:243], a[144:147], v[60:63]
    ds_read_b128 a[172:175], v6 offset:0
    v_cvt_pk_bf16_f32 v91, v54, v55
    v_mfma_f32_16x16x32_bf16 v[120:123], a[60:63], a[188:191], v[120:123]
    v_exp_f32 v56, v56
    v_mfma_f32_16x16x32_bf16 v[120:123], a[44:47], a[184:187], v[120:123]
    ds_write_b128 v3, v[88:91] offset:6144
    v_mfma_f32_16x16x32_bf16 v[120:123], a[28:31], a[180:183], v[120:123]
    v_exp_f32 v57, v57
    v_mfma_f32_16x16x32_bf16 v[120:123], a[12:15], v[92:95], v[120:123]
    ds_read_b128 a[144:147], v7 offset:12288
    ds_read_b128 a[148:151], v0 offset:12288
    v_mfma_f32_16x16x32_bf16 v[124:127], a[76:79], v[92:95], v[124:127]
    v_exp_f32 v58, v58
    v_mfma_f32_16x16x32_bf16 v[124:127], a[92:95], a[180:183], v[124:127]
    ds_read_b128 a[152:155], v15 offset:12288
    v_cvt_pk_bf16_f32 v92, v56, v57
    v_mfma_f32_16x16x32_bf16 v[124:127], a[108:111], a[184:187], v[124:127]
    v_exp_f32 v59, v59
    v_mfma_f32_16x16x32_bf16 v[124:127], a[124:127], a[188:191], v[124:127]
    ds_read_b128 a[180:183], v4 offset:1024
    v_cvt_pk_bf16_f32 v93, v58, v59
    v_smfmac_f32_16x16x64_bf16 a[176:179], a[192:195], v[80:87], v24
    s_waitcnt lgkmcnt(5)
    ds_read_b128 a[184:187], v5 offset:1024
    v_mfma_f32_16x16x32_bf16 v[48:51], v[128:131], a[128:131], -4.0
    v_exp_f32 v60, v60
    v_mfma_f32_16x16x32_bf16 v[48:51], v[132:135], a[132:135], v[48:51]
    v_mfma_f32_16x16x32_bf16 v[48:51], v[136:139], a[136:139], v[48:51]
    v_exp_f32 v61, v61
    v_mfma_f32_16x16x32_bf16 v[48:51], v[140:143], a[140:143], v[48:51]
    ds_read_b128 a[156:159], v25 offset:12288
    v_cvt_pk_bf16_f32 v94, v60, v61
    v_mfma_f32_16x16x32_bf16 v[52:55], v[156:159], a[140:143], -4.0
    v_exp_f32 v62, v62
    v_mfma_f32_16x16x32_bf16 v[52:55], v[152:155], a[136:139], v[52:55]
    v_accvgpr_read_b32 v26, a176
    v_accvgpr_read_b32 v27, a177
    v_mfma_f32_16x16x32_bf16 v[52:55], v[148:151], a[132:135], v[52:55]
    v_exp_f32 v63, v63
    v_mfma_f32_16x16x32_bf16 v[52:55], v[144:147], a[128:131], v[52:55]
    ds_read_b128 a[188:191], v6 offset:1024
    v_cvt_pk_bf16_f32 v95, v62, v63
    v_mfma_f32_16x16x32_bf16 v[96:99], a[60:63], a[172:175], v[96:99]
    v_exp_f32 v48, v48
    v_mfma_f32_16x16x32_bf16 v[96:99], a[44:47], a[168:171], v[96:99]
    ds_write_b128 v3, v[92:95] offset:7168
    v_mfma_f32_16x16x32_bf16 v[96:99], a[28:31], a[164:167], v[96:99]
    v_exp_f32 v49, v49
    v_mfma_f32_16x16x32_bf16 v[96:99], a[12:15], v[64:67], v[96:99]
    v_add_f32 v26, v26, v27
    v_mfma_f32_16x16x32_bf16 v[100:103], a[76:79], v[64:67], v[100:103]
    v_exp_f32 v50, v50
    v_mfma_f32_16x16x32_bf16 v[100:103], a[92:95], a[164:167], v[100:103]
    v_cvt_pk_bf16_f32 v64, v48, v49
    v_mfma_f32_16x16x32_bf16 v[100:103], a[108:111], a[168:171], v[100:103]
    v_exp_f32 v51, v51
    v_mfma_f32_16x16x32_bf16 v[100:103], a[124:127], a[172:175], v[100:103]
    s_waitcnt lgkmcnt(1)
    v_cvt_pk_bf16_f32 v65, v50, v51
    v_mfma_f32_16x16x32_bf16 v[56:59], v[128:131], a[144:147], -4.0
    v_exp_f32 v52, v52
    v_mfma_f32_16x16x32_bf16 v[56:59], v[132:135], a[148:151], v[56:59]
    s_waitcnt vmcnt(0)
    ds_inc_u32 v9, v24 offset:5640
    v_mfma_f32_16x16x32_bf16 v[56:59], v[136:139], a[152:155], v[56:59]
    v_exp_f32 v53, v53
    v_mfma_f32_16x16x32_bf16 v[56:59], v[140:143], a[156:159], v[56:59]
    ds_read_b128 a[164:167], v4 offset:2048
    v_cvt_pk_bf16_f32 v66, v52, v53
    ds_write_b32 v8, v26 offset:2560
    v_mfma_f32_16x16x32_bf16 v[60:63], v[156:159], a[156:159], -4.0
    v_exp_f32 v54, v54
    v_mfma_f32_16x16x32_bf16 v[60:63], v[152:155], a[152:155], v[60:63]
    ds_read_b128 a[168:171], v5 offset:2048
    ds_read_b128 v[20:23], v9 offset:1024
    v_mfma_f32_16x16x32_bf16 v[60:63], v[148:151], a[148:151], v[60:63]
    v_exp_f32 v55, v55
    v_mfma_f32_16x16x32_bf16 v[60:63], v[144:147], a[144:147], v[60:63]
    ds_read_b128 a[172:175], v6 offset:2048
    v_cvt_pk_bf16_f32 v67, v54, v55
    v_mfma_f32_16x16x32_bf16 v[104:107], a[60:63], a[188:191], v[104:107]
    v_exp_f32 v56, v56
    v_mfma_f32_16x16x32_bf16 v[104:107], a[44:47], a[184:187], v[104:107]
    ds_write_b128 v3, v[64:67] offset:32768
    v_mfma_f32_16x16x32_bf16 v[104:107], a[28:31], a[180:183], v[104:107]
    v_exp_f32 v57, v57
    v_mfma_f32_16x16x32_bf16 v[104:107], a[12:15], v[68:71], v[104:107]
    v_mfma_f32_16x16x32_bf16 v[108:111], a[76:79], v[68:71], v[108:111]
    v_exp_f32 v58, v58
    v_mfma_f32_16x16x32_bf16 v[108:111], a[92:95], a[180:183], v[108:111]
    ds_read_b32 v11, v9 offset:5640
    v_cvt_pk_bf16_f32 v68, v56, v57
    v_mfma_f32_16x16x32_bf16 v[108:111], a[108:111], a[184:187], v[108:111]
    v_exp_f32 v59, v59
    v_mfma_f32_16x16x32_bf16 v[108:111], a[124:127], a[188:191], v[108:111]
    ds_read_b128 a[180:183], v4 offset:3072
    v_cvt_pk_bf16_f32 v69, v58, v59
    v_smfmac_f32_16x16x64_bf16 a[248:251], a[192:195], v[88:95], v24
    s_waitcnt lgkmcnt(3)
    ds_read_b128 a[184:187], v5 offset:3072
    v_add_f32 v20, v20, v21
    v_mfma_f32_16x16x32_bf16 v[48:51], v[160:163], a[128:131], -4.0
    v_exp_f32 v60, v60
    v_mfma_f32_16x16x32_bf16 v[48:51], v[164:167], a[132:135], v[48:51]
    v_mfma_f32_16x16x32_bf16 v[48:51], v[168:171], a[136:139], v[48:51]
    v_exp_f32 v61, v61
    v_mfma_f32_16x16x32_bf16 v[48:51], v[172:175], a[140:143], v[48:51]
    s_waitcnt lgkmcnt(2)
    v_cvt_pk_bf16_f32 v70, v60, v61
    v_cmp_gt_u32 vcc, 8, v11
    v_mfma_f32_16x16x32_bf16 v[52:55], v[188:191], a[140:143], -4.0
    v_exp_f32 v62, v62
    v_mfma_f32_16x16x32_bf16 v[52:55], v[184:187], a[136:139], v[52:55]
    v_add_f32 v22, v22, v23
    v_add_f32 v20, v20, v22
    v_mfma_f32_16x16x32_bf16 v[52:55], v[180:183], a[132:135], v[52:55]
    v_exp_f32 v63, v63
    v_mfma_f32_16x16x32_bf16 v[52:55], v[176:179], a[128:131], v[52:55]
    s_cbranch_vccnz L_wait10
L_go10:
    ds_read_b128 a[188:191], v6 offset:3072
    v_cvt_pk_bf16_f32 v71, v62, v63
    v_mfma_f32_16x16x32_bf16 v[32:35], a[60:63], a[172:175], v[32:35]
    v_exp_f32 v48, v48
    s_add_u32 m0, s32, 24576
    s_mov_b32 s43, 57344
    buffer_load_dwordx4 v1, s[12:15], s43 offen lds
    v_mfma_f32_16x16x32_bf16 v[32:35], a[44:47], a[168:171], v[32:35]
    ds_write_b128 v3, v[68:71] offset:33792
    v_mfma_f32_16x16x32_bf16 v[32:35], a[28:31], a[164:167], v[32:35]
    v_exp_f32 v49, v49
    s_add_u32 m0, s32, 28672
    s_mov_b32 s43, 61440
    buffer_load_dwordx4 v1, s[12:15], s43 offen lds
    v_mfma_f32_16x16x32_bf16 v[32:35], a[12:15], v[72:75], v[32:35]
    v_rcp_f32 v12, v20
    v_mfma_f32_16x16x32_bf16 v[36:39], a[76:79], v[72:75], v[36:39]
    v_exp_f32 v50, v50
    s_add_u32 m0, s32, 0
    s_mov_b32 s43, 65536
    buffer_load_dwordx4 v1, s[12:15], s43 offen lds
    v_mfma_f32_16x16x32_bf16 v[36:39], a[92:95], a[164:167], v[36:39]
    v_cvt_pk_bf16_f32 v72, v48, v49
    v_accvgpr_read_b32 v26, a248
    v_mfma_f32_16x16x32_bf16 v[36:39], a[108:111], a[168:171], v[36:39]
    v_exp_f32 v51, v51
    s_add_u32 m0, s32, 4096
    s_mov_b32 s43, 69632
    buffer_load_dwordx4 v1, s[12:15], s43 offen lds
    v_mfma_f32_16x16x32_bf16 v[36:39], a[124:127], a[172:175], v[36:39]
    v_cvt_pk_bf16_f32 v73, v50, v51
    v_accvgpr_read_b32 v27, a249
    v_mfma_f32_16x16x32_bf16 v[56:59], v[160:163], a[144:147], -4.0
    v_exp_f32 v52, v52
    v_mfma_f32_16x16x32_bf16 v[56:59], v[164:167], a[148:151], v[56:59]
    v_add_f32 v26, v26, v27
    v_mov_b32 v11, 0
    v_readfirstlane_b32 s56, v20
    v_max_f32 v21, |v112|, |v120|
    v_max_f32 v22, |v113|, |v121|
    v_max_f32 v23, |v114|, |v122|
    v_min3_f32 v21, v21, v22, v23
    v_max_f32 v22, |v115|, |v123|
    v_max_f32 v23, |v116|, |v124|
    v_min3_f32 v21, v21, v22, v23
    v_max_f32 v22, |v117|, |v125|
    v_max_f32 v23, |v118|, |v126|
    s_sub_u32 s57, s56, 0x00800000
    s_add_u32 s58, s56, 0x00800000
    s_sub_u32 s59, s56, 0x02800000
    v_min3_f32 v21, v21, v22, v23
    v_max_f32 v22, |v119|, |v127|
    v_min_f32 v21, v21, v22
    v_cmp_le_u32 s[62:63], s57, v20
    v_cmp_ge_u32 s[56:57], s58, v20
    v_max_f32_dpp v21, v21, v21 row_ror:8 row_mask:0xf bank_mask:0xf
    s_nop 1
    v_max_f32_dpp v21, v21, v21 row_ror:4 row_mask:0xf bank_mask:0xf
    s_nop 1
    v_max_f32_dpp v21, v21, v21 row_ror:2 row_mask:0xf bank_mask:0xf
    s_nop 1
    v_max_f32_dpp v21, v21, v21 row_ror:1 row_mask:0xf bank_mask:0xf
    s_max_i32 s59, s59, s60
    s_and_b64 s[56:57], s[56:57], s[62:63]
    s_cmp_eq_u64 s[56:57], -1
    s_cselect_b32 s60, s59, s60
    s_cselect_b32 s61, -1, 0
    v_readlane_b32 s56, v21, 0
    v_readlane_b32 s57, v21, 16
    v_readlane_b32 s58, v21, 32
    v_readlane_b32 s59, v21, 48
    s_nop 3
    s_min_u32 s56, s56, s57
    s_min_u32 s58, s58, s59
    s_min_u32 s56, s56, s58
    s_min_u32 s56, s56, 0x6c800000
    s_and_b32 s56, s56, 0x7f800000
    s_add_u32 s56, s56, 0x2400000
    s_and_b32 s56, s56, s61
    v_mov_b32 v16, s56
    v_mov_b32 v17, s56
    v_mov_b32 v18, s56
    v_mov_b32 v19, s56
    v_mfma_f32_16x16x32_bf16 v[56:59], v[168:171], a[152:155], v[56:59]
    v_exp_f32 v53, v53
    v_mfma_f32_16x16x32_bf16 v[56:59], v[172:175], a[156:159], v[56:59]
    ds_read_b128 a[164:167], v4 offset:4096
    v_cvt_pk_bf16_f32 v74, v52, v53
    ds_write_b32 v8, v26 offset:3072
    v_mfma_f32_16x16x32_bf16 v[60:63], v[188:191], a[156:159], -4.0
    v_exp_f32 v54, v54
    v_mfma_f32_16x16x32_bf16 v[60:63], v[184:187], a[152:155], v[60:63]
    ds_read_b128 a[168:171], v5 offset:4096
    v_mov_b32 v13, v12
    v_min_f32 v10, v10, v20
    v_mfma_f32_16x16x32_bf16 v[60:63], v[180:183], a[148:151], v[60:63]
    v_exp_f32 v55, v55
    v_mfma_f32_16x16x32_bf16 v[60:63], v[176:179], a[144:147], v[60:63]
    s_waitcnt lgkmcnt(4)
    ds_read_b128 a[172:175], v6 offset:4096
    v_cvt_pk_bf16_f32 v75, v54, v55
    v_mfma_f32_16x16x32_bf16 v[40:43], a[60:63], a[188:191], v[40:43]
    v_exp_f32 v56, v56
    v_mfma_f32_16x16x32_bf16 v[40:43], a[44:47], a[184:187], v[40:43]
    ds_write_b128 v3, v[72:75] offset:34816
    v_mfma_f32_16x16x32_bf16 v[40:43], a[28:31], a[180:183], v[40:43]
    v_exp_f32 v57, v57
    v_mfma_f32_16x16x32_bf16 v[40:43], a[12:15], v[76:79], v[40:43]
    v_permlane32_swap_b32 v12, v13
    v_mul_f32 v112, v112, v12
    v_mfma_f32_16x16x32_bf16 v[44:47], a[76:79], v[76:79], v[44:47]
    v_exp_f32 v58, v58
    v_mfma_f32_16x16x32_bf16 v[44:47], a[92:95], a[180:183], v[44:47]
    v_cvt_pk_bf16_f32 v76, v56, v57
    v_mfma_f32_16x16x32_bf16 v[44:47], a[108:111], a[184:187], v[44:47]
    v_exp_f32 v59, v59
    v_mfma_f32_16x16x32_bf16 v[44:47], a[124:127], a[188:191], v[44:47]
    ds_read_b128 a[180:183], v4 offset:5120
    v_cvt_pk_bf16_f32 v77, v58, v59
    v_smfmac_f32_16x16x64_bf16 v[28:31], a[192:195], v[64:71], v24
    ds_read_b128 a[184:187], v5 offset:5120
    v_mul_f32 v113, v113, v12
    v_mfma_f32_16x16x32_bf16 v[48:51], v[192:195], a[128:131], -4.0
    v_exp_f32 v60, v60
    v_mfma_f32_16x16x32_bf16 v[48:51], v[196:199], a[132:135], v[48:51]
    v_mfma_f32_16x16x32_bf16 v[48:51], v[200:203], a[136:139], v[48:51]
    v_exp_f32 v61, v61
    v_mfma_f32_16x16x32_bf16 v[48:51], v[204:207], a[140:143], v[48:51]
    v_cvt_pk_bf16_f32 v78, v60, v61
    v_mfma_f32_16x16x32_bf16 v[52:55], v[220:223], a[140:143], -4.0
    v_exp_f32 v62, v62
    v_mfma_f32_16x16x32_bf16 v[52:55], v[216:219], a[136:139], v[52:55]
    v_mul_f32 v114, v114, v12
    v_mul_f32 v115, v115, v12
    v_mfma_f32_16x16x32_bf16 v[52:55], v[212:215], a[132:135], v[52:55]
    v_exp_f32 v63, v63
    v_mfma_f32_16x16x32_bf16 v[52:55], v[208:211], a[128:131], v[52:55]
    s_waitcnt lgkmcnt(0)
    ds_read_b128 a[188:191], v6 offset:5120
    v_cvt_pk_bf16_f32 v79, v62, v63
    v_mfma_f32_16x16x32_bf16 a[200:203], a[60:63], a[172:175], a[200:203]
    v_exp_f32 v48, v48
    v_mfma_f32_16x16x32_bf16 a[200:203], a[44:47], a[168:171], a[200:203]
    ds_write_b128 v3, v[76:79] offset:35840
    v_mfma_f32_16x16x32_bf16 a[200:203], a[28:31], a[164:167], a[200:203]
    v_exp_f32 v49, v49
    v_mfma_f32_16x16x32_bf16 a[200:203], a[12:15], v[80:83], a[200:203]
    v_mul_f32 v116, v116, v12
    v_mul_f32 v117, v117, v12
    v_mfma_f32_16x16x32_bf16 a[204:207], a[76:79], v[80:83], a[204:207]
    v_exp_f32 v50, v50
    v_mfma_f32_16x16x32_bf16 a[204:207], a[92:95], a[164:167], a[204:207]
    v_cvt_pk_bf16_f32 v80, v48, v49
    v_mfma_f32_16x16x32_bf16 a[204:207], a[108:111], a[168:171], a[204:207]
    v_exp_f32 v51, v51
    v_mfma_f32_16x16x32_bf16 a[204:207], a[124:127], a[172:175], a[204:207]
    v_cvt_pk_bf16_f32 v81, v50, v51
    v_mfma_f32_16x16x32_bf16 v[56:59], v[192:195], a[144:147], -4.0
    v_exp_f32 v52, v52
    v_mfma_f32_16x16x32_bf16 v[56:59], v[196:199], a[148:151], v[56:59]
    v_mul_f32 v118, v118, v12
    v_mul_f32 v119, v119, v12
    v_mfma_f32_16x16x32_bf16 v[56:59], v[200:203], a[152:155], v[56:59]
    v_exp_f32 v53, v53
    v_mfma_f32_16x16x32_bf16 v[56:59], v[204:207], a[156:159], v[56:59]
    ds_read_b128 a[164:167], v4 offset:6144
    v_cvt_pk_bf16_f32 v82, v52, v53
    v_mfma_f32_16x16x32_bf16 v[60:63], v[220:223], a[156:159], -4.0
    v_exp_f32 v54, v54
    v_mfma_f32_16x16x32_bf16 v[60:63], v[216:219], a[152:155], v[60:63]
    ds_read_b128 a[168:171], v5 offset:6144
    v_cvt_pk_bf16_f32 v112, v112, v113
    v_cvt_pk_bf16_f32 v113, v114, v115
    v_mfma_f32_16x16x32_bf16 v[60:63], v[212:215], a[148:151], v[60:63]
    v_exp_f32 v55, v55
    v_mfma_f32_16x16x32_bf16 v[60:63], v[208:211], a[144:147], v[60:63]
    s_waitcnt lgkmcnt(3)
    ds_read_b128 a[172:175], v6 offset:6144
    v_cvt_pk_bf16_f32 v83, v54, v55
    v_mfma_f32_16x16x32_bf16 a[208:211], a[60:63], a[188:191], a[208:211]
    v_exp_f32 v56, v56
    v_mfma_f32_16x16x32_bf16 a[208:211], a[44:47], a[184:187], a[208:211]
    ds_write_b128 v3, v[80:83] offset:36864
    v_mfma_f32_16x16x32_bf16 a[208:211], a[28:31], a[180:183], a[208:211]
    v_exp_f32 v57, v57
    v_mfma_f32_16x16x32_bf16 a[208:211], a[12:15], v[84:87], a[208:211]
    v_cvt_pk_bf16_f32 v114, v116, v117
    v_cvt_pk_bf16_f32 v115, v118, v119
    v_mfma_f32_16x16x32_bf16 a[212:215], a[76:79], v[84:87], a[212:215]
    v_exp_f32 v58, v58
    v_mfma_f32_16x16x32_bf16 a[212:215], a[92:95], a[180:183], a[212:215]
    v_cvt_pk_bf16_f32 v84, v56, v57
    v_mfma_f32_16x16x32_bf16 a[212:215], a[108:111], a[184:187], a[212:215]
    v_exp_f32 v59, v59
    v_mfma_f32_16x16x32_bf16 a[212:215], a[124:127], a[188:191], a[212:215]
    ds_read_b128 a[180:183], v4 offset:7168
    v_cvt_pk_bf16_f32 v85, v58, v59
    v_smfmac_f32_16x16x64_bf16 v[28:31], a[192:195], v[72:79], v24
    ds_read_b128 a[184:187], v5 offset:7168
    v_mfma_f32_16x16x32_bf16 v[48:51], v[224:227], a[128:131], -4.0
    v_exp_f32 v60, v60
    v_mfma_f32_16x16x32_bf16 v[48:51], v[228:231], a[132:135], v[48:51]
    s_mov_b32 s44, 0
    buffer_store_dwordx4 v[112:115], v2, s[24:27], s44 offen sc1
    v_mfma_f32_16x16x32_bf16 v[48:51], v[232:235], a[136:139], v[48:51]
    v_exp_f32 v61, v61
    v_mfma_f32_16x16x32_bf16 v[48:51], v[236:239], a[140:143], v[48:51]
    v_cvt_pk_bf16_f32 v86, v60, v61
    v_mfma_f32_16x16x32_bf16 v[52:55], v[252:255], a[140:143], -4.0
    v_exp_f32 v62, v62
    v_mfma_f32_16x16x32_bf16 v[52:55], v[248:251], a[136:139], v[52:55]
    v_mul_f32 v120, v120, v13
    v_mul_f32 v121, v121, v13
    v_mfma_f32_16x16x32_bf16 v[52:55], v[244:247], a[132:135], v[52:55]
    v_exp_f32 v63, v63
    v_mfma_f32_16x16x32_bf16 v[52:55], v[240:243], a[128:131], v[52:55]
    s_waitcnt lgkmcnt(0)
    ds_read_b128 a[188:191], v6 offset:7168
    v_cvt_pk_bf16_f32 v87, v62, v63
    v_mfma_f32_16x16x32_bf16 a[216:219], a[60:63], a[172:175], a[216:219]
    v_exp_f32 v48, v48
    v_mfma_f32_16x16x32_bf16 a[216:219], a[44:47], a[168:171], a[216:219]
    ds_write_b128 v3, v[84:87] offset:37888
    v_mfma_f32_16x16x32_bf16 a[216:219], a[28:31], a[164:167], a[216:219]
    v_exp_f32 v49, v49
    v_mfma_f32_16x16x32_bf16 a[216:219], a[12:15], v[88:91], a[216:219]
    v_mul_f32 v122, v122, v13
    v_mul_f32 v123, v123, v13
    v_mfma_f32_16x16x32_bf16 a[220:223], a[76:79], v[88:91], a[220:223]
    v_exp_f32 v50, v50
    v_mfma_f32_16x16x32_bf16 a[220:223], a[92:95], a[164:167], a[220:223]
    v_cvt_pk_bf16_f32 v88, v48, v49
    v_mfma_f32_16x16x32_bf16 a[220:223], a[108:111], a[168:171], a[220:223]
    v_exp_f32 v51, v51
    v_mfma_f32_16x16x32_bf16 a[220:223], a[124:127], a[172:175], a[220:223]
    v_cvt_pk_bf16_f32 v89, v50, v51
    v_mfma_f32_16x16x32_bf16 v[56:59], v[224:227], a[144:147], -4.0
    v_exp_f32 v52, v52
    v_mfma_f32_16x16x32_bf16 v[56:59], v[228:231], a[148:151], v[56:59]
    v_mul_f32 v124, v124, v13
    v_mul_f32 v125, v125, v13
    v_mfma_f32_16x16x32_bf16 v[56:59], v[232:235], a[152:155], v[56:59]
    v_exp_f32 v53, v53
    v_mfma_f32_16x16x32_bf16 v[56:59], v[236:239], a[156:159], v[56:59]
    ds_read_b128 a[128:131], v7 offset:16384
    v_cvt_pk_bf16_f32 v90, v52, v53
    v_mfma_f32_16x16x32_bf16 v[60:63], v[252:255], a[156:159], -4.0
    v_exp_f32 v54, v54
    v_mfma_f32_16x16x32_bf16 v[60:63], v[248:251], a[152:155], v[60:63]
    ds_read_b128 a[132:135], v0 offset:16384
    ds_read_b128 a[136:139], v15 offset:16384
    v_mfma_f32_16x16x32_bf16 v[60:63], v[244:247], a[148:151], v[60:63]
    v_exp_f32 v55, v55
    v_mfma_f32_16x16x32_bf16 v[60:63], v[240:243], a[144:147], v[60:63]
    s_waitcnt lgkmcnt(4)
    ds_read_b128 a[140:143], v25 offset:16384
    v_cvt_pk_bf16_f32 v91, v54, v55
    v_mfma_f32_16x16x32_bf16 a[224:227], a[60:63], a[188:191], a[224:227]
    v_exp_f32 v56, v56
    v_mfma_f32_16x16x32_bf16 a[224:227], a[44:47], a[184:187], a[224:227]
    ds_write_b128 v3, v[88:91] offset:38912
    v_mfma_f32_16x16x32_bf16 a[224:227], a[28:31], a[180:183], a[224:227]
    v_exp_f32 v57, v57
    v_mfma_f32_16x16x32_bf16 a[224:227], a[12:15], v[92:95], a[224:227]
    v_mul_f32 v126, v126, v13
    v_mul_f32 v127, v127, v13
    v_mfma_f32_16x16x32_bf16 a[228:231], a[76:79], v[92:95], a[228:231]
    v_exp_f32 v58, v58
    v_mfma_f32_16x16x32_bf16 a[228:231], a[92:95], a[180:183], a[228:231]
    ds_read_b128 a[144:147], v7 offset:20480
    v_cvt_pk_bf16_f32 v92, v56, v57
    v_mfma_f32_16x16x32_bf16 a[228:231], a[108:111], a[184:187], a[228:231]
    v_exp_f32 v59, v59
    v_mfma_f32_16x16x32_bf16 a[228:231], a[124:127], a[188:191], a[228:231]
    ds_read_b128 a[148:151], v0 offset:20480
    v_cvt_pk_bf16_f32 v93, v58, v59
    v_smfmac_f32_16x16x64_bf16 v[28:31], a[192:195], v[80:87], v24
    s_waitcnt lgkmcnt(3)
    v_cvt_pk_bf16_f32 v120, v120, v121
    v_mfma_f32_16x16x32_bf16 v[48:51], v[128:131], a[128:131], -4.0
    v_exp_f32 v60, v60
    v_mfma_f32_16x16x32_bf16 v[48:51], v[132:135], a[132:135], v[48:51]
    v_cvt_pk_bf16_f32 v121, v122, v123
    v_cvt_pk_bf16_f32 v122, v124, v125
    v_mfma_f32_16x16x32_bf16 v[48:51], v[136:139], a[136:139], v[48:51]
    v_exp_f32 v61, v61
    v_mfma_f32_16x16x32_bf16 v[48:51], v[140:143], a[140:143], v[48:51]
    ds_read_b128 a[152:155], v15 offset:20480
    v_cvt_pk_bf16_f32 v94, v60, v61
    v_mfma_f32_16x16x32_bf16 v[52:55], v[156:159], a[140:143], -4.0
    s_add_u32 m0, s32, 8192
    v_exp_f32 v62, v62
    v_mfma_f32_16x16x32_bf16 v[52:55], v[152:155], a[136:139], v[52:55]
    buffer_load_dwordx4 v1, s[12:15], s30 offen lds
    v_mfma_f32_16x16x32_bf16 v[52:55], v[148:151], a[132:135], v[52:55]
    s_add_u32 s30, s30, 4096
    v_exp_f32 v63, v63
    v_mfma_f32_16x16x32_bf16 v[52:55], v[144:147], a[128:131], v[52:55]
    ds_read_b128 a[156:159], v25 offset:20480
    v_cvt_pk_bf16_f32 v95, v62, v63
    v_mfma_f32_16x16x32_bf16 v[112:115], a[12:15], v[88:91], v[16:19]
    v_exp_f32 v48, v48
    v_mfma_f32_16x16x32_bf16 v[112:115], a[8:11], v[80:83], v[112:115]
    ds_write_b128 v3, v[92:95] offset:39936
    v_mfma_f32_16x16x32_bf16 v[112:115], a[4:7], v[72:75], v[112:115]
    v_exp_f32 v49, v49
    v_mfma_f32_16x16x32_bf16 v[112:115], a[0:3], v[64:67], v[112:115]
    s_waitcnt vmcnt(2)
    ds_inc_u32 v9, v24 offset:4096
    v_mfma_f32_16x16x32_bf16 v[116:119], a[64:67], v[64:67], v[16:19]
    s_add_u32 s46, s46, 8
    v_exp_f32 v50, v50
    v_mfma_f32_16x16x32_bf16 v[116:119], a[68:71], v[72:75], v[116:119]
    v_cvt_pk_bf16_f32 v64, v48, v49
    v_cvt_pk_bf16_f32 v123, v126, v127
    v_mfma_f32_16x16x32_bf16 v[116:119], a[72:75], v[80:83], v[116:119]
    v_exp_f32 v51, v51
    v_mfma_f32_16x16x32_bf16 v[116:119], a[76:79], v[88:91], v[116:119]
    s_waitcnt lgkmcnt(2)
    v_cvt_pk_bf16_f32 v65, v50, v51
    v_mfma_f32_16x16x32_bf16 v[56:59], v[128:131], a[144:147], -4.0
    v_exp_f32 v52, v52
    v_mfma_f32_16x16x32_bf16 v[56:59], v[132:135], a[148:151], v[56:59]
    s_mov_b32 s44, 4096
    buffer_store_dwordx4 v[120:123], v2, s[24:27], s44 offen sc1
    v_mfma_f32_16x16x32_bf16 v[56:59], v[136:139], a[152:155], v[56:59]
    v_exp_f32 v53, v53
    v_mfma_f32_16x16x32_bf16 v[56:59], v[140:143], a[156:159], v[56:59]
    v_cvt_pk_bf16_f32 v66, v52, v53
    v_max_u32 v11, v11, v20
    v_mfma_f32_16x16x32_bf16 v[60:63], v[156:159], a[156:159], -4.0
    v_exp_f32 v54, v54
    v_mfma_f32_16x16x32_bf16 v[60:63], v[152:155], a[152:155], v[60:63]
    ds_read_b32 v14, v9 offset:4096
    ds_read_b128 v[20:23], v9 offset:1536
    v_mfma_f32_16x16x32_bf16 v[60:63], v[148:151], a[148:151], v[60:63]
    v_exp_f32 v55, v55
    v_mfma_f32_16x16x32_bf16 v[60:63], v[144:147], a[144:147], v[60:63]
    ds_read_b128 a[160:163], v4 offset:32768
    v_cvt_pk_bf16_f32 v67, v54, v55
    v_mfma_f32_16x16x32_bf16 v[120:123], a[12:15], v[92:95], v[16:19]
    v_exp_f32 v56, v56
    v_mfma_f32_16x16x32_bf16 v[120:123], a[8:11], v[84:87], v[120:123]
    ds_read_b128 a[164:167], v4 offset:34816
    ds_read_b128 a[168:171], v4 offset:36864
    v_mfma_f32_16x16x32_bf16 v[120:123], a[4:7], v[76:79], v[120:123]
    s_add_u32 m0, s32, 12288
    v_exp_f32 v57, v57
    v_mfma_f32_16x16x32_bf16 v[120:123], a[0:3], v[68:71], v[120:123]
    buffer_load_dwordx4 v1, s[12:15], s30 offen lds
    v_mfma_f32_16x16x32_bf16 v[124:127], a[64:67], v[68:71], v[16:19]
    s_add_u32 s30, s30, 4096
    v_exp_f32 v58, v58
    v_mfma_f32_16x16x32_bf16 v[124:127], a[68:71], v[76:79], v[124:127]
    s_waitcnt lgkmcnt(4)
    v_cvt_pk_bf16_f32 v68, v56, v57
    v_cmp_gt_u32 vcc, s46, v14
    v_mfma_f32_16x16x32_bf16 v[124:127], a[72:75], v[84:87], v[124:127]
    v_exp_f32 v59, v59
    v_mfma_f32_16x16x32_bf16 v[124:127], a[76:79], v[92:95], v[124:127]
    ds_read_b128 a[172:175], v4 offset:38912
    v_cvt_pk_bf16_f32 v69, v58, v59
    v_smfmac_f32_16x16x64_bf16 v[28:31], a[192:195], v[88:95], v24
    s_cbranch_vccnz L_late6
L_back6:
    s_waitcnt lgkmcnt(3)
    v_add_f32 v20, v20, v21
    v_mfma_f32_16x16x32_bf16 v[48:51], v[160:163], a[128:131], -4.0
    v_exp_f32 v60, v60
    v_mfma_f32_16x16x32_bf16 v[48:51], v[164:167], a[132:135], v[48:51]
    ds_write_b128 v3, v[64:67] offset:0
    v_mfma_f32_16x16x32_bf16 v[48:51], v[168:171], a[136:139], v[48:51]
    v_exp_f32 v61, v61
    v_mfma_f32_16x16x32_bf16 v[48:51], v[172:175], a[140:143], v[48:51]
    ds_read_b128 a[176:179], v4 offset:33792
    v_cvt_pk_bf16_f32 v70, v60, v61
    v_mfma_f32_16x16x32_bf16 v[52:55], v[188:191], a[140:143], -4.0
    v_exp_f32 v62, v62
    v_mfma_f32_16x16x32_bf16 v[52:55], v[184:187], a[136:139], v[52:55]
    v_add_f32 v22, v22, v23
    v_add_f32 v20, v20, v22
    v_mfma_f32_16x16x32_bf16 v[52:55], v[180:183], a[132:135], v[52:55]
    v_exp_f32 v63, v63
    v_mfma_f32_16x16x32_bf16 v[52:55], v[176:179], a[128:131], v[52:55]
    ds_read_b128 a[180:183], v4 offset:35840
    v_cvt_pk_bf16_f32 v71, v62, v63
    v_mfma_f32_16x16x32_bf16 v[112:115], a[16:19], a[160:163], v[112:115]
    s_waitcnt lgkmcnt(3)
    v_exp_f32 v48, v48
    v_mfma_f32_16x16x32_bf16 v[112:115], a[20:23], a[164:167], v[112:115]
    ds_write_b128 v3, v[68:71] offset:1024
    v_mfma_f32_16x16x32_bf16 v[112:115], a[24:27], a[168:171], v[112:115]
    v_exp_f32 v49, v49
    v_mfma_f32_16x16x32_bf16 v[112:115], a[28:31], a[172:175], v[112:115]
    v_rcp_f32 v12, v20
    v_mfma_f32_16x16x32_bf16 v[116:119], a[92:95], a[172:175], v[116:119]
    v_exp_f32 v50, v50
    v_mfma_f32_16x16x32_bf16 v[116:119], a[88:91], a[168:171], v[116:119]
    ds_read_b128 a[184:187], v4 offset:37888
    v_cvt_pk_bf16_f32 v72, v48, v49
    v_mfma_f32_16x16x32_bf16 v[116:119], a[84:87], a[164:167], v[116:119]
    v_exp_f32 v51, v51
    v_mfma_f32_16x16x32_bf16 v[116:119], a[80:83], a[160:163], v[116:119]
    ds_read_b128 a[188:191], v4 offset:39936
    v_cvt_pk_bf16_f32 v73, v50, v51
    v_mfma_f32_16x16x32_bf16 v[56:59], v[160:163], a[144:147], -4.0
    v_exp_f32 v52, v52
    v_mfma_f32_16x16x32_bf16 v[56:59], v[164:167], a[148:151], v[56:59]
    v_add_f32 v14, v28, v29
    v_mov_b64 v[28:29], 0
    v_mfma_f32_16x16x32_bf16 v[56:59], v[168:171], a[152:155], v[56:59]
    v_exp_f32 v53, v53
    v_mfma_f32_16x16x32_bf16 v[56:59], v[172:175], a[156:159], v[56:59]
    ds_read_b128 a[160:163], v5 offset:32768
    v_cvt_pk_bf16_f32 v74, v52, v53
    v_mfma_f32_16x16x32_bf16 v[60:63], v[188:191], a[156:159], -4.0
    v_exp_f32 v54, v54
    v_mfma_f32_16x16x32_bf16 v[60:63], v[184:187], a[152:155], v[60:63]
    v_mov_b32 v13, v12
    v_min_f32 v10, v10, v20
    v_mfma_f32_16x16x32_bf16 v[60:63], v[180:183], a[148:151], v[60:63]
    v_exp_f32 v55, v55
    v_mfma_f32_16x16x32_bf16 v[60:63], v[176:179], a[144:147], v[60:63]
    s_waitcnt lgkmcnt(1)
    ds_read_b128 a[164:167], v5 offset:34816
    ds_read_b128 v[88:91], v9 offset:2560
    v_cvt_pk_bf16_f32 v75, v54, v55
    v_mfma_f32_16x16x32_bf16 v[120:123], a[16:19], a[176:179], v[120:123]
    v_exp_f32 v56, v56
    v_mfma_f32_16x16x32_bf16 v[120:123], a[20:23], a[180:183], v[120:123]
    ds_write_b128 v3, v[72:75] offset:2048
    v_mfma_f32_16x16x32_bf16 v[120:123], a[24:27], a[184:187], v[120:123]
    v_exp_f32 v57, v57
    v_mfma_f32_16x16x32_bf16 v[120:123], a[28:31], a[188:191], v[120:123]
    v_permlane32_swap_b32 v12, v13
    v_mul_f32 v96, v96, v12
    v_mfma_f32_16x16x32_bf16 v[124:127], a[92:95], a[188:191], v[124:127]
    v_exp_f32 v58, v58
    v_mfma_f32_16x16x32_bf16 v[124:127], a[88:91], a[184:187], v[124:127]
    ds_read_b128 a[168:171], v5 offset:36864
    v_cvt_pk_bf16_f32 v76, v56, v57
    v_mfma_f32_16x16x32_bf16 v[124:127], a[84:87], a[180:183], v[124:127]
    v_exp_f32 v59, v59
    v_mfma_f32_16x16x32_bf16 v[124:127], a[80:83], a[176:179], v[124:127]
    ds_read_b128 a[172:175], v5 offset:38912
    v_cvt_pk_bf16_f32 v77, v58, v59
    v_smfmac_f32_16x16x64_bf16 v[28:31], a[192:195], v[64:71], v24
    v_mul_f32 v97, v97, v12
    v_mfma_f32_16x16x32_bf16 v[48:51], v[192:195], a[128:131], -4.0
    v_exp_f32 v60, v60
    v_mfma_f32_16x16x32_bf16 v[48:51], v[196:199], a[132:135], v[48:51]
    ds_write_b32 v8, v14 offset:512
    s_waitcnt lgkmcnt(4)
    v_add_f32 v88, v88, v89
    v_add_f32 v90, v90, v91
    v_add_f32 v88, v88, v90
    v_rcp_f32 v26, v88
    s_nop 0
    v_mov_b32 v27, v26
    s_nop 1
    v_permlane32_swap_b32 v26, v27
    v_min_f32 v10, v10, v88
    v_max_u32 v11, v11, v88
    v_mfma_f32_16x16x32_bf16 v[48:51], v[200:203], a[136:139], v[48:51]
    v_exp_f32 v61, v61
    v_mfma_f32_16x16x32_bf16 v[48:51], v[204:207], a[140:143], v[48:51]
    ds_read_b128 a[176:179], v5 offset:33792
    v_cvt_pk_bf16_f32 v78, v60, v61
    v_mfma_f32_16x16x32_bf16 v[52:55], v[220:223], a[140:143], -4.0
    v_exp_f32 v62, v62
    v_mfma_f32_16x16x32_bf16 v[52:55], v[216:219], a[136:139], v[52:55]
    v_mul_f32 v98, v98, v12
    v_mul_f32 v99, v99, v12
    v_mfma_f32_16x16x32_bf16 v[52:55], v[212:215], a[132:135], v[52:55]
    v_exp_f32 v63, v63
    v_mfma_f32_16x16x32_bf16 v[52:55], v[208:211], a[128:131], v[52:55]
    ds_read_b128 a[180:183], v5 offset:35840
    v_cvt_pk_bf16_f32 v79, v62, v63
    v_mfma_f32_16x16x32_bf16 v[112:115], a[32:35], a[160:163], v[112:115]
    v_exp_f32 v48, v48
    v_mfma_f32_16x16x32_bf16 v[112:115], a[36:39], a[164:167], v[112:115]
    s_waitcnt lgkmcnt(3)
    ds_write_b128 v3, v[76:79] offset:3072
    v_accvgpr_read_b32 v88, a200
    v_accvgpr_read_b32 v89, a201
    v_accvgpr_read_b32 v90, a202
    v_accvgpr_read_b32 v91, a203
    v_accvgpr_read_b32 v92, a204
    v_accvgpr_read_b32 v93, a205
    v_accvgpr_read_b32 v94, a206
    v_accvgpr_read_b32 v95, a207
    v_pk_mul_f32 v[88:89], v[88:89], v[26:27] op_sel:[0,0] op_sel_hi:[1,0]
    v_pk_mul_f32 v[90:91], v[90:91], v[26:27] op_sel:[0,0] op_sel_hi:[1,0]
    v_pk_mul_f32 v[92:93], v[92:93], v[26:27] op_sel:[0,0] op_sel_hi:[1,0]
    v_pk_mul_f32 v[94:95], v[94:95], v[26:27] op_sel:[0,0] op_sel_hi:[1,0]
    v_cvt_pk_bf16_f32 v88, v88, v89
    v_cvt_pk_bf16_f32 v89, v90, v91
    v_cvt_pk_bf16_f32 v90, v92, v93
    v_cvt_pk_bf16_f32 v91, v94, v95
    s_mov_b32 s45, 24576
    v_mfma_f32_16x16x32_bf16 v[112:115], a[40:43], a[168:171], v[112:115]
    buffer_store_dwordx4 v[88:91], v2, s[24:27], s45 offen sc1
    v_exp_f32 v49, v49
    v_mfma_f32_16x16x32_bf16 v[112:115], a[44:47], a[172:175], v[112:115]
    v_mul_f32 v100, v100, v12
    v_mul_f32 v101, v101, v12
    v_mfma_f32_16x16x32_bf16 v[116:119], a[108:111], a[172:175], v[116:119]
    v_exp_f32 v50, v50
    v_mfma_f32_16x16x32_bf16 v[116:119], a[104:107], a[168:171], v[116:119]
    ds_read_b128 a[184:187], v5 offset:37888
    v_cvt_pk_bf16_f32 v80, v48, v49
    v_mfma_f32_16x16x32_bf16 v[116:119], a[100:103], a[164:167], v[116:119]
    v_exp_f32 v51, v51
    v_mfma_f32_16x16x32_bf16 v[116:119], a[96:99], a[160:163], v[116:119]
    ds_read_b128 a[188:191], v5 offset:39936
    v_cvt_pk_bf16_f32 v81, v50, v51
    v_mfma_f32_16x16x32_bf16 v[56:59], v[192:195], a[144:147], -4.0
    v_exp_f32 v52, v52
    v_mfma_f32_16x16x32_bf16 v[56:59], v[196:199], a[148:151], v[56:59]
    v_mul_f32 v102, v102, v12
    v_mul_f32 v103, v103, v12
    v_mfma_f32_16x16x32_bf16 v[56:59], v[200:203], a[152:155], v[56:59]
    v_exp_f32 v53, v53
    v_mfma_f32_16x16x32_bf16 v[56:59], v[204:207], a[156:159], v[56:59]
    ds_read_b128 a[160:163], v6 offset:32768
    v_cvt_pk_bf16_f32 v82, v52, v53
    v_mfma_f32_16x16x32_bf16 v[60:63], v[220:223], a[156:159], -4.0
    v_exp_f32 v54, v54
    v_mfma_f32_16x16x32_bf16 v[60:63], v[216:219], a[152:155], v[60:63]
    v_cvt_pk_bf16_f32 v96, v96, v97
    v_cvt_pk_bf16_f32 v97, v98, v99
    v_mfma_f32_16x16x32_bf16 v[60:63], v[212:215], a[148:151], v[60:63]
    v_exp_f32 v55, v55
    v_mfma_f32_16x16x32_bf16 v[60:63], v[208:211], a[144:147], v[60:63]
    s_waitcnt lgkmcnt(1)
    ds_read_b128 a[164:167], v6 offset:34816
    v_cvt_pk_bf16_f32 v83, v54, v55
    v_mfma_f32_16x16x32_bf16 v[120:123], a[32:35], a[176:179], v[120:123]
    v_exp_f32 v56, v56
    v_mfma_f32_16x16x32_bf16 v[120:123], a[36:39], a[180:183], v[120:123]
    ds_write_b128 v3, v[80:83] offset:4096
    v_accvgpr_read_b32 v88, a208
    v_accvgpr_read_b32 v89, a209
    v_accvgpr_read_b32 v90, a210
    v_accvgpr_read_b32 v91, a211
    v_accvgpr_read_b32 v92, a212
    v_accvgpr_read_b32 v93, a213
    v_accvgpr_read_b32 v94, a214
    v_accvgpr_read_b32 v95, a215
    v_pk_mul_f32 v[88:89], v[88:89], v[26:27] op_sel:[0,1] op_sel_hi:[1,1]
    v_pk_mul_f32 v[90:91], v[90:91], v[26:27] op_sel:[0,1] op_sel_hi:[1,1]
    v_pk_mul_f32 v[92:93], v[92:93], v[26:27] op_sel:[0,1] op_sel_hi:[1,1]
    v_pk_mul_f32 v[94:95], v[94:95], v[26:27] op_sel:[0,1] op_sel_hi:[1,1]
    v_cvt_pk_bf16_f32 v88, v88, v89
    v_cvt_pk_bf16_f32 v89, v90, v91
    v_cvt_pk_bf16_f32 v90, v92, v93
    v_cvt_pk_bf16_f32 v91, v94, v95
    s_mov_b32 s45, 28672
    v_mfma_f32_16x16x32_bf16 v[120:123], a[40:43], a[184:187], v[120:123]
    buffer_store_dwordx4 v[88:91], v2, s[24:27], s45 offen sc1
    v_exp_f32 v57, v57
    v_mfma_f32_16x16x32_bf16 v[120:123], a[44:47], a[188:191], v[120:123]
    v_cvt_pk_bf16_f32 v98, v100, v101
    v_cvt_pk_bf16_f32 v99, v102, v103
    v_mfma_f32_16x16x32_bf16 v[124:127], a[108:111], a[188:191], v[124:127]
    v_exp_f32 v58, v58
    v_mfma_f32_16x16x32_bf16 v[124:127], a[104:107], a[184:187], v[124:127]
    ds_read_b128 a[168:171], v6 offset:36864
    v_cvt_pk_bf16_f32 v84, v56, v57
    v_mfma_f32_16x16x32_bf16 v[124:127], a[100:103], a[180:183], v[124:127]
    v_exp_f32 v59, v59
    v_mfma_f32_16x16x32_bf16 v[124:127], a[96:99], a[176:179], v[124:127]
    ds_read_b128 a[172:175], v6 offset:38912
    v_cvt_pk_bf16_f32 v85, v58, v59
    v_smfmac_f32_16x16x64_bf16 v[28:31], a[192:195], v[72:79], v24
    v_mfma_f32_16x16x32_bf16 v[48:51], v[224:227], a[128:131], -4.0
    v_exp_f32 v60, v60
    v_mfma_f32_16x16x32_bf16 v[48:51], v[228:231], a[132:135], v[48:51]
    s_mov_b32 s44, 8192
    buffer_store_dwordx4 v[96:99], v2, s[24:27], s44 offen sc1
    v_mfma_f32_16x16x32_bf16 v[48:51], v[232:235], a[136:139], v[48:51]
    v_exp_f32 v61, v61
    v_mfma_f32_16x16x32_bf16 v[48:51], v[236:239], a[140:143], v[48:51]
    ds_read_b128 a[176:179], v6 offset:33792
    v_cvt_pk_bf16_f32 v86, v60, v61
    v_mfma_f32_16x16x32_bf16 v[52:55], v[252:255], a[140:143], -4.0
    v_exp_f32 v62, v62
    v_mfma_f32_16x16x32_bf16 v[52:55], v[248:251], a[136:139], v[52:55]
    v_mul_f32 v104, v104, v13
    v_mul_f32 v105, v105, v13
    v_mfma_f32_16x16x32_bf16 v[52:55], v[244:247], a[132:135], v[52:55]
    v_exp_f32 v63, v63
    v_mfma_f32_16x16x32_bf16 v[52:55], v[240:243], a[128:131], v[52:55]
    s_waitcnt lgkmcnt(1)
    ds_read_b128 a[180:183], v6 offset:35840
    v_cvt_pk_bf16_f32 v87, v62, v63
    v_mfma_f32_16x16x32_bf16 v[112:115], a[48:51], a[160:163], v[112:115]
    v_exp_f32 v48, v48
    v_mfma_f32_16x16x32_bf16 v[112:115], a[52:55], a[164:167], v[112:115]
    ds_write_b128 v3, v[84:87] offset:5120
    v_mfma_f32_16x16x32_bf16 v[112:115], a[56:59], a[168:171], v[112:115]
    v_exp_f32 v49, v49
    v_mfma_f32_16x16x32_bf16 v[112:115], a[60:63], a[172:175], v[112:115]
    v_mul_f32 v106, v106, v13
    v_mul_f32 v107, v107, v13
    v_mfma_f32_16x16x32_bf16 v[116:119], a[124:127], a[172:175], v[116:119]
    v_exp_f32 v50, v50
    v_mfma_f32_16x16x32_bf16 v[116:119], a[120:123], a[168:171], v[116:119]
    ds_read_b128 a[184:187], v6 offset:37888
    v_cvt_pk_bf16_f32 v88, v48, v49
    v_mfma_f32_16x16x32_bf16 v[116:119], a[116:119], a[164:167], v[116:119]
    v_exp_f32 v51, v51
    v_mfma_f32_16x16x32_bf16 v[116:119], a[112:115], a[160:163], v[116:119]
    ds_read_b128 a[188:191], v6 offset:39936
    v_cvt_pk_bf16_f32 v89, v50, v51
    v_mfma_f32_16x16x32_bf16 v[56:59], v[224:227], a[144:147], -4.0
    v_exp_f32 v52, v52
    v_mfma_f32_16x16x32_bf16 v[56:59], v[228:231], a[148:151], v[56:59]
    v_mul_f32 v108, v108, v13
    v_mul_f32 v109, v109, v13
    v_mfma_f32_16x16x32_bf16 v[56:59], v[232:235], a[152:155], v[56:59]
    v_exp_f32 v53, v53
    v_mfma_f32_16x16x32_bf16 v[56:59], v[236:239], a[156:159], v[56:59]
    ds_read_b128 a[128:131], v7 offset:24576
    v_cvt_pk_bf16_f32 v90, v52, v53
    v_mfma_f32_16x16x32_bf16 v[60:63], v[252:255], a[156:159], -4.0
    v_exp_f32 v54, v54
    v_mfma_f32_16x16x32_bf16 v[60:63], v[248:251], a[152:155], v[60:63]
    ds_read_b128 a[132:135], v0 offset:24576
    ds_read_b128 a[136:139], v15 offset:24576
    v_mfma_f32_16x16x32_bf16 v[60:63], v[244:247], a[148:151], v[60:63]
    v_exp_f32 v55, v55
    v_mfma_f32_16x16x32_bf16 v[60:63], v[240:243], a[144:147], v[60:63]
    s_waitcnt lgkmcnt(3)
    ds_read_b128 a[140:143], v25 offset:24576
    v_cvt_pk_bf16_f32 v91, v54, v55
    v_mfma_f32_16x16x32_bf16 v[120:123], a[48:51], a[176:179], v[120:123]
    v_exp_f32 v56, v56
    v_mfma_f32_16x16x32_bf16 v[120:123], a[52:55], a[180:183], v[120:123]
    ds_write_b128 v3, v[88:91] offset:6144
    v_mfma_f32_16x16x32_bf16 v[120:123], a[56:59], a[184:187], v[120:123]
    v_exp_f32 v57, v57
    v_mfma_f32_16x16x32_bf16 v[120:123], a[60:63], a[188:191], v[120:123]
    v_mul_f32 v110, v110, v13
    v_mul_f32 v111, v111, v13
    v_mfma_f32_16x16x32_bf16 v[124:127], a[124:127], a[188:191], v[124:127]
    v_exp_f32 v58, v58
    v_mfma_f32_16x16x32_bf16 v[124:127], a[120:123], a[184:187], v[124:127]
    ds_read_b128 a[144:147], v7 offset:28672
    v_cvt_pk_bf16_f32 v92, v56, v57
    v_mfma_f32_16x16x32_bf16 v[124:127], a[116:119], a[180:183], v[124:127]
    v_exp_f32 v59, v59
    v_mfma_f32_16x16x32_bf16 v[124:127], a[112:115], a[176:179], v[124:127]
    ds_read_b128 a[148:151], v0 offset:28672
    v_cvt_pk_bf16_f32 v93, v58, v59
    v_smfmac_f32_16x16x64_bf16 v[28:31], a[192:195], v[80:87], v24
    s_waitcnt lgkmcnt(3)
    v_cvt_pk_bf16_f32 v104, v104, v105
    v_mfma_f32_16x16x32_bf16 v[48:51], v[128:131], a[128:131], -4.0
    v_exp_f32 v60, v60
    v_mfma_f32_16x16x32_bf16 v[48:51], v[132:135], a[132:135], v[48:51]
    v_cvt_pk_bf16_f32 v105, v106, v107
    v_cvt_pk_bf16_f32 v106, v108, v109
    v_mfma_f32_16x16x32_bf16 v[48:51], v[136:139], a[136:139], v[48:51]
    v_exp_f32 v61, v61
    v_mfma_f32_16x16x32_bf16 v[48:51], v[140:143], a[140:143], v[48:51]
    ds_read_b128 a[152:155], v15 offset:28672
    v_cvt_pk_bf16_f32 v94, v60, v61
    v_mfma_f32_16x16x32_bf16 v[52:55], v[156:159], a[140:143], -4.0
    s_add_u32 m0, s32, 16384
    v_exp_f32 v62, v62
    v_mfma_f32_16x16x32_bf16 v[52:55], v[152:155], a[136:139], v[52:55]
    buffer_load_dwordx4 v1, s[12:15], s30 offen lds
    v_mfma_f32_16x16x32_bf16 v[52:55], v[148:151], a[132:135], v[52:55]
    s_add_u32 s30, s30, 4096
    v_exp_f32 v63, v63
    v_mfma_f32_16x16x32_bf16 v[52:55], v[144:147], a[128:131], v[52:55]
    ds_read_b128 a[156:159], v25 offset:28672
    v_cvt_pk_bf16_f32 v95, v62, v63
    v_mfma_f32_16x16x32_bf16 v[96:99], a[12:15], v[88:91], v[16:19]
    v_exp_f32 v48, v48
    v_mfma_f32_16x16x32_bf16 v[96:99], a[8:11], v[80:83], v[96:99]
    ds_write_b128 v3, v[92:95] offset:7168
    v_mfma_f32_16x16x32_bf16 v[96:99], a[4:7], v[72:75], v[96:99]
    v_exp_f32 v49, v49
    v_mfma_f32_16x16x32_bf16 v[96:99], a[0:3], v[64:67], v[96:99]
    ds_inc_u32 v9, v24 offset:4096
    v_mfma_f32_16x16x32_bf16 v[100:103], a[64:67], v[64:67], v[16:19]
    s_add_u32 s46, s46, 8
    v_exp_f32 v50, v50
    v_mfma_f32_16x16x32_bf16 v[100:103], a[68:71], v[72:75], v[100:103]
    v_cvt_pk_bf16_f32 v64, v48, v49
    v_cvt_pk_bf16_f32 v107, v110, v111
    v_mfma_f32_16x16x32_bf16 v[100:103], a[72:75], v[80:83], v[100:103]
    v_exp_f32 v51, v51
    v_mfma_f32_16x16x32_bf16 v[100:103], a[76:79], v[88:91], v[100:103]
    s_waitcnt lgkmcnt(2)
    v_cvt_pk_bf16_f32 v65, v50, v51
    v_mfma_f32_16x16x32_bf16 v[56:59], v[128:131], a[144:147], -4.0
    v_exp_f32 v52, v52
    v_mfma_f32_16x16x32_bf16 v[56:59], v[132:135], a[148:151], v[56:59]
    s_mov_b32 s44, 12288
    buffer_store_dwordx4 v[104:107], v2, s[24:27], s44 offen sc1
    v_mfma_f32_16x16x32_bf16 v[56:59], v[136:139], a[152:155], v[56:59]
    v_exp_f32 v53, v53
    v_mfma_f32_16x16x32_bf16 v[56:59], v[140:143], a[156:159], v[56:59]
    v_cvt_pk_bf16_f32 v66, v52, v53
    v_max_u32 v11, v11, v20
    v_mfma_f32_16x16x32_bf16 v[60:63], v[156:159], a[156:159], -4.0
    v_exp_f32 v54, v54
    v_mfma_f32_16x16x32_bf16 v[60:63], v[152:155], a[152:155], v[60:63]
    ds_read_b32 v14, v9 offset:4096
    ds_read_b128 v[20:23], v9 offset:512
    v_mfma_f32_16x16x32_bf16 v[60:63], v[148:151], a[148:151], v[60:63]
    v_exp_f32 v55, v55
    v_mfma_f32_16x16x32_bf16 v[60:63], v[144:147], a[144:147], v[60:63]
    ds_read_b128 a[160:163], v4 offset:0
    v_cvt_pk_bf16_f32 v67, v54, v55
    v_mfma_f32_16x16x32_bf16 v[104:107], a[12:15], v[92:95], v[16:19]
    v_exp_f32 v56, v56
    v_mfma_f32_16x16x32_bf16 v[104:107], a[8:11], v[84:87], v[104:107]
    ds_read_b128 a[164:167], v4 offset:2048
    ds_read_b128 a[168:171], v4 offset:4096
    v_mfma_f32_16x16x32_bf16 v[104:107], a[4:7], v[76:79], v[104:107]
    s_add_u32 m0, s32, 20480
    v_exp_f32 v57, v57
    v_mfma_f32_16x16x32_bf16 v[104:107], a[0:3], v[68:71], v[104:107]
    buffer_load_dwordx4 v1, s[12:15], s30 offen lds
    v_mfma_f32_16x16x32_bf16 v[108:111], a[64:67], v[68:71], v[16:19]
    s_add_u32 s30, s30, 4096
    v_exp_f32 v58, v58
    v_mfma_f32_16x16x32_bf16 v[108:111], a[68:71], v[76:79], v[108:111]
    s_waitcnt lgkmcnt(4)
    v_cvt_pk_bf16_f32 v68, v56, v57
    v_cmp_gt_u32 vcc, s46, v14
    v_mfma_f32_16x16x32_bf16 v[108:111], a[72:75], v[84:87], v[108:111]
    v_exp_f32 v59, v59
    v_mfma_f32_16x16x32_bf16 v[108:111], a[76:79], v[92:95], v[108:111]
    ds_read_b128 a[172:175], v4 offset:6144
    v_cvt_pk_bf16_f32 v69, v58, v59
    v_smfmac_f32_16x16x64_bf16 v[28:31], a[192:195], v[88:95], v24
    s_cbranch_vccnz L_late7
L_back7:
    s_waitcnt lgkmcnt(3)
    v_add_f32 v20, v20, v21
    v_mfma_f32_16x16x32_bf16 v[48:51], v[160:163], a[128:131], -4.0
    v_exp_f32 v60, v60
    v_mfma_f32_16x16x32_bf16 v[48:51], v[164:167], a[132:135], v[48:51]
    ds_write_b128 v3, v[64:67] offset:32768
    v_mfma_f32_16x16x32_bf16 v[48:51], v[168:171], a[136:139], v[48:51]
    v_exp_f32 v61, v61
    v_mfma_f32_16x16x32_bf16 v[48:51], v[172:175], a[140:143], v[48:51]
    ds_read_b128 a[176:179], v4 offset:1024
    v_cvt_pk_bf16_f32 v70, v60, v61
    v_mfma_f32_16x16x32_bf16 v[52:55], v[188:191], a[140:143], -4.0
    v_exp_f32 v62, v62
    v_mfma_f32_16x16x32_bf16 v[52:55], v[184:187], a[136:139], v[52:55]
    v_add_f32 v22, v22, v23
    v_add_f32 v20, v20, v22
    v_mfma_f32_16x16x32_bf16 v[52:55], v[180:183], a[132:135], v[52:55]
    v_exp_f32 v63, v63
    v_mfma_f32_16x16x32_bf16 v[52:55], v[176:179], a[128:131], v[52:55]
    ds_read_b128 a[180:183], v4 offset:3072
    v_cvt_pk_bf16_f32 v71, v62, v63
    v_mfma_f32_16x16x32_bf16 v[96:99], a[16:19], a[160:163], v[96:99]
    s_waitcnt lgkmcnt(3)
    v_exp_f32 v48, v48
    v_mfma_f32_16x16x32_bf16 v[96:99], a[20:23], a[164:167], v[96:99]
    ds_write_b128 v3, v[68:71] offset:33792
    v_mfma_f32_16x16x32_bf16 v[96:99], a[24:27], a[168:171], v[96:99]
    v_exp_f32 v49, v49
    v_mfma_f32_16x16x32_bf16 v[96:99], a[28:31], a[172:175], v[96:99]
    v_rcp_f32 v12, v20
    v_mfma_f32_16x16x32_bf16 v[100:103], a[92:95], a[172:175], v[100:103]
    v_exp_f32 v50, v50
    v_mfma_f32_16x16x32_bf16 v[100:103], a[88:91], a[168:171], v[100:103]
    ds_read_b128 a[184:187], v4 offset:5120
    v_cvt_pk_bf16_f32 v72, v48, v49
    v_mfma_f32_16x16x32_bf16 v[100:103], a[84:87], a[164:167], v[100:103]
    v_exp_f32 v51, v51
    v_mfma_f32_16x16x32_bf16 v[100:103], a[80:83], a[160:163], v[100:103]
    ds_read_b128 a[188:191], v4 offset:7168
    v_cvt_pk_bf16_f32 v73, v50, v51
    v_mfma_f32_16x16x32_bf16 v[56:59], v[160:163], a[144:147], -4.0
    v_exp_f32 v52, v52
    v_mfma_f32_16x16x32_bf16 v[56:59], v[164:167], a[148:151], v[56:59]
    v_add_f32 v14, v28, v29
    v_mov_b64 v[28:29], 0
    v_mfma_f32_16x16x32_bf16 v[56:59], v[168:171], a[152:155], v[56:59]
    v_exp_f32 v53, v53
    v_mfma_f32_16x16x32_bf16 v[56:59], v[172:175], a[156:159], v[56:59]
    ds_read_b128 a[160:163], v5 offset:0
    v_cvt_pk_bf16_f32 v74, v52, v53
    v_mfma_f32_16x16x32_bf16 v[60:63], v[188:191], a[156:159], -4.0
    v_exp_f32 v54, v54
    v_mfma_f32_16x16x32_bf16 v[60:63], v[184:187], a[152:155], v[60:63]
    v_mov_b32 v13, v12
    v_min_f32 v10, v10, v20
    v_mfma_f32_16x16x32_bf16 v[60:63], v[180:183], a[148:151], v[60:63]
    v_exp_f32 v55, v55
    v_mfma_f32_16x16x32_bf16 v[60:63], v[176:179], a[144:147], v[60:63]
    s_waitcnt lgkmcnt(1)
    ds_read_b128 a[164:167], v5 offset:2048
    v_cvt_pk_bf16_f32 v75, v54, v55
    v_mfma_f32_16x16x32_bf16 v[104:107], a[16:19], a[176:179], v[104:107]
    v_exp_f32 v56, v56
    v_mfma_f32_16x16x32_bf16 v[104:107], a[20:23], a[180:183], v[104:107]
    ds_write_b128 v3, v[72:75] offset:34816
    v_mfma_f32_16x16x32_bf16 v[104:107], a[24:27], a[184:187], v[104:107]
    v_exp_f32 v57, v57
    v_mfma_f32_16x16x32_bf16 v[104:107], a[28:31], a[188:191], v[104:107]
    v_permlane32_swap_b32 v12, v13
    v_mul_f32 v21, -v16, v12
    v_mfma_f32_16x16x32_bf16 v[108:111], a[92:95], a[188:191], v[108:111]
    v_exp_f32 v58, v58
    v_mfma_f32_16x16x32_bf16 v[108:111], a[88:91], a[184:187], v[108:111]
    ds_read_b128 a[168:171], v5 offset:4096
    v_cvt_pk_bf16_f32 v76, v56, v57
    v_mfma_f32_16x16x32_bf16 v[108:111], a[84:87], a[180:183], v[108:111]
    v_exp_f32 v59, v59
    v_mfma_f32_16x16x32_bf16 v[108:111], a[80:83], a[176:179], v[108:111]
    ds_read_b128 a[172:175], v5 offset:6144
    v_cvt_pk_bf16_f32 v77, v58, v59
    v_smfmac_f32_16x16x64_bf16 v[28:31], a[192:195], v[64:71], v24
    v_fma_f32 v112, v112, v12, v21
    v_mfma_f32_16x16x32_bf16 v[48:51], v[192:195], a[128:131], -4.0
    v_exp_f32 v60, v60
    v_mfma_f32_16x16x32_bf16 v[48:51], v[196:199], a[132:135], v[48:51]
    ds_write_b32 v8, v14 offset:0
    v_mfma_f32_16x16x32_bf16 v[48:51], v[200:203], a[136:139], v[48:51]
    v_exp_f32 v61, v61
    v_mfma_f32_16x16x32_bf16 v[48:51], v[204:207], a[140:143], v[48:51]
    ds_read_b128 a[176:179], v5 offset:1024
    v_cvt_pk_bf16_f32 v78, v60, v61
    v_mfma_f32_16x16x32_bf16 v[52:55], v[220:223], a[140:143], -4.0
    v_exp_f32 v62, v62
    v_mfma_f32_16x16x32_bf16 v[52:55], v[216:219], a[136:139], v[52:55]
    v_fma_f32 v113, v113, v12, v21
    v_fma_f32 v114, v114, v12, v21
    v_mfma_f32_16x16x32_bf16 v[52:55], v[212:215], a[132:135], v[52:55]
    v_exp_f32 v63, v63
    v_mfma_f32_16x16x32_bf16 v[52:55], v[208:211], a[128:131], v[52:55]
    s_waitcnt lgkmcnt(2)
    ds_read_b128 a[180:183], v5 offset:3072
    v_cvt_pk_bf16_f32 v79, v62, v63
    v_mfma_f32_16x16x32_bf16 v[96:99], a[32:35], a[160:163], v[96:99]
    v_exp_f32 v48, v48
    v_mfma_f32_16x16x32_bf16 v[96:99], a[36:39], a[164:167], v[96:99]
    ds_write_b128 v3, v[76:79] offset:35840
    v_mfma_f32_16x16x32_bf16 v[96:99], a[40:43], a[168:171], v[96:99]
    v_exp_f32 v49, v49
    v_mfma_f32_16x16x32_bf16 v[96:99], a[44:47], a[172:175], v[96:99]
    v_fma_f32 v115, v115, v12, v21
    v_fma_f32 v116, v116, v12, v21
    v_mfma_f32_16x16x32_bf16 v[100:103], a[108:111], a[172:175], v[100:103]
    v_exp_f32 v50, v50
    v_mfma_f32_16x16x32_bf16 v[100:103], a[104:107], a[168:171], v[100:103]
    ds_read_b128 a[184:187], v5 offset:5120
    v_cvt_pk_bf16_f32 v80, v48, v49
    v_mfma_f32_16x16x32_bf16 v[100:103], a[100:103], a[164:167], v[100:103]
    v_exp_f32 v51, v51
    v_mfma_f32_16x16x32_bf16 v[100:103], a[96:99], a[160:163], v[100:103]
    ds_read_b128 a[188:191], v5 offset:7168
    v_cvt_pk_bf16_f32 v81, v50, v51
    v_mfma_f32_16x16x32_bf16 v[56:59], v[192:195], a[144:147], -4.0
    v_exp_f32 v52, v52
    v_mfma_f32_16x16x32_bf16 v[56:59], v[196:199], a[148:151], v[56:59]
    v_fma_f32 v117, v117, v12, v21
    v_fma_f32 v118, v118, v12, v21
    v_mfma_f32_16x16x32_bf16 v[56:59], v[200:203], a[152:155], v[56:59]
    v_exp_f32 v53, v53
    v_mfma_f32_16x16x32_bf16 v[56:59], v[204:207], a[156:159], v[56:59]
    ds_read_b128 a[160:163], v6 offset:0
    v_cvt_pk_bf16_f32 v82, v52, v53
    v_mfma_f32_16x16x32_bf16 v[60:63], v[220:223], a[156:159], -4.0
    v_exp_f32 v54, v54
    v_mfma_f32_16x16x32_bf16 v[60:63], v[216:219], a[152:155], v[60:63]
    v_fma_f32 v119, v119, v12, v21
    v_cvt_pk_bf16_f32 v112, v112, v113
    v_mfma_f32_16x16x32_bf16 v[60:63], v[212:215], a[148:151], v[60:63]
    v_exp_f32 v55, v55
    v_mfma_f32_16x16x32_bf16 v[60:63], v[208:211], a[144:147], v[60:63]
    s_waitcnt lgkmcnt(1)
    ds_read_b128 a[164:167], v6 offset:2048
    v_cvt_pk_bf16_f32 v83, v54, v55
    v_mfma_f32_16x16x32_bf16 v[104:107], a[32:35], a[176:179], v[104:107]
    v_exp_f32 v56, v56
    v_mfma_f32_16x16x32_bf16 v[104:107], a[36:39], a[180:183], v[104:107]
    ds_write_b128 v3, v[80:83] offset:36864
    v_mfma_f32_16x16x32_bf16 v[104:107], a[40:43], a[184:187], v[104:107]
    v_exp_f32 v57, v57
    v_mfma_f32_16x16x32_bf16 v[104:107], a[44:47], a[188:191], v[104:107]
    v_cvt_pk_bf16_f32 v113, v114, v115
    v_cvt_pk_bf16_f32 v114, v116, v117
    v_mfma_f32_16x16x32_bf16 v[108:111], a[108:111], a[188:191], v[108:111]
    v_exp_f32 v58, v58
    v_mfma_f32_16x16x32_bf16 v[108:111], a[104:107], a[184:187], v[108:111]
    ds_read_b128 a[168:171], v6 offset:4096
    v_cvt_pk_bf16_f32 v84, v56, v57
    v_mfma_f32_16x16x32_bf16 v[108:111], a[100:103], a[180:183], v[108:111]
    v_exp_f32 v59, v59
    v_mfma_f32_16x16x32_bf16 v[108:111], a[96:99], a[176:179], v[108:111]
    ds_read_b128 a[172:175], v6 offset:6144
    v_cvt_pk_bf16_f32 v85, v58, v59
    v_smfmac_f32_16x16x64_bf16 v[28:31], a[192:195], v[72:79], v24
    v_cvt_pk_bf16_f32 v115, v118, v119
    v_mfma_f32_16x16x32_bf16 v[48:51], v[224:227], a[128:131], -4.0
    v_exp_f32 v60, v60
    v_mfma_f32_16x16x32_bf16 v[48:51], v[228:231], a[132:135], v[48:51]
    buffer_store_dwordx4 v[112:115], v2, s[24:27], s31 offen sc1
    v_mfma_f32_16x16x32_bf16 v[48:51], v[232:235], a[136:139], v[48:51]
    s_add_u32 s31, s31, 4096
    v_exp_f32 v61, v61
    v_mfma_f32_16x16x32_bf16 v[48:51], v[236:239], a[140:143], v[48:51]
    ds_read_b128 a[176:179], v6 offset:1024
    v_cvt_pk_bf16_f32 v86, v60, v61
    v_mfma_f32_16x16x32_bf16 v[52:55], v[252:255], a[140:143], -4.0
    v_exp_f32 v62, v62
    v_mfma_f32_16x16x32_bf16 v[52:55], v[248:251], a[136:139], v[52:55]
    v_mul_f32 v21, -v16, v13
    v_fma_f32 v120, v120, v13, v21
    v_mfma_f32_16x16x32_bf16 v[52:55], v[244:247], a[132:135], v[52:55]
    v_exp_f32 v63, v63
    v_mfma_f32_16x16x32_bf16 v[52:55], v[240:243], a[128:131], v[52:55]
    s_waitcnt lgkmcnt(1)
    ds_read_b128 a[180:183], v6 offset:3072
    v_cvt_pk_bf16_f32 v87, v62, v63
    v_mfma_f32_16x16x32_bf16 v[96:99], a[48:51], a[160:163], v[96:99]
    v_exp_f32 v48, v48
    v_mfma_f32_16x16x32_bf16 v[96:99], a[52:55], a[164:167], v[96:99]
    ds_write_b128 v3, v[84:87] offset:37888
    v_mfma_f32_16x16x32_bf16 v[96:99], a[56:59], a[168:171], v[96:99]
    v_exp_f32 v49, v49
    v_mfma_f32_16x16x32_bf16 v[96:99], a[60:63], a[172:175], v[96:99]
    v_fma_f32 v121, v121, v13, v21
    v_fma_f32 v122, v122, v13, v21
    v_mfma_f32_16x16x32_bf16 v[100:103], a[124:127], a[172:175], v[100:103]
    v_exp_f32 v50, v50
    v_mfma_f32_16x16x32_bf16 v[100:103], a[120:123], a[168:171], v[100:103]
    ds_read_b128 a[184:187], v6 offset:5120
    v_cvt_pk_bf16_f32 v88, v48, v49
    v_mfma_f32_16x16x32_bf16 v[100:103], a[116:119], a[164:167], v[100:103]
    v_exp_f32 v51, v51
    v_mfma_f32_16x16x32_bf16 v[100:103], a[112:115], a[160:163], v[100:103]
    ds_read_b128 a[188:191], v6 offset:7168
    v_cvt_pk_bf16_f32 v89, v50, v51
    v_mfma_f32_16x16x32_bf16 v[56:59], v[224:227], a[144:147], -4.0
    v_exp_f32 v52, v52
    v_mfma_f32_16x16x32_bf16 v[56:59], v[228:231], a[148:151], v[56:59]
    v_fma_f32 v123, v123, v13, v21
    v_fma_f32 v124, v124, v13, v21
    v_mfma_f32_16x16x32_bf16 v[56:59], v[232:235], a[152:155], v[56:59]
    v_exp_f32 v53, v53
    v_mfma_f32_16x16x32_bf16 v[56:59], v[236:239], a[156:159], v[56:59]
    ds_read_b128 a[128:131], v7 offset:0
    v_cvt_pk_bf16_f32 v90, v52, v53
    v_mfma_f32_16x16x32_bf16 v[60:63], v[252:255], a[156:159], -4.0
    v_exp_f32 v54, v54
    v_mfma_f32_16x16x32_bf16 v[60:63], v[248:251], a[152:155], v[60:63]
    ds_read_b128 a[132:135], v0 offset:0
    ds_read_b128 a[136:139], v15 offset:0
    v_mfma_f32_16x16x32_bf16 v[60:63], v[244:247], a[148:151], v[60:63]
    v_exp_f32 v55, v55
    v_mfma_f32_16x16x32_bf16 v[60:63], v[240:243], a[144:147], v[60:63]
    s_waitcnt lgkmcnt(3)
    ds_read_b128 a[140:143], v25 offset:0
    v_cvt_pk_bf16_f32 v91, v54, v55
    v_mfma_f32_16x16x32_bf16 v[104:107], a[48:51], a[176:179], v[104:107]
    v_exp_f32 v56, v56
    v_mfma_f32_16x16x32_bf16 v[104:107], a[52:55], a[180:183], v[104:107]
    ds_write_b128 v3, v[88:91] offset:38912
    v_mfma_f32_16x16x32_bf16 v[104:107], a[56:59], a[184:187], v[104:107]
    v_exp_f32 v57, v57
    v_mfma_f32_16x16x32_bf16 v[104:107], a[60:63], a[188:191], v[104:107]
    v_fma_f32 v125, v125, v13, v21
    v_fma_f32 v126, v126, v13, v21
    v_mfma_f32_16x16x32_bf16 v[108:111], a[124:127], a[188:191], v[108:111]
    v_exp_f32 v58, v58
    v_mfma_f32_16x16x32_bf16 v[108:111], a[120:123], a[184:187], v[108:111]
    ds_read_b128 a[144:147], v7 offset:4096
    v_cvt_pk_bf16_f32 v92, v56, v57
    v_mfma_f32_16x16x32_bf16 v[108:111], a[116:119], a[180:183], v[108:111]
    v_exp_f32 v59, v59
    v_mfma_f32_16x16x32_bf16 v[108:111], a[112:115], a[176:179], v[108:111]
    ds_read_b128 a[148:151], v0 offset:4096
    v_cvt_pk_bf16_f32 v93, v58, v59
    v_smfmac_f32_16x16x64_bf16 v[28:31], a[192:195], v[80:87], v24
    s_waitcnt lgkmcnt(3)
    v_fma_f32 v127, v127, v13, v21
    v_mfma_f32_16x16x32_bf16 v[48:51], v[128:131], a[128:131], -4.0
    v_exp_f32 v60, v60
    v_mfma_f32_16x16x32_bf16 v[48:51], v[132:135], a[132:135], v[48:51]
    v_cvt_pk_bf16_f32 v120, v120, v121
    v_cvt_pk_bf16_f32 v121, v122, v123
    v_mfma_f32_16x16x32_bf16 v[48:51], v[136:139], a[136:139], v[48:51]
    v_exp_f32 v61, v61
    v_mfma_f32_16x16x32_bf16 v[48:51], v[140:143], a[140:143], v[48:51]
    ds_read_b128 a[152:155], v15 offset:4096
    v_cvt_pk_bf16_f32 v94, v60, v61
    v_mfma_f32_16x16x32_bf16 v[52:55], v[156:159], a[140:143], -4.0
    s_add_u32 m0, s32, 24576
    v_exp_f32 v62, v62
    v_mfma_f32_16x16x32_bf16 v[52:55], v[152:155], a[136:139], v[52:55]
    buffer_load_dwordx4 v1, s[12:15], s30 offen lds
    v_mfma_f32_16x16x32_bf16 v[52:55], v[148:151], a[132:135], v[52:55]
    s_add_u32 s30, s30, 4096
    v_exp_f32 v63, v63
    v_mfma_f32_16x16x32_bf16 v[52:55], v[144:147], a[128:131], v[52:55]
    ds_read_b128 a[156:159], v25 offset:4096
    v_cvt_pk_bf16_f32 v95, v62, v63
    v_mfma_f32_16x16x32_bf16 v[112:115], a[12:15], v[88:91], v[16:19]
    v_exp_f32 v48, v48
    v_mfma_f32_16x16x32_bf16 v[112:115], a[8:11], v[80:83], v[112:115]
    ds_write_b128 v3, v[92:95] offset:39936
    v_mfma_f32_16x16x32_bf16 v[112:115], a[4:7], v[72:75], v[112:115]
    v_exp_f32 v49, v49
    v_mfma_f32_16x16x32_bf16 v[112:115], a[0:3], v[64:67], v[112:115]
    s_waitcnt vmcnt(8)
    ds_inc_u32 v9, v24 offset:4096
    v_mfma_f32_16x16x32_bf16 v[116:119], a[64:67], v[64:67], v[16:19]
    s_add_u32 s46, s46, 8
    v_exp_f32 v50, v50
    v_mfma_f32_16x16x32_bf16 v[116:119], a[68:71], v[72:75], v[116:119]
    v_cvt_pk_bf16_f32 v64, v48, v49
    v_cvt_pk_bf16_f32 v122, v124, v125
    v_mfma_f32_16x16x32_bf16 v[116:119], a[72:75], v[80:83], v[116:119]
    v_exp_f32 v51, v51
    v_mfma_f32_16x16x32_bf16 v[116:119], a[76:79], v[88:91], v[116:119]
    s_waitcnt lgkmcnt(2)
    v_cvt_pk_bf16_f32 v65, v50, v51
    v_cvt_pk_bf16_f32 v123, v126, v127
    v_mfma_f32_16x16x32_bf16 v[56:59], v[128:131], a[144:147], -4.0
    v_exp_f32 v52, v52
    v_mfma_f32_16x16x32_bf16 v[56:59], v[132:135], a[148:151], v[56:59]
    buffer_store_dwordx4 v[120:123], v2, s[24:27], s31 offen sc1
    v_mfma_f32_16x16x32_bf16 v[56:59], v[136:139], a[152:155], v[56:59]
    s_add_u32 s31, s31, 4096
    v_exp_f32 v53, v53
    v_mfma_f32_16x16x32_bf16 v[56:59], v[140:143], a[156:159], v[56:59]
    v_cvt_pk_bf16_f32 v66, v52, v53
    v_max_u32 v11, v11, v20
    v_mfma_f32_16x16x32_bf16 v[60:63], v[156:159], a[156:159], -4.0
    v_exp_f32 v54, v54
    v_mfma_f32_16x16x32_bf16 v[60:63], v[152:155], a[152:155], v[60:63]
    ds_read_b32 v14, v9 offset:4096
    ds_read_b128 v[20:23], v9 offset:0
    v_mfma_f32_16x16x32_bf16 v[60:63], v[148:151], a[148:151], v[60:63]
    v_exp_f32 v55, v55
    v_mfma_f32_16x16x32_bf16 v[60:63], v[144:147], a[144:147], v[60:63]
    ds_read_b128 a[160:163], v4 offset:32768
    v_cvt_pk_bf16_f32 v67, v54, v55
    v_mfma_f32_16x16x32_bf16 v[120:123], a[12:15], v[92:95], v[16:19]
    v_exp_f32 v56, v56
    v_mfma_f32_16x16x32_bf16 v[120:123], a[8:11], v[84:87], v[120:123]
    ds_read_b128 a[164:167], v4 offset:34816
    ds_read_b128 a[168:171], v4 offset:36864
    v_mfma_f32_16x16x32_bf16 v[120:123], a[4:7], v[76:79], v[120:123]
    s_add_u32 m0, s32, 28672
    v_exp_f32 v57, v57
    v_mfma_f32_16x16x32_bf16 v[120:123], a[0:3], v[68:71], v[120:123]
    buffer_load_dwordx4 v1, s[12:15], s30 offen lds
    v_mfma_f32_16x16x32_bf16 v[124:127], a[64:67], v[68:71], v[16:19]
    s_add_u32 s30, s30, 4096
    v_exp_f32 v58, v58
    v_mfma_f32_16x16x32_bf16 v[124:127], a[68:71], v[76:79], v[124:127]
    s_waitcnt lgkmcnt(4)
    v_cvt_pk_bf16_f32 v68, v56, v57
    v_cmp_gt_u32 vcc, s46, v14
    v_mfma_f32_16x16x32_bf16 v[124:127], a[72:75], v[84:87], v[124:127]
    v_exp_f32 v59, v59
    v_mfma_f32_16x16x32_bf16 v[124:127], a[76:79], v[92:95], v[124:127]
    ds_read_b128 a[172:175], v4 offset:38912
    v_cvt_pk_bf16_f32 v69, v58, v59
    v_smfmac_f32_16x16x64_bf16 v[28:31], a[192:195], v[88:95], v24
    s_cbranch_vccnz L_late8
L_back8:
    s_waitcnt lgkmcnt(3)
    v_add_f32 v20, v20, v21
    v_mfma_f32_16x16x32_bf16 v[48:51], v[160:163], a[128:131], -4.0
    v_exp_f32 v60, v60
    v_mfma_f32_16x16x32_bf16 v[48:51], v[164:167], a[132:135], v[48:51]
    ds_write_b128 v3, v[64:67] offset:0
    v_mfma_f32_16x16x32_bf16 v[48:51], v[168:171], a[136:139], v[48:51]
    v_exp_f32 v61, v61
    v_mfma_f32_16x16x32_bf16 v[48:51], v[172:175], a[140:143], v[48:51]
    ds_read_b128 a[176:179], v4 offset:33792
    v_cvt_pk_bf16_f32 v70, v60, v61
    v_mfma_f32_16x16x32_bf16 v[52:55], v[188:191], a[140:143], -4.0
    v_exp_f32 v62, v62
    v_mfma_f32_16x16x32_bf16 v[52:55], v[184:187], a[136:139], v[52:55]
    v_add_f32 v22, v22, v23
    v_add_f32 v20, v20, v22
    v_mfma_f32_16x16x32_bf16 v[52:55], v[180:183], a[132:135], v[52:55]
    v_exp_f32 v63, v63
    v_mfma_f32_16x16x32_bf16 v[52:55], v[176:179], a[128:131], v[52:55]
    ds_read_b128 a[180:183], v4 offset:35840
    v_cvt_pk_bf16_f32 v71, v62, v63
    v_mfma_f32_16x16x32_bf16 v[112:115], a[16:19], a[160:163], v[112:115]
    s_waitcnt lgkmcnt(3)
    v_exp_f32 v48, v48
    v_mfma_f32_16x16x32_bf16 v[112:115], a[20:23], a[164:167], v[112:115]
    ds_write_b128 v3, v[68:71] offset:1024
    v_mfma_f32_16x16x32_bf16 v[112:115], a[24:27], a[168:171], v[112:115]
    v_exp_f32 v49, v49
    v_mfma_f32_16x16x32_bf16 v[112:115], a[28:31], a[172:175], v[112:115]
    v_rcp_f32 v12, v20
    v_mfma_f32_16x16x32_bf16 v[116:119], a[92:95], a[172:175], v[116:119]
    v_exp_f32 v50, v50
    v_mfma_f32_16x16x32_bf16 v[116:119], a[88:91], a[168:171], v[116:119]
    ds_read_b128 a[184:187], v4 offset:37888
    v_cvt_pk_bf16_f32 v72, v48, v49
    v_mfma_f32_16x16x32_bf16 v[116:119], a[84:87], a[164:167], v[116:119]
    v_exp_f32 v51, v51
    v_mfma_f32_16x16x32_bf16 v[116:119], a[80:83], a[160:163], v[116:119]
    ds_read_b128 a[188:191], v4 offset:39936
    v_cvt_pk_bf16_f32 v73, v50, v51
    v_mfma_f32_16x16x32_bf16 v[56:59], v[160:163], a[144:147], -4.0
    v_exp_f32 v52, v52
    v_mfma_f32_16x16x32_bf16 v[56:59], v[164:167], a[148:151], v[56:59]
    v_add_f32 v14, v28, v29
    v_mov_b64 v[28:29], 0
    v_mfma_f32_16x16x32_bf16 v[56:59], v[168:171], a[152:155], v[56:59]
    v_exp_f32 v53, v53
    v_mfma_f32_16x16x32_bf16 v[56:59], v[172:175], a[156:159], v[56:59]
    ds_read_b128 a[160:163], v5 offset:32768
    v_cvt_pk_bf16_f32 v74, v52, v53
    v_mfma_f32_16x16x32_bf16 v[60:63], v[188:191], a[156:159], -4.0
    v_exp_f32 v54, v54
    v_mfma_f32_16x16x32_bf16 v[60:63], v[184:187], a[152:155], v[60:63]
    v_mov_b32 v13, v12
    v_min_f32 v10, v10, v20
    v_mfma_f32_16x16x32_bf16 v[60:63], v[180:183], a[148:151], v[60:63]
    v_exp_f32 v55, v55
    v_mfma_f32_16x16x32_bf16 v[60:63], v[176:179], a[144:147], v[60:63]
    s_waitcnt lgkmcnt(1)
    ds_read_b128 a[164:167], v5 offset:34816
    v_cvt_pk_bf16_f32 v75, v54, v55
    v_mfma_f32_16x16x32_bf16 v[120:123], a[16:19], a[176:179], v[120:123]
    v_exp_f32 v56, v56
    v_mfma_f32_16x16x32_bf16 v[120:123], a[20:23], a[180:183], v[120:123]
    ds_write_b128 v3, v[72:75] offset:2048
    v_mfma_f32_16x16x32_bf16 v[120:123], a[24:27], a[184:187], v[120:123]
    v_exp_f32 v57, v57
    v_mfma_f32_16x16x32_bf16 v[120:123], a[28:31], a[188:191], v[120:123]
    v_permlane32_swap_b32 v12, v13
    v_mul_f32 v21, -v16, v12
    v_mfma_f32_16x16x32_bf16 v[124:127], a[92:95], a[188:191], v[124:127]
    v_exp_f32 v58, v58
    v_mfma_f32_16x16x32_bf16 v[124:127], a[88:91], a[184:187], v[124:127]
    ds_read_b128 a[168:171], v5 offset:36864
    v_cvt_pk_bf16_f32 v76, v56, v57
    v_mfma_f32_16x16x32_bf16 v[124:127], a[84:87], a[180:183], v[124:127]
    v_exp_f32 v59, v59
    v_mfma_f32_16x16x32_bf16 v[124:127], a[80:83], a[176:179], v[124:127]
    ds_read_b128 a[172:175], v5 offset:38912
    v_cvt_pk_bf16_f32 v77, v58, v59
    v_smfmac_f32_16x16x64_bf16 v[28:31], a[192:195], v[64:71], v24
    v_fma_f32 v96, v96, v12, v21
    v_mfma_f32_16x16x32_bf16 v[48:51], v[192:195], a[128:131], -4.0
    v_exp_f32 v60, v60
    v_mfma_f32_16x16x32_bf16 v[48:51], v[196:199], a[132:135], v[48:51]
    ds_write_b32 v8, v14 offset:512
    v_mfma_f32_16x16x32_bf16 v[48:51], v[200:203], a[136:139], v[48:51]
    v_exp_f32 v61, v61
    v_mfma_f32_16x16x32_bf16 v[48:51], v[204:207], a[140:143], v[48:51]
    ds_read_b128 a[176:179], v5 offset:33792
    v_cvt_pk_bf16_f32 v78, v60, v61
    v_mfma_f32_16x16x32_bf16 v[52:55], v[220:223], a[140:143], -4.0
    v_exp_f32 v62, v62
    v_mfma_f32_16x16x32_bf16 v[52:55], v[216:219], a[136:139], v[52:55]
    v_fma_f32 v97, v97, v12, v21
    v_fma_f32 v98, v98, v12, v21
    v_mfma_f32_16x16x32_bf16 v[52:55], v[212:215], a[132:135], v[52:55]
    v_exp_f32 v63, v63
    v_mfma_f32_16x16x32_bf16 v[52:55], v[208:211], a[128:131], v[52:55]
    s_waitcnt lgkmcnt(2)
    ds_read_b128 a[180:183], v5 offset:35840
    v_cvt_pk_bf16_f32 v79, v62, v63
    v_mfma_f32_16x16x32_bf16 v[112:115], a[32:35], a[160:163], v[112:115]
    v_exp_f32 v48, v48
    v_mfma_f32_16x16x32_bf16 v[112:115], a[36:39], a[164:167], v[112:115]
    ds_write_b128 v3, v[76:79] offset:3072
    v_mfma_f32_16x16x32_bf16 v[112:115], a[40:43], a[168:171], v[112:115]
    v_exp_f32 v49, v49
    v_mfma_f32_16x16x32_bf16 v[112:115], a[44:47], a[172:175], v[112:115]
    v_fma_f32 v99, v99, v12, v21
    v_fma_f32 v100, v100, v12, v21
    v_mfma_f32_16x16x32_bf16 v[116:119], a[108:111], a[172:175], v[116:119]
    v_exp_f32 v50, v50
    v_mfma_f32_16x16x32_bf16 v[116:119], a[104:107], a[168:171], v[116:119]
    ds_read_b128 a[184:187], v5 offset:37888
    v_cvt_pk_bf16_f32 v80, v48, v49
    v_mfma_f32_16x16x32_bf16 v[116:119], a[100:103], a[164:167], v[116:119]
    v_exp_f32 v51, v51
    v_mfma_f32_16x16x32_bf16 v[116:119], a[96:99], a[160:163], v[116:119]
    ds_read_b128 a[188:191], v5 offset:39936
    v_cvt_pk_bf16_f32 v81, v50, v51
    v_mfma_f32_16x16x32_bf16 v[56:59], v[192:195], a[144:147], -4.0
    v_exp_f32 v52, v52
    v_mfma_f32_16x16x32_bf16 v[56:59], v[196:199], a[148:151], v[56:59]
    v_fma_f32 v101, v101, v12, v21
    v_fma_f32 v102, v102, v12, v21
    v_mfma_f32_16x16x32_bf16 v[56:59], v[200:203], a[152:155], v[56:59]
    v_exp_f32 v53, v53
    v_mfma_f32_16x16x32_bf16 v[56:59], v[204:207], a[156:159], v[56:59]
    ds_read_b128 a[160:163], v6 offset:32768
    v_cvt_pk_bf16_f32 v82, v52, v53
    v_mfma_f32_16x16x32_bf16 v[60:63], v[220:223], a[156:159], -4.0
    v_exp_f32 v54, v54
    v_mfma_f32_16x16x32_bf16 v[60:63], v[216:219], a[152:155], v[60:63]
    v_fma_f32 v103, v103, v12, v21
    v_cvt_pk_bf16_f32 v96, v96, v97
    v_mfma_f32_16x16x32_bf16 v[60:63], v[212:215], a[148:151], v[60:63]
    v_exp_f32 v55, v55
    v_mfma_f32_16x16x32_bf16 v[60:63], v[208:211], a[144:147], v[60:63]
    s_waitcnt lgkmcnt(1)
    ds_read_b128 a[164:167], v6 offset:34816
    v_cvt_pk_bf16_f32 v83, v54, v55
    v_mfma_f32_16x16x32_bf16 v[120:123], a[32:35], a[176:179], v[120:123]
    v_exp_f32 v56, v56
    v_mfma_f32_16x16x32_bf16 v[120:123], a[36:39], a[180:183], v[120:123]
    ds_write_b128 v3, v[80:83] offset:4096
    v_mfma_f32_16x16x32_bf16 v[120:123], a[40:43], a[184:187], v[120:123]
    v_exp_f32 v57, v57
    v_mfma_f32_16x16x32_bf16 v[120:123], a[44:47], a[188:191], v[120:123]
    v_cvt_pk_bf16_f32 v97, v98, v99
    v_cvt_pk_bf16_f32 v98, v100, v101
    v_mfma_f32_16x16x32_bf16 v[124:127], a[108:111], a[188:191], v[124:127]
    v_exp_f32 v58, v58
    v_mfma_f32_16x16x32_bf16 v[124:127], a[104:107], a[184:187], v[124:127]
    ds_read_b128 a[168:171], v6 offset:36864
    v_cvt_pk_bf16_f32 v84, v56, v57
    v_mfma_f32_16x16x32_bf16 v[124:127], a[100:103], a[180:183], v[124:127]
    v_exp_f32 v59, v59
    v_mfma_f32_16x16x32_bf16 v[124:127], a[96:99], a[176:179], v[124:127]
    ds_read_b128 a[172:175], v6 offset:38912
    v_cvt_pk_bf16_f32 v85, v58, v59
    v_smfmac_f32_16x16x64_bf16 v[28:31], a[192:195], v[72:79], v24
    v_cvt_pk_bf16_f32 v99, v102, v103
    v_mfma_f32_16x16x32_bf16 v[48:51], v[224:227], a[128:131], -4.0
    v_exp_f32 v60, v60
    v_mfma_f32_16x16x32_bf16 v[48:51], v[228:231], a[132:135], v[48:51]
    buffer_store_dwordx4 v[96:99], v2, s[24:27], s31 offen sc1
    v_mfma_f32_16x16x32_bf16 v[48:51], v[232:235], a[136:139], v[48:51]
    s_add_u32 s31, s31, 4096
    v_exp_f32 v61, v61
    v_mfma_f32_16x16x32_bf16 v[48:51], v[236:239], a[140:143], v[48:51]
    ds_read_b128 a[176:179], v6 offset:33792
    v_cvt_pk_bf16_f32 v86, v60, v61
    v_mfma_f32_16x16x32_bf16 v[52:55], v[252:255], a[140:143], -4.0
    v_exp_f32 v62, v62
    v_mfma_f32_16x16x32_bf16 v[52:55], v[248:251], a[136:139], v[52:55]
    v_mul_f32 v21, -v16, v13
    v_fma_f32 v104, v104, v13, v21
    v_mfma_f32_16x16x32_bf16 v[52:55], v[244:247], a[132:135], v[52:55]
    v_exp_f32 v63, v63
    v_mfma_f32_16x16x32_bf16 v[52:55], v[240:243], a[128:131], v[52:55]
    s_waitcnt lgkmcnt(1)
    ds_read_b128 a[180:183], v6 offset:35840
    v_cvt_pk_bf16_f32 v87, v62, v63
    v_mfma_f32_16x16x32_bf16 v[112:115], a[48:51], a[160:163], v[112:115]
    v_exp_f32 v48, v48
    v_mfma_f32_16x16x32_bf16 v[112:115], a[52:55], a[164:167], v[112:115]
    ds_write_b128 v3, v[84:87] offset:5120
    v_mfma_f32_16x16x32_bf16 v[112:115], a[56:59], a[168:171], v[112:115]
    v_exp_f32 v49, v49
    v_mfma_f32_16x16x32_bf16 v[112:115], a[60:63], a[172:175], v[112:115]
    v_fma_f32 v105, v105, v13, v21
    v_fma_f32 v106, v106, v13, v21
    v_mfma_f32_16x16x32_bf16 v[116:119], a[124:127], a[172:175], v[116:119]
    v_exp_f32 v50, v50
    v_mfma_f32_16x16x32_bf16 v[116:119], a[120:123], a[168:171], v[116:119]
    ds_read_b128 a[184:187], v6 offset:37888
    v_cvt_pk_bf16_f32 v88, v48, v49
    v_mfma_f32_16x16x32_bf16 v[116:119], a[116:119], a[164:167], v[116:119]
    v_exp_f32 v51, v51
    v_mfma_f32_16x16x32_bf16 v[116:119], a[112:115], a[160:163], v[116:119]
    ds_read_b128 a[188:191], v6 offset:39936
    v_cvt_pk_bf16_f32 v89, v50, v51
    v_mfma_f32_16x16x32_bf16 v[56:59], v[224:227], a[144:147], -4.0
    v_exp_f32 v52, v52
    v_mfma_f32_16x16x32_bf16 v[56:59], v[228:231], a[148:151], v[56:59]
    v_fma_f32 v107, v107, v13, v21
    v_fma_f32 v108, v108, v13, v21
    v_mfma_f32_16x16x32_bf16 v[56:59], v[232:235], a[152:155], v[56:59]
    v_exp_f32 v53, v53
    v_mfma_f32_16x16x32_bf16 v[56:59], v[236:239], a[156:159], v[56:59]
    ds_read_b128 a[128:131], v7 offset:8192
    v_cvt_pk_bf16_f32 v90, v52, v53
    v_mfma_f32_16x16x32_bf16 v[60:63], v[252:255], a[156:159], -4.0
    v_exp_f32 v54, v54
    v_mfma_f32_16x16x32_bf16 v[60:63], v[248:251], a[152:155], v[60:63]
    ds_read_b128 a[132:135], v0 offset:8192
    ds_read_b128 a[136:139], v15 offset:8192
    v_mfma_f32_16x16x32_bf16 v[60:63], v[244:247], a[148:151], v[60:63]
    v_exp_f32 v55, v55
    v_mfma_f32_16x16x32_bf16 v[60:63], v[240:243], a[144:147], v[60:63]
    s_waitcnt lgkmcnt(3)
    ds_read_b128 a[140:143], v25 offset:8192
    v_cvt_pk_bf16_f32 v91, v54, v55
    v_mfma_f32_16x16x32_bf16 v[120:123], a[48:51], a[176:179], v[120:123]
    v_exp_f32 v56, v56
    v_mfma_f32_16x16x32_bf16 v[120:123], a[52:55], a[180:183], v[120:123]
    ds_write_b128 v3, v[88:91] offset:6144
    v_mfma_f32_16x16x32_bf16 v[120:123], a[56:59], a[184:187], v[120:123]
    v_exp_f32 v57, v57
    v_mfma_f32_16x16x32_bf16 v[120:123], a[60:63], a[188:191], v[120:123]
    v_fma_f32 v109, v109, v13, v21
    v_fma_f32 v110, v110, v13, v21
    v_mfma_f32_16x16x32_bf16 v[124:127], a[124:127], a[188:191], v[124:127]
    v_exp_f32 v58, v58
    v_mfma_f32_16x16x32_bf16 v[124:127], a[120:123], a[184:187], v[124:127]
    ds_read_b128 a[144:147], v7 offset:12288
    v_cvt_pk_bf16_f32 v92, v56, v57
    v_mfma_f32_16x16x32_bf16 v[124:127], a[116:119], a[180:183], v[124:127]
    v_exp_f32 v59, v59
    v_mfma_f32_16x16x32_bf16 v[124:127], a[112:115], a[176:179], v[124:127]
    ds_read_b128 a[148:151], v0 offset:12288
    v_cvt_pk_bf16_f32 v93, v58, v59
    v_smfmac_f32_16x16x64_bf16 v[28:31], a[192:195], v[80:87], v24
    s_waitcnt lgkmcnt(3)
    v_fma_f32 v111, v111, v13, v21
    v_mfma_f32_16x16x32_bf16 v[48:51], v[128:131], a[128:131], -4.0
    v_exp_f32 v60, v60
    v_mfma_f32_16x16x32_bf16 v[48:51], v[132:135], a[132:135], v[48:51]
    v_cvt_pk_bf16_f32 v104, v104, v105
    v_cvt_pk_bf16_f32 v105, v106, v107
    v_mfma_f32_16x16x32_bf16 v[48:51], v[136:139], a[136:139], v[48:51]
    v_exp_f32 v61, v61
    v_mfma_f32_16x16x32_bf16 v[48:51], v[140:143], a[140:143], v[48:51]
    ds_read_b128 a[152:155], v15 offset:12288
    v_cvt_pk_bf16_f32 v94, v60, v61
    v_mfma_f32_16x16x32_bf16 v[52:55], v[156:159], a[140:143], -4.0
    s_add_u32 m0, s32, 0
    v_exp_f32 v62, v62
    v_mfma_f32_16x16x32_bf16 v[52:55], v[152:155], a[136:139], v[52:55]
    buffer_load_dwordx4 v1, s[12:15], s30 offen lds
    v_mfma_f32_16x16x32_bf16 v[52:55], v[148:151], a[132:135], v[52:55]
    s_add_u32 s30, s30, 4096
    v_exp_f32 v63, v63
    v_mfma_f32_16x16x32_bf16 v[52:55], v[144:147], a[128:131], v[52:55]
    ds_read_b128 a[156:159], v25 offset:12288
    v_cvt_pk_bf16_f32 v95, v62, v63
    v_mfma_f32_16x16x32_bf16 v[96:99], a[12:15], v[88:91], v[16:19]
    v_exp_f32 v48, v48
    v_mfma_f32_16x16x32_bf16 v[96:99], a[8:11], v[80:83], v[96:99]
    ds_write_b128 v3, v[92:95] offset:7168
    v_mfma_f32_16x16x32_bf16 v[96:99], a[4:7], v[72:75], v[96:99]
    v_exp_f32 v49, v49
    v_mfma_f32_16x16x32_bf16 v[96:99], a[0:3], v[64:67], v[96:99]
    s_waitcnt vmcnt(6)
    ds_inc_u32 v9, v24 offset:4096
    v_mfma_f32_16x16x32_bf16 v[100:103], a[64:67], v[64:67], v[16:19]
    s_add_u32 s46, s46, 8
    v_exp_f32 v50, v50
    v_mfma_f32_16x16x32_bf16 v[100:103], a[68:71], v[72:75], v[100:103]
    v_cvt_pk_bf16_f32 v64, v48, v49
    v_cvt_pk_bf16_f32 v106, v108, v109
    v_mfma_f32_16x16x32_bf16 v[100:103], a[72:75], v[80:83], v[100:103]
    v_exp_f32 v51, v51
    v_mfma_f32_16x16x32_bf16 v[100:103], a[76:79], v[88:91], v[100:103]
    s_waitcnt lgkmcnt(2)
    v_cvt_pk_bf16_f32 v65, v50, v51
    v_cvt_pk_bf16_f32 v107, v110, v111
    v_mfma_f32_16x16x32_bf16 v[56:59], v[128:131], a[144:147], -4.0
    v_exp_f32 v52, v52
    v_mfma_f32_16x16x32_bf16 v[56:59], v[132:135], a[148:151], v[56:59]
    buffer_store_dwordx4 v[104:107], v2, s[24:27], s31 offen sc1
    v_mfma_f32_16x16x32_bf16 v[56:59], v[136:139], a[152:155], v[56:59]
    s_add_u32 s31, s31, 4096
    v_exp_f32 v53, v53
    v_mfma_f32_16x16x32_bf16 v[56:59], v[140:143], a[156:159], v[56:59]
    v_cvt_pk_bf16_f32 v66, v52, v53
    v_max_u32 v11, v11, v20
    v_mfma_f32_16x16x32_bf16 v[60:63], v[156:159], a[156:159], -4.0
    v_exp_f32 v54, v54
    v_mfma_f32_16x16x32_bf16 v[60:63], v[152:155], a[152:155], v[60:63]
    ds_read_b32 v14, v9 offset:4096
    ds_read_b128 v[20:23], v9 offset:512
    v_mfma_f32_16x16x32_bf16 v[60:63], v[148:151], a[148:151], v[60:63]
    v_exp_f32 v55, v55
    v_mfma_f32_16x16x32_bf16 v[60:63], v[144:147], a[144:147], v[60:63]
    ds_read_b128 a[160:163], v4 offset:0
    v_cvt_pk_bf16_f32 v67, v54, v55
    v_mfma_f32_16x16x32_bf16 v[104:107], a[12:15], v[92:95], v[16:19]
    v_exp_f32 v56, v56
    v_mfma_f32_16x16x32_bf16 v[104:107], a[8:11], v[84:87], v[104:107]
    ds_read_b128 a[164:167], v4 offset:2048
    ds_read_b128 a[168:171], v4 offset:4096
    v_mfma_f32_16x16x32_bf16 v[104:107], a[4:7], v[76:79], v[104:107]
    s_add_u32 m0, s32, 4096
    v_exp_f32 v57, v57
    v_mfma_f32_16x16x32_bf16 v[104:107], a[0:3], v[68:71], v[104:107]
    buffer_load_dwordx4 v1, s[12:15], s30 offen lds
    v_mfma_f32_16x16x32_bf16 v[108:111], a[64:67], v[68:71], v[16:19]
    s_add_u32 s30, s30, 4096
    v_exp_f32 v58, v58
    v_mfma_f32_16x16x32_bf16 v[108:111], a[68:71], v[76:79], v[108:111]
    s_waitcnt lgkmcnt(4)
    v_cvt_pk_bf16_f32 v68, v56, v57
    v_cmp_gt_u32 vcc, s46, v14
    v_mfma_f32_16x16x32_bf16 v[108:111], a[72:75], v[84:87], v[108:111]
    v_exp_f32 v59, v59
    v_mfma_f32_16x16x32_bf16 v[108:111], a[76:79], v[92:95], v[108:111]
    ds_read_b128 a[172:175], v4 offset:6144
    v_cvt_pk_bf16_f32 v69, v58, v59
    v_smfmac_f32_16x16x64_bf16 v[28:31], a[192:195], v[88:95], v24
    s_cbranch_vccnz L_late9
L_back9:
    s_waitcnt lgkmcnt(3)
    v_add_f32 v20, v20, v21
    v_mfma_f32_16x16x32_bf16 v[48:51], v[160:163], a[128:131], -4.0
    v_exp_f32 v60, v60
    v_mfma_f32_16x16x32_bf16 v[48:51], v[164:167], a[132:135], v[48:51]
    ds_write_b128 v3, v[64:67] offset:32768
    v_mfma_f32_16x16x32_bf16 v[48:51], v[168:171], a[136:139], v[48:51]
    v_exp_f32 v61, v61
    v_mfma_f32_16x16x32_bf16 v[48:51], v[172:175], a[140:143], v[48:51]
    ds_read_b128 a[176:179], v4 offset:1024
    v_cvt_pk_bf16_f32 v70, v60, v61
    v_mfma_f32_16x16x32_bf16 v[52:55], v[188:191], a[140:143], -4.0
    v_exp_f32 v62, v62
    v_mfma_f32_16x16x32_bf16 v[52:55], v[184:187], a[136:139], v[52:55]
    v_add_f32 v22, v22, v23
    v_add_f32 v20, v20, v22
    v_mfma_f32_16x16x32_bf16 v[52:55], v[180:183], a[132:135], v[52:55]
    v_exp_f32 v63, v63
    v_mfma_f32_16x16x32_bf16 v[52:55], v[176:179], a[128:131], v[52:55]
    ds_read_b128 a[180:183], v4 offset:3072
    v_cvt_pk_bf16_f32 v71, v62, v63
    v_mfma_f32_16x16x32_bf16 v[96:99], a[16:19], a[160:163], v[96:99]
    s_waitcnt lgkmcnt(3)
    v_exp_f32 v48, v48
    v_mfma_f32_16x16x32_bf16 v[96:99], a[20:23], a[164:167], v[96:99]
    ds_write_b128 v3, v[68:71] offset:33792
    v_mfma_f32_16x16x32_bf16 v[96:99], a[24:27], a[168:171], v[96:99]
    v_exp_f32 v49, v49
    v_mfma_f32_16x16x32_bf16 v[96:99], a[28:31], a[172:175], v[96:99]
    v_rcp_f32 v12, v20
    v_mfma_f32_16x16x32_bf16 v[100:103], a[92:95], a[172:175], v[100:103]
    v_exp_f32 v50, v50
    v_mfma_f32_16x16x32_bf16 v[100:103], a[88:91], a[168:171], v[100:103]
    ds_read_b128 a[184:187], v4 offset:5120
    v_cvt_pk_bf16_f32 v72, v48, v49
    v_mfma_f32_16x16x32_bf16 v[100:103], a[84:87], a[164:167], v[100:103]
    v_exp_f32 v51, v51
    v_mfma_f32_16x16x32_bf16 v[100:103], a[80:83], a[160:163], v[100:103]
    ds_read_b128 a[188:191], v4 offset:7168
    v_cvt_pk_bf16_f32 v73, v50, v51
    v_mfma_f32_16x16x32_bf16 v[56:59], v[160:163], a[144:147], -4.0
    v_exp_f32 v52, v52
    v_mfma_f32_16x16x32_bf16 v[56:59], v[164:167], a[148:151], v[56:59]
    v_add_f32 v14, v28, v29
    v_mov_b64 v[28:29], 0
    v_mfma_f32_16x16x32_bf16 v[56:59], v[168:171], a[152:155], v[56:59]
    v_exp_f32 v53, v53
    v_mfma_f32_16x16x32_bf16 v[56:59], v[172:175], a[156:159], v[56:59]
    ds_read_b128 a[160:163], v5 offset:0
    v_cvt_pk_bf16_f32 v74, v52, v53
    v_mfma_f32_16x16x32_bf16 v[60:63], v[188:191], a[156:159], -4.0
    v_exp_f32 v54, v54
    v_mfma_f32_16x16x32_bf16 v[60:63], v[184:187], a[152:155], v[60:63]
    v_mov_b32 v13, v12
    v_min_f32 v10, v10, v20
.p2align 6
L_loop:
    v_mfma_f32_16x16x32_bf16 v[60:63], v[180:183], a[148:151], v[60:63]
    v_exp_f32 v55, v55
    v_mfma_f32_16x16x32_bf16 v[60:63], v[176:179], a[144:147], v[60:63]
    s_waitcnt lgkmcnt(1)
    ds_read_b128 a[164:167], v5 offset:2048
    v_cvt_pk_bf16_f32 v75, v54, v55
    v_mfma_f32_16x16x32_bf16 v[104:107], a[16:19], a[176:179], v[104:107]
    v_exp_f32 v56, v56
    v_mfma_f32_16x16x32_bf16 v[104:107], a[20:23], a[180:183], v[104:107]
    ds_write_b128 v3, v[72:75] offset:34816
    v_mfma_f32_16x16x32_bf16 v[104:107], a[24:27], a[184:187], v[104:107]
    v_exp_f32 v57, v57
    v_mfma_f32_16x16x32_bf16 v[104:107], a[28:31], a[188:191], v[104:107]
    v_permlane32_swap_b32 v12, v13
    v_mul_f32 v21, -v16, v12
    v_mfma_f32_16x16x32_bf16 v[108:111], a[92:95], a[188:191], v[108:111]
    v_exp_f32 v58, v58
    v_mfma_f32_16x16x32_bf16 v[108:111], a[88:91], a[184:187], v[108:111]
    ds_read_b128 a[168:171], v5 offset:4096
    v_cvt_pk_bf16_f32 v76, v56, v57
    v_mfma_f32_16x16x32_bf16 v[108:111], a[84:87], a[180:183], v[108:111]
    v_exp_f32 v59, v59
    v_mfma_f32_16x16x32_bf16 v[108:111], a[80:83], a[176:179], v[108:111]
    ds_read_b128 a[172:175], v5 offset:6144
    v_cvt_pk_bf16_f32 v77, v58, v59
    v_smfmac_f32_16x16x64_bf16 v[28:31], a[192:195], v[64:71], v24
    v_fma_f32 v112, v112, v12, v21
    v_mfma_f32_16x16x32_bf16 v[48:51], v[192:195], a[128:131], -4.0
    v_exp_f32 v60, v60
    v_mfma_f32_16x16x32_bf16 v[48:51], v[196:199], a[132:135], v[48:51]
    ds_write_b32 v8, v14 offset:0
    v_mfma_f32_16x16x32_bf16 v[48:51], v[200:203], a[136:139], v[48:51]
    v_exp_f32 v61, v61
    v_mfma_f32_16x16x32_bf16 v[48:51], v[204:207], a[140:143], v[48:51]
    ds_read_b128 a[176:179], v5 offset:1024
    v_cvt_pk_bf16_f32 v78, v60, v61
    v_mfma_f32_16x16x32_bf16 v[52:55], v[220:223], a[140:143], -4.0
    v_exp_f32 v62, v62
    v_mfma_f32_16x16x32_bf16 v[52:55], v[216:219], a[136:139], v[52:55]
    v_fma_f32 v113, v113, v12, v21
    v_fma_f32 v114, v114, v12, v21
    v_mfma_f32_16x16x32_bf16 v[52:55], v[212:215], a[132:135], v[52:55]
    v_exp_f32 v63, v63
    v_mfma_f32_16x16x32_bf16 v[52:55], v[208:211], a[128:131], v[52:55]
    s_waitcnt lgkmcnt(2)
    ds_read_b128 a[180:183], v5 offset:3072
    v_cvt_pk_bf16_f32 v79, v62, v63
    v_mfma_f32_16x16x32_bf16 v[96:99], a[32:35], a[160:163], v[96:99]
    v_exp_f32 v48, v48
    v_mfma_f32_16x16x32_bf16 v[96:99], a[36:39], a[164:167], v[96:99]
    ds_write_b128 v3, v[76:79] offset:35840
    v_mfma_f32_16x16x32_bf16 v[96:99], a[40:43], a[168:171], v[96:99]
    v_exp_f32 v49, v49
    v_mfma_f32_16x16x32_bf16 v[96:99], a[44:47], a[172:175], v[96:99]
    v_fma_f32 v115, v115, v12, v21
    v_fma_f32 v116, v116, v12, v21
    v_mfma_f32_16x16x32_bf16 v[100:103], a[108:111], a[172:175], v[100:103]
    v_exp_f32 v50, v50
    v_mfma_f32_16x16x32_bf16 v[100:103], a[104:107], a[168:171], v[100:103]
    ds_read_b128 a[184:187], v5 offset:5120
    v_cvt_pk_bf16_f32 v80, v48, v49
    v_mfma_f32_16x16x32_bf16 v[100:103], a[100:103], a[164:167], v[100:103]
    v_exp_f32 v51, v51
    v_mfma_f32_16x16x32_bf16 v[100:103], a[96:99], a[160:163], v[100:103]
    ds_read_b128 a[188:191], v5 offset:7168
    v_cvt_pk_bf16_f32 v81, v50, v51
    v_mfma_f32_16x16x32_bf16 v[56:59], v[192:195], a[144:147], -4.0
    v_exp_f32 v52, v52
    v_mfma_f32_16x16x32_bf16 v[56:59], v[196:199], a[148:151], v[56:59]
    v_fma_f32 v117, v117, v12, v21
    v_fma_f32 v118, v118, v12, v21
    v_mfma_f32_16x16x32_bf16 v[56:59], v[200:203], a[152:155], v[56:59]
    v_exp_f32 v53, v53
    v_mfma_f32_16x16x32_bf16 v[56:59], v[204:207], a[156:159], v[56:59]
    ds_read_b128 a[160:163], v6 offset:0
    v_cvt_pk_bf16_f32 v82, v52, v53
    v_mfma_f32_16x16x32_bf16 v[60:63], v[220:223], a[156:159], -4.0
    v_exp_f32 v54, v54
    v_mfma_f32_16x16x32_bf16 v[60:63], v[216:219], a[152:155], v[60:63]
    v_fma_f32 v119, v119, v12, v21
    v_cvt_pk_bf16_f32 v112, v112, v113
    v_mfma_f32_16x16x32_bf16 v[60:63], v[212:215], a[148:151], v[60:63]
    v_exp_f32 v55, v55
    v_mfma_f32_16x16x32_bf16 v[60:63], v[208:211], a[144:147], v[60:63]
    s_waitcnt lgkmcnt(1)
    ds_read_b128 a[164:167], v6 offset:2048
    v_cvt_pk_bf16_f32 v83, v54, v55
    v_mfma_f32_16x16x32_bf16 v[104:107], a[32:35], a[176:179], v[104:107]
    v_exp_f32 v56, v56
    v_mfma_f32_16x16x32_bf16 v[104:107], a[36:39], a[180:183], v[104:107]
    ds_write_b128 v3, v[80:83] offset:36864
    v_mfma_f32_16x16x32_bf16 v[104:107], a[40:43], a[184:187], v[104:107]
    v_exp_f32 v57, v57
    v_mfma_f32_16x16x32_bf16 v[104:107], a[44:47], a[188:191], v[104:107]
    v_cvt_pk_bf16_f32 v113, v114, v115
    v_cvt_pk_bf16_f32 v114, v116, v117
    v_mfma_f32_16x16x32_bf16 v[108:111], a[108:111], a[188:191], v[108:111]
    v_exp_f32 v58, v58
    v_mfma_f32_16x16x32_bf16 v[108:111], a[104:107], a[184:187], v[108:111]
    ds_read_b128 a[168:171], v6 offset:4096
    v_cvt_pk_bf16_f32 v84, v56, v57
    v_mfma_f32_16x16x32_bf16 v[108:111], a[100:103], a[180:183], v[108:111]
    v_exp_f32 v59, v59
    v_mfma_f32_16x16x32_bf16 v[108:111], a[96:99], a[176:179], v[108:111]
    ds_read_b128 a[172:175], v6 offset:6144
    v_cvt_pk_bf16_f32 v85, v58, v59
    v_smfmac_f32_16x16x64_bf16 v[28:31], a[192:195], v[72:79], v24
    v_cvt_pk_bf16_f32 v115, v118, v119
    v_mfma_f32_16x16x32_bf16 v[48:51], v[224:227], a[128:131], -4.0
    v_exp_f32 v60, v60
    v_mfma_f32_16x16x32_bf16 v[48:51], v[228:231], a[132:135], v[48:51]
    buffer_store_dwordx4 v[112:115], v2, s[24:27], s31 offen sc1
    v_mfma_f32_16x16x32_bf16 v[48:51], v[232:235], a[136:139], v[48:51]
    s_add_u32 s31, s31, 4096
    v_exp_f32 v61, v61
    v_mfma_f32_16x16x32_bf16 v[48:51], v[236:239], a[140:143], v[48:51]
    ds_read_b128 a[176:179], v6 offset:1024
    v_cvt_pk_bf16_f32 v86, v60, v61
    v_mfma_f32_16x16x32_bf16 v[52:55], v[252:255], a[140:143], -4.0
    v_exp_f32 v62, v62
    v_mfma_f32_16x16x32_bf16 v[52:55], v[248:251], a[136:139], v[52:55]
    v_mul_f32 v21, -v16, v13
    v_fma_f32 v120, v120, v13, v21
    v_mfma_f32_16x16x32_bf16 v[52:55], v[244:247], a[132:135], v[52:55]
    v_exp_f32 v63, v63
    v_mfma_f32_16x16x32_bf16 v[52:55], v[240:243], a[128:131], v[52:55]
    s_waitcnt lgkmcnt(1)
    ds_read_b128 a[180:183], v6 offset:3072
    v_cvt_pk_bf16_f32 v87, v62, v63
    v_mfma_f32_16x16x32_bf16 v[96:99], a[48:51], a[160:163], v[96:99]
    v_exp_f32 v48, v48
    v_mfma_f32_16x16x32_bf16 v[96:99], a[52:55], a[164:167], v[96:99]
    ds_write_b128 v3, v[84:87] offset:37888
    v_mfma_f32_16x16x32_bf16 v[96:99], a[56:59], a[168:171], v[96:99]
    v_exp_f32 v49, v49
    v_mfma_f32_16x16x32_bf16 v[96:99], a[60:63], a[172:175], v[96:99]
    v_fma_f32 v121, v121, v13, v21
    v_fma_f32 v122, v122, v13, v21
    v_mfma_f32_16x16x32_bf16 v[100:103], a[124:127], a[172:175], v[100:103]
    v_exp_f32 v50, v50
    v_mfma_f32_16x16x32_bf16 v[100:103], a[120:123], a[168:171], v[100:103]
    ds_read_b128 a[184:187], v6 offset:5120
    v_cvt_pk_bf16_f32 v88, v48, v49
    v_mfma_f32_16x16x32_bf16 v[100:103], a[116:119], a[164:167], v[100:103]
    v_exp_f32 v51, v51
    v_mfma_f32_16x16x32_bf16 v[100:103], a[112:115], a[160:163], v[100:103]
    ds_read_b128 a[188:191], v6 offset:7168
    v_cvt_pk_bf16_f32 v89, v50, v51
    v_mfma_f32_16x16x32_bf16 v[56:59], v[224:227], a[144:147], -4.0
    v_exp_f32 v52, v52
    v_mfma_f32_16x16x32_bf16 v[56:59], v[228:231], a[148:151], v[56:59]
    v_fma_f32 v123, v123, v13, v21
    v_fma_f32 v124, v124, v13, v21
    v_mfma_f32_16x16x32_bf16 v[56:59], v[232:235], a[152:155], v[56:59]
    v_exp_f32 v53, v53
    v_mfma_f32_16x16x32_bf16 v[56:59], v[236:239], a[156:159], v[56:59]
    ds_read_b128 a[128:131], v7 offset:16384
    v_cvt_pk_bf16_f32 v90, v52, v53
    v_mfma_f32_16x16x32_bf16 v[60:63], v[252:255], a[156:159], -4.0
    v_exp_f32 v54, v54
    v_mfma_f32_16x16x32_bf16 v[60:63], v[248:251], a[152:155], v[60:63]
    ds_read_b128 a[132:135], v0 offset:16384
    ds_read_b128 a[136:139], v15 offset:16384
    v_mfma_f32_16x16x32_bf16 v[60:63], v[244:247], a[148:151], v[60:63]
    v_exp_f32 v55, v55
    v_mfma_f32_16x16x32_bf16 v[60:63], v[240:243], a[144:147], v[60:63]
    s_waitcnt lgkmcnt(3)
    ds_read_b128 a[140:143], v25 offset:16384
    v_cvt_pk_bf16_f32 v91, v54, v55
    v_mfma_f32_16x16x32_bf16 v[104:107], a[48:51], a[176:179], v[104:107]
    v_exp_f32 v56, v56
    v_mfma_f32_16x16x32_bf16 v[104:107], a[52:55], a[180:183], v[104:107]
    ds_write_b128 v3, v[88:91] offset:38912
    v_mfma_f32_16x16x32_bf16 v[104:107], a[56:59], a[184:187], v[104:107]
    v_exp_f32 v57, v57
    v_mfma_f32_16x16x32_bf16 v[104:107], a[60:63], a[188:191], v[104:107]
    v_fma_f32 v125, v125, v13, v21
    v_fma_f32 v126, v126, v13, v21
    v_mfma_f32_16x16x32_bf16 v[108:111], a[124:127], a[188:191], v[108:111]
    v_exp_f32 v58, v58
    v_mfma_f32_16x16x32_bf16 v[108:111], a[120:123], a[184:187], v[108:111]
    ds_read_b128 a[144:147], v7 offset:20480
    v_cvt_pk_bf16_f32 v92, v56, v57
    v_mfma_f32_16x16x32_bf16 v[108:111], a[116:119], a[180:183], v[108:111]
    v_exp_f32 v59, v59
    v_mfma_f32_16x16x32_bf16 v[108:111], a[112:115], a[176:179], v[108:111]
    ds_read_b128 a[148:151], v0 offset:20480
    v_cvt_pk_bf16_f32 v93, v58, v59
    v_smfmac_f32_16x16x64_bf16 v[28:31], a[192:195], v[80:87], v24
    s_waitcnt lgkmcnt(3)
    v_fma_f32 v127, v127, v13, v21
    v_mfma_f32_16x16x32_bf16 v[48:51], v[128:131], a[128:131], -4.0
    v_exp_f32 v60, v60
    v_mfma_f32_16x16x32_bf16 v[48:51], v[132:135], a[132:135], v[48:51]
    v_cvt_pk_bf16_f32 v120, v120, v121
    v_cvt_pk_bf16_f32 v121, v122, v123
    v_mfma_f32_16x16x32_bf16 v[48:51], v[136:139], a[136:139], v[48:51]
    v_exp_f32 v61, v61
    v_mfma_f32_16x16x32_bf16 v[48:51], v[140:143], a[140:143], v[48:51]
    ds_read_b128 a[152:155], v15 offset:20480
    v_cvt_pk_bf16_f32 v94, v60, v61
    v_mfma_f32_16x16x32_bf16 v[52:55], v[156:159], a[140:143], -4.0
    s_add_u32 m0, s32, 8192
    v_exp_f32 v62, v62
    v_mfma_f32_16x16x32_bf16 v[52:55], v[152:155], a[136:139], v[52:55]
    buffer_load_dwordx4 v1, s[12:15], s30 offen lds
    v_mfma_f32_16x16x32_bf16 v[52:55], v[148:151], a[132:135], v[52:55]
    s_add_u32 s30, s30, 4096
    v_exp_f32 v63, v63
    v_mfma_f32_16x16x32_bf16 v[52:55], v[144:147], a[128:131], v[52:55]
    ds_read_b128 a[156:159], v25 offset:20480
    v_cvt_pk_bf16_f32 v95, v62, v63
    v_mfma_f32_16x16x32_bf16 v[112:115], a[12:15], v[88:91], v[16:19]
    v_exp_f32 v48, v48
    v_mfma_f32_16x16x32_bf16 v[112:115], a[8:11], v[80:83], v[112:115]
    ds_write_b128 v3, v[92:95] offset:39936
    v_mfma_f32_16x16x32_bf16 v[112:115], a[4:7], v[72:75], v[112:115]
    v_exp_f32 v49, v49
    v_mfma_f32_16x16x32_bf16 v[112:115], a[0:3], v[64:67], v[112:115]
    s_waitcnt vmcnt(6)
    ds_inc_u32 v9, v24 offset:4096
    v_mfma_f32_16x16x32_bf16 v[116:119], a[64:67], v[64:67], v[16:19]
    s_add_u32 s46, s46, 8
    v_exp_f32 v50, v50
    v_mfma_f32_16x16x32_bf16 v[116:119], a[68:71], v[72:75], v[116:119]
    v_cvt_pk_bf16_f32 v64, v48, v49
    v_cvt_pk_bf16_f32 v122, v124, v125
    v_mfma_f32_16x16x32_bf16 v[116:119], a[72:75], v[80:83], v[116:119]
    v_exp_f32 v51, v51
    v_mfma_f32_16x16x32_bf16 v[116:119], a[76:79], v[88:91], v[116:119]
    s_waitcnt lgkmcnt(2)
    v_cvt_pk_bf16_f32 v65, v50, v51
    v_cvt_pk_bf16_f32 v123, v126, v127
    v_mfma_f32_16x16x32_bf16 v[56:59], v[128:131], a[144:147], -4.0
    v_exp_f32 v52, v52
    v_mfma_f32_16x16x32_bf16 v[56:59], v[132:135], a[148:151], v[56:59]
    buffer_store_dwordx4 v[120:123], v2, s[24:27], s31 offen sc1
    v_mfma_f32_16x16x32_bf16 v[56:59], v[136:139], a[152:155], v[56:59]
    s_add_u32 s31, s31, 4096
    v_exp_f32 v53, v53
    v_mfma_f32_16x16x32_bf16 v[56:59], v[140:143], a[156:159], v[56:59]
    v_cvt_pk_bf16_f32 v66, v52, v53
    v_max_u32 v11, v11, v20
    v_mfma_f32_16x16x32_bf16 v[60:63], v[156:159], a[156:159], -4.0
    v_exp_f32 v54, v54
    v_mfma_f32_16x16x32_bf16 v[60:63], v[152:155], a[152:155], v[60:63]
    ds_read_b32 v14, v9 offset:4096
    ds_read_b128 v[20:23], v9 offset:0
    v_mfma_f32_16x16x32_bf16 v[60:63], v[148:151], a[148:151], v[60:63]
    v_exp_f32 v55, v55
    v_mfma_f32_16x16x32_bf16 v[60:63], v[144:147], a[144:147], v[60:63]
    ds_read_b128 a[160:163], v4 offset:32768
    v_cvt_pk_bf16_f32 v67, v54, v55
    v_mfma_f32_16x16x32_bf16 v[120:123], a[12:15], v[92:95], v[16:19]
    v_exp_f32 v56, v56
    v_mfma_f32_16x16x32_bf16 v[120:123], a[8:11], v[84:87], v[120:123]
    ds_read_b128 a[164:167], v4 offset:34816
    ds_read_b128 a[168:171], v4 offset:36864
    v_mfma_f32_16x16x32_bf16 v[120:123], a[4:7], v[76:79], v[120:123]
    s_add_u32 m0, s32, 12288
    v_exp_f32 v57, v57
    v_mfma_f32_16x16x32_bf16 v[120:123], a[0:3], v[68:71], v[120:123]
    buffer_load_dwordx4 v1, s[12:15], s30 offen lds
    v_mfma_f32_16x16x32_bf16 v[124:127], a[64:67], v[68:71], v[16:19]
    s_add_u32 s30, s30, 4096
    v_exp_f32 v58, v58
    v_mfma_f32_16x16x32_bf16 v[124:127], a[68:71], v[76:79], v[124:127]
    s_waitcnt lgkmcnt(4)
    v_cvt_pk_bf16_f32 v68, v56, v57
    v_cmp_gt_u32 vcc, s46, v14
    v_mfma_f32_16x16x32_bf16 v[124:127], a[72:75], v[84:87], v[124:127]
    v_exp_f32 v59, v59
    v_mfma_f32_16x16x32_bf16 v[124:127], a[76:79], v[92:95], v[124:127]
    ds_read_b128 a[172:175], v4 offset:38912
    v_cvt_pk_bf16_f32 v69, v58, v59
    v_smfmac_f32_16x16x64_bf16 v[28:31], a[192:195], v[88:95], v24
    s_cbranch_vccnz L_lateL0
L_backL0:
    s_waitcnt lgkmcnt(3)
    v_add_f32 v20, v20, v21
    v_mfma_f32_16x16x32_bf16 v[48:51], v[160:163], a[128:131], -4.0
    v_exp_f32 v60, v60
    v_mfma_f32_16x16x32_bf16 v[48:51], v[164:167], a[132:135], v[48:51]
    ds_write_b128 v3, v[64:67] offset:0
    v_mfma_f32_16x16x32_bf16 v[48:51], v[168:171], a[136:139], v[48:51]
    v_exp_f32 v61, v61
    v_mfma_f32_16x16x32_bf16 v[48:51], v[172:175], a[140:143], v[48:51]
    ds_read_b128 a[176:179], v4 offset:33792
    v_cvt_pk_bf16_f32 v70, v60, v61
    v_mfma_f32_16x16x32_bf16 v[52:55], v[188:191], a[140:143], -4.0
    v_exp_f32 v62, v62
    v_mfma_f32_16x16x32_bf16 v[52:55], v[184:187], a[136:139], v[52:55]
    v_add_f32 v22, v22, v23
    v_add_f32 v20, v20, v22
    v_mfma_f32_16x16x32_bf16 v[52:55], v[180:183], a[132:135], v[52:55]
    v_exp_f32 v63, v63
    v_mfma_f32_16x16x32_bf16 v[52:55], v[176:179], a[128:131], v[52:55]
    ds_read_b128 a[180:183], v4 offset:35840
    v_cvt_pk_bf16_f32 v71, v62, v63
    v_mfma_f32_16x16x32_bf16 v[112:115], a[16:19], a[160:163], v[112:115]
    s_waitcnt lgkmcnt(3)
    v_exp_f32 v48, v48
    v_mfma_f32_16x16x32_bf16 v[112:115], a[20:23], a[164:167], v[112:115]
    ds_write_b128 v3, v[68:71] offset:1024
    v_mfma_f32_16x16x32_bf16 v[112:115], a[24:27], a[168:171], v[112:115]
    v_exp_f32 v49, v49
    v_mfma_f32_16x16x32_bf16 v[112:115], a[28:31], a[172:175], v[112:115]
    v_rcp_f32 v12, v20
    v_mfma_f32_16x16x32_bf16 v[116:119], a[92:95], a[172:175], v[116:119]
    v_exp_f32 v50, v50
    v_mfma_f32_16x16x32_bf16 v[116:119], a[88:91], a[168:171], v[116:119]
    ds_read_b128 a[184:187], v4 offset:37888
    v_cvt_pk_bf16_f32 v72, v48, v49
    v_mfma_f32_16x16x32_bf16 v[116:119], a[84:87], a[164:167], v[116:119]
    v_exp_f32 v51, v51
    v_mfma_f32_16x16x32_bf16 v[116:119], a[80:83], a[160:163], v[116:119]
    ds_read_b128 a[188:191], v4 offset:39936
    v_cvt_pk_bf16_f32 v73, v50, v51
    v_mfma_f32_16x16x32_bf16 v[56:59], v[160:163], a[144:147], -4.0
    v_exp_f32 v52, v52
    v_mfma_f32_16x16x32_bf16 v[56:59], v[164:167], a[148:151], v[56:59]
    v_add_f32 v14, v28, v29
    v_mov_b64 v[28:29], 0
    v_mfma_f32_16x16x32_bf16 v[56:59], v[168:171], a[152:155], v[56:59]
    v_exp_f32 v53, v53
    v_mfma_f32_16x16x32_bf16 v[56:59], v[172:175], a[156:159], v[56:59]
    ds_read_b128 a[160:163], v5 offset:32768
    v_cvt_pk_bf16_f32 v74, v52, v53
    v_mfma_f32_16x16x32_bf16 v[60:63], v[188:191], a[156:159], -4.0
    v_exp_f32 v54, v54
    v_mfma_f32_16x16x32_bf16 v[60:63], v[184:187], a[152:155], v[60:63]
    v_mov_b32 v13, v12
    v_min_f32 v10, v10, v20
    v_mfma_f32_16x16x32_bf16 v[60:63], v[180:183], a[148:151], v[60:63]
    v_exp_f32 v55, v55
    v_mfma_f32_16x16x32_bf16 v[60:63], v[176:179], a[144:147], v[60:63]
    s_waitcnt lgkmcnt(1)
    ds_read_b128 a[164:167], v5 offset:34816
    v_cvt_pk_bf16_f32 v75, v54, v55
    v_mfma_f32_16x16x32_bf16 v[120:123], a[16:19], a[176:179], v[120:123]
    v_exp_f32 v56, v56
    v_mfma_f32_16x16x32_bf16 v[120:123], a[20:23], a[180:183], v[120:123]
    ds_write_b128 v3, v[72:75] offset:2048
    v_mfma_f32_16x16x32_bf16 v[120:123], a[24:27], a[184:187], v[120:123]
    v_exp_f32 v57, v57
    v_mfma_f32_16x16x32_bf16 v[120:123], a[28:31], a[188:191], v[120:123]
    v_permlane32_swap_b32 v12, v13
    v_mul_f32 v21, -v16, v12
    v_mfma_f32_16x16x32_bf16 v[124:127], a[92:95], a[188:191], v[124:127]
    v_exp_f32 v58, v58
    v_mfma_f32_16x16x32_bf16 v[124:127], a[88:91], a[184:187], v[124:127]
    ds_read_b128 a[168:171], v5 offset:36864
    v_cvt_pk_bf16_f32 v76, v56, v57
    v_mfma_f32_16x16x32_bf16 v[124:127], a[84:87], a[180:183], v[124:127]
    v_exp_f32 v59, v59
    v_mfma_f32_16x16x32_bf16 v[124:127], a[80:83], a[176:179], v[124:127]
    ds_read_b128 a[172:175], v5 offset:38912
    v_cvt_pk_bf16_f32 v77, v58, v59
    v_smfmac_f32_16x16x64_bf16 v[28:31], a[192:195], v[64:71], v24
    v_fma_f32 v96, v96, v12, v21
    v_mfma_f32_16x16x32_bf16 v[48:51], v[192:195], a[128:131], -4.0
    v_exp_f32 v60, v60
    v_mfma_f32_16x16x32_bf16 v[48:51], v[196:199], a[132:135], v[48:51]
    ds_write_b32 v8, v14 offset:512
    v_mfma_f32_16x16x32_bf16 v[48:51], v[200:203], a[136:139], v[48:51]
    v_exp_f32 v61, v61
    v_mfma_f32_16x16x32_bf16 v[48:51], v[204:207], a[140:143], v[48:51]
    ds_read_b128 a[176:179], v5 offset:33792
    v_cvt_pk_bf16_f32 v78, v60, v61
    v_mfma_f32_16x16x32_bf16 v[52:55], v[220:223], a[140:143], -4.0
    v_exp_f32 v62, v62
    v_mfma_f32_16x16x32_bf16 v[52:55], v[216:219], a[136:139], v[52:55]
    v_fma_f32 v97, v97, v12, v21
    v_fma_f32 v98, v98, v12, v21
    v_mfma_f32_16x16x32_bf16 v[52:55], v[212:215], a[132:135], v[52:55]
    v_exp_f32 v63, v63
    v_mfma_f32_16x16x32_bf16 v[52:55], v[208:211], a[128:131], v[52:55]
    s_waitcnt lgkmcnt(2)
    ds_read_b128 a[180:183], v5 offset:35840
    v_cvt_pk_bf16_f32 v79, v62, v63
    v_mfma_f32_16x16x32_bf16 v[112:115], a[32:35], a[160:163], v[112:115]
    v_exp_f32 v48, v48
    v_mfma_f32_16x16x32_bf16 v[112:115], a[36:39], a[164:167], v[112:115]
    ds_write_b128 v3, v[76:79] offset:3072
    v_mfma_f32_16x16x32_bf16 v[112:115], a[40:43], a[168:171], v[112:115]
    v_exp_f32 v49, v49
    v_mfma_f32_16x16x32_bf16 v[112:115], a[44:47], a[172:175], v[112:115]
    v_fma_f32 v99, v99, v12, v21
    v_fma_f32 v100, v100, v12, v21
    v_mfma_f32_16x16x32_bf16 v[116:119], a[108:111], a[172:175], v[116:119]
    v_exp_f32 v50, v50
    v_mfma_f32_16x16x32_bf16 v[116:119], a[104:107], a[168:171], v[116:119]
    ds_read_b128 a[184:187], v5 offset:37888
    v_cvt_pk_bf16_f32 v80, v48, v49
    v_mfma_f32_16x16x32_bf16 v[116:119], a[100:103], a[164:167], v[116:119]
    v_exp_f32 v51, v51
    v_mfma_f32_16x16x32_bf16 v[116:119], a[96:99], a[160:163], v[116:119]
    ds_read_b128 a[188:191], v5 offset:39936
    v_cvt_pk_bf16_f32 v81, v50, v51
    v_mfma_f32_16x16x32_bf16 v[56:59], v[192:195], a[144:147], -4.0
    v_exp_f32 v52, v52
    v_mfma_f32_16x16x32_bf16 v[56:59], v[196:199], a[148:151], v[56:59]
    v_fma_f32 v101, v101, v12, v21
    v_fma_f32 v102, v102, v12, v21
    v_mfma_f32_16x16x32_bf16 v[56:59], v[200:203], a[152:155], v[56:59]
    v_exp_f32 v53, v53
    v_mfma_f32_16x16x32_bf16 v[56:59], v[204:207], a[156:159], v[56:59]
    ds_read_b128 a[160:163], v6 offset:32768
    v_cvt_pk_bf16_f32 v82, v52, v53
    v_mfma_f32_16x16x32_bf16 v[60:63], v[220:223], a[156:159], -4.0
    v_exp_f32 v54, v54
    v_mfma_f32_16x16x32_bf16 v[60:63], v[216:219], a[152:155], v[60:63]
    v_fma_f32 v103, v103, v12, v21
    v_cvt_pk_bf16_f32 v96, v96, v97
    v_mfma_f32_16x16x32_bf16 v[60:63], v[212:215], a[148:151], v[60:63]
    v_exp_f32 v55, v55
    v_mfma_f32_16x16x32_bf16 v[60:63], v[208:211], a[144:147], v[60:63]
    s_waitcnt lgkmcnt(1)
    ds_read_b128 a[164:167], v6 offset:34816
    v_cvt_pk_bf16_f32 v83, v54, v55
    v_mfma_f32_16x16x32_bf16 v[120:123], a[32:35], a[176:179], v[120:123]
    v_exp_f32 v56, v56
    v_mfma_f32_16x16x32_bf16 v[120:123], a[36:39], a[180:183], v[120:123]
    ds_write_b128 v3, v[80:83] offset:4096
    v_mfma_f32_16x16x32_bf16 v[120:123], a[40:43], a[184:187], v[120:123]
    v_exp_f32 v57, v57
    v_mfma_f32_16x16x32_bf16 v[120:123], a[44:47], a[188:191], v[120:123]
    v_cvt_pk_bf16_f32 v97, v98, v99
    v_cvt_pk_bf16_f32 v98, v100, v101
    v_mfma_f32_16x16x32_bf16 v[124:127], a[108:111], a[188:191], v[124:127]
    v_exp_f32 v58, v58
    v_mfma_f32_16x16x32_bf16 v[124:127], a[104:107], a[184:187], v[124:127]
    ds_read_b128 a[168:171], v6 offset:36864
    v_cvt_pk_bf16_f32 v84, v56, v57
    v_mfma_f32_16x16x32_bf16 v[124:127], a[100:103], a[180:183], v[124:127]
    v_exp_f32 v59, v59
    v_mfma_f32_16x16x32_bf16 v[124:127], a[96:99], a[176:179], v[124:127]
    ds_read_b128 a[172:175], v6 offset:38912
    v_cvt_pk_bf16_f32 v85, v58, v59
    v_smfmac_f32_16x16x64_bf16 v[28:31], a[192:195], v[72:79], v24
    v_cvt_pk_bf16_f32 v99, v102, v103
    v_mfma_f32_16x16x32_bf16 v[48:51], v[224:227], a[128:131], -4.0
    v_exp_f32 v60, v60
    v_mfma_f32_16x16x32_bf16 v[48:51], v[228:231], a[132:135], v[48:51]
    buffer_store_dwordx4 v[96:99], v2, s[24:27], s31 offen sc1
    v_mfma_f32_16x16x32_bf16 v[48:51], v[232:235], a[136:139], v[48:51]
    s_add_u32 s31, s31, 4096
    v_exp_f32 v61, v61
    v_mfma_f32_16x16x32_bf16 v[48:51], v[236:239], a[140:143], v[48:51]
    ds_read_b128 a[176:179], v6 offset:33792
    v_cvt_pk_bf16_f32 v86, v60, v61
    v_mfma_f32_16x16x32_bf16 v[52:55], v[252:255], a[140:143], -4.0
    v_exp_f32 v62, v62
    v_mfma_f32_16x16x32_bf16 v[52:55], v[248:251], a[136:139], v[52:55]
    v_mul_f32 v21, -v16, v13
    v_fma_f32 v104, v104, v13, v21
    v_mfma_f32_16x16x32_bf16 v[52:55], v[244:247], a[132:135], v[52:55]
    v_exp_f32 v63, v63
    v_mfma_f32_16x16x32_bf16 v[52:55], v[240:243], a[128:131], v[52:55]
    s_waitcnt lgkmcnt(1)
    ds_read_b128 a[180:183], v6 offset:35840
    v_cvt_pk_bf16_f32 v87, v62, v63
    v_mfma_f32_16x16x32_bf16 v[112:115], a[48:51], a[160:163], v[112:115]
    v_exp_f32 v48, v48
    v_mfma_f32_16x16x32_bf16 v[112:115], a[52:55], a[164:167], v[112:115]
    ds_write_b128 v3, v[84:87] offset:5120
    v_mfma_f32_16x16x32_bf16 v[112:115], a[56:59], a[168:171], v[112:115]
    v_exp_f32 v49, v49
    v_mfma_f32_16x16x32_bf16 v[112:115], a[60:63], a[172:175], v[112:115]
    v_fma_f32 v105, v105, v13, v21
    v_fma_f32 v106, v106, v13, v21
    v_mfma_f32_16x16x32_bf16 v[116:119], a[124:127], a[172:175], v[116:119]
    v_exp_f32 v50, v50
    v_mfma_f32_16x16x32_bf16 v[116:119], a[120:123], a[168:171], v[116:119]
    ds_read_b128 a[184:187], v6 offset:37888
    v_cvt_pk_bf16_f32 v88, v48, v49
    v_mfma_f32_16x16x32_bf16 v[116:119], a[116:119], a[164:167], v[116:119]
    v_exp_f32 v51, v51
    v_mfma_f32_16x16x32_bf16 v[116:119], a[112:115], a[160:163], v[116:119]
    ds_read_b128 a[188:191], v6 offset:39936
    v_cvt_pk_bf16_f32 v89, v50, v51
    v_mfma_f32_16x16x32_bf16 v[56:59], v[224:227], a[144:147], -4.0
    v_exp_f32 v52, v52
    v_mfma_f32_16x16x32_bf16 v[56:59], v[228:231], a[148:151], v[56:59]
    v_fma_f32 v107, v107, v13, v21
    v_fma_f32 v108, v108, v13, v21
    v_mfma_f32_16x16x32_bf16 v[56:59], v[232:235], a[152:155], v[56:59]
    v_exp_f32 v53, v53
    v_mfma_f32_16x16x32_bf16 v[56:59], v[236:239], a[156:159], v[56:59]
    ds_read_b128 a[128:131], v7 offset:24576
    v_cvt_pk_bf16_f32 v90, v52, v53
    v_mfma_f32_16x16x32_bf16 v[60:63], v[252:255], a[156:159], -4.0
    v_exp_f32 v54, v54
    v_mfma_f32_16x16x32_bf16 v[60:63], v[248:251], a[152:155], v[60:63]
    ds_read_b128 a[132:135], v0 offset:24576
    ds_read_b128 a[136:139], v15 offset:24576
    v_mfma_f32_16x16x32_bf16 v[60:63], v[244:247], a[148:151], v[60:63]
    v_exp_f32 v55, v55
    v_mfma_f32_16x16x32_bf16 v[60:63], v[240:243], a[144:147], v[60:63]
    s_waitcnt lgkmcnt(3)
    ds_read_b128 a[140:143], v25 offset:24576
    v_cvt_pk_bf16_f32 v91, v54, v55
    v_mfma_f32_16x16x32_bf16 v[120:123], a[48:51], a[176:179], v[120:123]
    v_exp_f32 v56, v56
    v_mfma_f32_16x16x32_bf16 v[120:123], a[52:55], a[180:183], v[120:123]
    ds_write_b128 v3, v[88:91] offset:6144
    v_mfma_f32_16x16x32_bf16 v[120:123], a[56:59], a[184:187], v[120:123]
    v_exp_f32 v57, v57
    v_mfma_f32_16x16x32_bf16 v[120:123], a[60:63], a[188:191], v[120:123]
    v_fma_f32 v109, v109, v13, v21
    v_fma_f32 v110, v110, v13, v21
    v_mfma_f32_16x16x32_bf16 v[124:127], a[124:127], a[188:191], v[124:127]
    v_exp_f32 v58, v58
    v_mfma_f32_16x16x32_bf16 v[124:127], a[120:123], a[184:187], v[124:127]
    ds_read_b128 a[144:147], v7 offset:28672
    v_cvt_pk_bf16_f32 v92, v56, v57
    v_mfma_f32_16x16x32_bf16 v[124:127], a[116:119], a[180:183], v[124:127]
    v_exp_f32 v59, v59
    v_mfma_f32_16x16x32_bf16 v[124:127], a[112:115], a[176:179], v[124:127]
    ds_read_b128 a[148:151], v0 offset:28672
    v_cvt_pk_bf16_f32 v93, v58, v59
    v_smfmac_f32_16x16x64_bf16 v[28:31], a[192:195], v[80:87], v24
    s_waitcnt lgkmcnt(3)
    v_fma_f32 v111, v111, v13, v21
    v_mfma_f32_16x16x32_bf16 v[48:51], v[128:131], a[128:131], -4.0
    v_exp_f32 v60, v60
    v_mfma_f32_16x16x32_bf16 v[48:51], v[132:135], a[132:135], v[48:51]
    v_cvt_pk_bf16_f32 v104, v104, v105
    v_cvt_pk_bf16_f32 v105, v106, v107
    v_mfma_f32_16x16x32_bf16 v[48:51], v[136:139], a[136:139], v[48:51]
    v_exp_f32 v61, v61
    v_mfma_f32_16x16x32_bf16 v[48:51], v[140:143], a[140:143], v[48:51]
    ds_read_b128 a[152:155], v15 offset:28672
    v_cvt_pk_bf16_f32 v94, v60, v61
    v_mfma_f32_16x16x32_bf16 v[52:55], v[156:159], a[140:143], -4.0
    s_add_u32 m0, s32, 16384
    v_exp_f32 v62, v62
    v_mfma_f32_16x16x32_bf16 v[52:55], v[152:155], a[136:139], v[52:55]
    buffer_load_dwordx4 v1, s[12:15], s30 offen lds
    v_mfma_f32_16x16x32_bf16 v[52:55], v[148:151], a[132:135], v[52:55]
    s_add_u32 s30, s30, 4096
    v_exp_f32 v63, v63
    v_mfma_f32_16x16x32_bf16 v[52:55], v[144:147], a[128:131], v[52:55]
    ds_read_b128 a[156:159], v25 offset:28672
    v_cvt_pk_bf16_f32 v95, v62, v63
    v_mfma_f32_16x16x32_bf16 v[96:99], a[12:15], v[88:91], v[16:19]
    v_exp_f32 v48, v48
    v_mfma_f32_16x16x32_bf16 v[96:99], a[8:11], v[80:83], v[96:99]
    ds_write_b128 v3, v[92:95] offset:7168
    v_mfma_f32_16x16x32_bf16 v[96:99], a[4:7], v[72:75], v[96:99]
    v_exp_f32 v49, v49
    v_mfma_f32_16x16x32_bf16 v[96:99], a[0:3], v[64:67], v[96:99]
    s_waitcnt vmcnt(6)
    ds_inc_u32 v9, v24 offset:4096
    v_mfma_f32_16x16x32_bf16 v[100:103], a[64:67], v[64:67], v[16:19]
    s_add_u32 s46, s46, 8
    v_exp_f32 v50, v50
    v_mfma_f32_16x16x32_bf16 v[100:103], a[68:71], v[72:75], v[100:103]
    v_cvt_pk_bf16_f32 v64, v48, v49
    v_cvt_pk_bf16_f32 v106, v108, v109
    v_mfma_f32_16x16x32_bf16 v[100:103], a[72:75], v[80:83], v[100:103]
    v_exp_f32 v51, v51
    v_mfma_f32_16x16x32_bf16 v[100:103], a[76:79], v[88:91], v[100:103]
    s_waitcnt lgkmcnt(2)
    v_cvt_pk_bf16_f32 v65, v50, v51
    v_cvt_pk_bf16_f32 v107, v110, v111
    v_mfma_f32_16x16x32_bf16 v[56:59], v[128:131], a[144:147], -4.0
    v_exp_f32 v52, v52
    v_mfma_f32_16x16x32_bf16 v[56:59], v[132:135], a[148:151], v[56:59]
    buffer_store_dwordx4 v[104:107], v2, s[24:27], s31 offen sc1
    v_mfma_f32_16x16x32_bf16 v[56:59], v[136:139], a[152:155], v[56:59]
    s_add_u32 s31, s31, 4096
    v_exp_f32 v53, v53
    v_mfma_f32_16x16x32_bf16 v[56:59], v[140:143], a[156:159], v[56:59]
    v_cvt_pk_bf16_f32 v66, v52, v53
    v_max_u32 v11, v11, v20
    v_mfma_f32_16x16x32_bf16 v[60:63], v[156:159], a[156:159], -4.0
    v_exp_f32 v54, v54
    v_mfma_f32_16x16x32_bf16 v[60:63], v[152:155], a[152:155], v[60:63]
    ds_read_b32 v14, v9 offset:4096
    ds_read_b128 v[20:23], v9 offset:512
    v_mfma_f32_16x16x32_bf16 v[60:63], v[148:151], a[148:151], v[60:63]
    v_exp_f32 v55, v55
    v_mfma_f32_16x16x32_bf16 v[60:63], v[144:147], a[144:147], v[60:63]
    ds_read_b128 a[160:163], v4 offset:0
    v_cvt_pk_bf16_f32 v67, v54, v55
    v_mfma_f32_16x16x32_bf16 v[104:107], a[12:15], v[92:95], v[16:19]
    v_exp_f32 v56, v56
    v_mfma_f32_16x16x32_bf16 v[104:107], a[8:11], v[84:87], v[104:107]
    ds_read_b128 a[164:167], v4 offset:2048
    ds_read_b128 a[168:171], v4 offset:4096
    v_mfma_f32_16x16x32_bf16 v[104:107], a[4:7], v[76:79], v[104:107]
    s_add_u32 m0, s32, 20480
    v_exp_f32 v57, v57
    v_mfma_f32_16x16x32_bf16 v[104:107], a[0:3], v[68:71], v[104:107]
    buffer_load_dwordx4 v1, s[12:15], s30 offen lds
    v_mfma_f32_16x16x32_bf16 v[108:111], a[64:67], v[68:71], v[16:19]
    s_add_u32 s30, s30, 4096
    v_exp_f32 v58, v58
    v_mfma_f32_16x16x32_bf16 v[108:111], a[68:71], v[76:79], v[108:111]
    s_waitcnt lgkmcnt(4)
    v_cvt_pk_bf16_f32 v68, v56, v57
    v_cmp_gt_u32 vcc, s46, v14
    v_mfma_f32_16x16x32_bf16 v[108:111], a[72:75], v[84:87], v[108:111]
    v_exp_f32 v59, v59
    v_mfma_f32_16x16x32_bf16 v[108:111], a[76:79], v[92:95], v[108:111]
    ds_read_b128 a[172:175], v4 offset:6144
    v_cvt_pk_bf16_f32 v69, v58, v59
    v_smfmac_f32_16x16x64_bf16 v[28:31], a[192:195], v[88:95], v24
    s_cbranch_vccnz L_lateL1
L_backL1:
    s_waitcnt lgkmcnt(3)
    v_add_f32 v20, v20, v21
    v_mfma_f32_16x16x32_bf16 v[48:51], v[160:163], a[128:131], -4.0
    v_exp_f32 v60, v60
    v_mfma_f32_16x16x32_bf16 v[48:51], v[164:167], a[132:135], v[48:51]
    ds_write_b128 v3, v[64:67] offset:32768
    v_mfma_f32_16x16x32_bf16 v[48:51], v[168:171], a[136:139], v[48:51]
    v_exp_f32 v61, v61
    v_mfma_f32_16x16x32_bf16 v[48:51], v[172:175], a[140:143], v[48:51]
    ds_read_b128 a[176:179], v4 offset:1024
    v_cvt_pk_bf16_f32 v70, v60, v61
    v_mfma_f32_16x16x32_bf16 v[52:55], v[188:191], a[140:143], -4.0
    v_exp_f32 v62, v62
    v_mfma_f32_16x16x32_bf16 v[52:55], v[184:187], a[136:139], v[52:55]
    v_add_f32 v22, v22, v23
    v_add_f32 v20, v20, v22
    v_mfma_f32_16x16x32_bf16 v[52:55], v[180:183], a[132:135], v[52:55]
    v_exp_f32 v63, v63
    v_mfma_f32_16x16x32_bf16 v[52:55], v[176:179], a[128:131], v[52:55]
    ds_read_b128 a[180:183], v4 offset:3072
    v_cvt_pk_bf16_f32 v71, v62, v63
    v_mfma_f32_16x16x32_bf16 v[96:99], a[16:19], a[160:163], v[96:99]
    s_waitcnt lgkmcnt(3)
    v_exp_f32 v48, v48
    v_mfma_f32_16x16x32_bf16 v[96:99], a[20:23], a[164:167], v[96:99]
    ds_write_b128 v3, v[68:71] offset:33792
    v_mfma_f32_16x16x32_bf16 v[96:99], a[24:27], a[168:171], v[96:99]
    v_exp_f32 v49, v49
    v_mfma_f32_16x16x32_bf16 v[96:99], a[28:31], a[172:175], v[96:99]
    v_rcp_f32 v12, v20
    v_mfma_f32_16x16x32_bf16 v[100:103], a[92:95], a[172:175], v[100:103]
    v_exp_f32 v50, v50
    v_mfma_f32_16x16x32_bf16 v[100:103], a[88:91], a[168:171], v[100:103]
    ds_read_b128 a[184:187], v4 offset:5120
    v_cvt_pk_bf16_f32 v72, v48, v49
    v_mfma_f32_16x16x32_bf16 v[100:103], a[84:87], a[164:167], v[100:103]
    v_exp_f32 v51, v51
    v_mfma_f32_16x16x32_bf16 v[100:103], a[80:83], a[160:163], v[100:103]
    ds_read_b128 a[188:191], v4 offset:7168
    v_cvt_pk_bf16_f32 v73, v50, v51
    v_mfma_f32_16x16x32_bf16 v[56:59], v[160:163], a[144:147], -4.0
    v_exp_f32 v52, v52
    v_mfma_f32_16x16x32_bf16 v[56:59], v[164:167], a[148:151], v[56:59]
    v_add_f32 v14, v28, v29
    v_mov_b64 v[28:29], 0
    v_mfma_f32_16x16x32_bf16 v[56:59], v[168:171], a[152:155], v[56:59]
    v_exp_f32 v53, v53
    v_mfma_f32_16x16x32_bf16 v[56:59], v[172:175], a[156:159], v[56:59]
    ds_read_b128 a[160:163], v5 offset:0
    v_cvt_pk_bf16_f32 v74, v52, v53
    v_mfma_f32_16x16x32_bf16 v[60:63], v[188:191], a[156:159], -4.0
    v_exp_f32 v54, v54
    v_mfma_f32_16x16x32_bf16 v[60:63], v[184:187], a[152:155], v[60:63]
    v_mov_b32 v13, v12
    v_min_f32 v10, v10, v20
    v_mfma_f32_16x16x32_bf16 v[60:63], v[180:183], a[148:151], v[60:63]
    v_exp_f32 v55, v55
    v_mfma_f32_16x16x32_bf16 v[60:63], v[176:179], a[144:147], v[60:63]
    s_waitcnt lgkmcnt(1)
    ds_read_b128 a[164:167], v5 offset:2048
    v_cvt_pk_bf16_f32 v75, v54, v55
    v_mfma_f32_16x16x32_bf16 v[104:107], a[16:19], a[176:179], v[104:107]
    v_exp_f32 v56, v56
    v_mfma_f32_16x16x32_bf16 v[104:107], a[20:23], a[180:183], v[104:107]
    ds_write_b128 v3, v[72:75] offset:34816
    v_mfma_f32_16x16x32_bf16 v[104:107], a[24:27], a[184:187], v[104:107]
    v_exp_f32 v57, v57
    v_mfma_f32_16x16x32_bf16 v[104:107], a[28:31], a[188:191], v[104:107]
    v_permlane32_swap_b32 v12, v13
    v_mul_f32 v21, -v16, v12
    v_mfma_f32_16x16x32_bf16 v[108:111], a[92:95], a[188:191], v[108:111]
    v_exp_f32 v58, v58
    v_mfma_f32_16x16x32_bf16 v[108:111], a[88:91], a[184:187], v[108:111]
    ds_read_b128 a[168:171], v5 offset:4096
    v_cvt_pk_bf16_f32 v76, v56, v57
    v_mfma_f32_16x16x32_bf16 v[108:111], a[84:87], a[180:183], v[108:111]
    v_exp_f32 v59, v59
    v_mfma_f32_16x16x32_bf16 v[108:111], a[80:83], a[176:179], v[108:111]
    ds_read_b128 a[172:175], v5 offset:6144
    v_cvt_pk_bf16_f32 v77, v58, v59
    v_smfmac_f32_16x16x64_bf16 v[28:31], a[192:195], v[64:71], v24
    v_fma_f32 v112, v112, v12, v21
    v_mfma_f32_16x16x32_bf16 v[48:51], v[192:195], a[128:131], -4.0
    v_exp_f32 v60, v60
    v_mfma_f32_16x16x32_bf16 v[48:51], v[196:199], a[132:135], v[48:51]
    ds_write_b32 v8, v14 offset:0
    v_mfma_f32_16x16x32_bf16 v[48:51], v[200:203], a[136:139], v[48:51]
    v_exp_f32 v61, v61
    v_mfma_f32_16x16x32_bf16 v[48:51], v[204:207], a[140:143], v[48:51]
    ds_read_b128 a[176:179], v5 offset:1024
    v_cvt_pk_bf16_f32 v78, v60, v61
    v_mfma_f32_16x16x32_bf16 v[52:55], v[220:223], a[140:143], -4.0
    v_exp_f32 v62, v62
    v_mfma_f32_16x16x32_bf16 v[52:55], v[216:219], a[136:139], v[52:55]
    v_fma_f32 v113, v113, v12, v21
    v_fma_f32 v114, v114, v12, v21
    v_mfma_f32_16x16x32_bf16 v[52:55], v[212:215], a[132:135], v[52:55]
    v_exp_f32 v63, v63
    v_mfma_f32_16x16x32_bf16 v[52:55], v[208:211], a[128:131], v[52:55]
    s_waitcnt lgkmcnt(2)
    ds_read_b128 a[180:183], v5 offset:3072
    v_cvt_pk_bf16_f32 v79, v62, v63
    v_mfma_f32_16x16x32_bf16 v[96:99], a[32:35], a[160:163], v[96:99]
    v_exp_f32 v48, v48
    v_mfma_f32_16x16x32_bf16 v[96:99], a[36:39], a[164:167], v[96:99]
    ds_write_b128 v3, v[76:79] offset:35840
    v_mfma_f32_16x16x32_bf16 v[96:99], a[40:43], a[168:171], v[96:99]
    v_exp_f32 v49, v49
    v_mfma_f32_16x16x32_bf16 v[96:99], a[44:47], a[172:175], v[96:99]
    v_fma_f32 v115, v115, v12, v21
    v_fma_f32 v116, v116, v12, v21
    v_mfma_f32_16x16x32_bf16 v[100:103], a[108:111], a[172:175], v[100:103]
    v_exp_f32 v50, v50
    v_mfma_f32_16x16x32_bf16 v[100:103], a[104:107], a[168:171], v[100:103]
    ds_read_b128 a[184:187], v5 offset:5120
    v_cvt_pk_bf16_f32 v80, v48, v49
    v_mfma_f32_16x16x32_bf16 v[100:103], a[100:103], a[164:167], v[100:103]
    v_exp_f32 v51, v51
    v_mfma_f32_16x16x32_bf16 v[100:103], a[96:99], a[160:163], v[100:103]
    ds_read_b128 a[188:191], v5 offset:7168
    v_cvt_pk_bf16_f32 v81, v50, v51
    v_mfma_f32_16x16x32_bf16 v[56:59], v[192:195], a[144:147], -4.0
    v_exp_f32 v52, v52
    v_mfma_f32_16x16x32_bf16 v[56:59], v[196:199], a[148:151], v[56:59]
    v_fma_f32 v117, v117, v12, v21
    v_fma_f32 v118, v118, v12, v21
    v_mfma_f32_16x16x32_bf16 v[56:59], v[200:203], a[152:155], v[56:59]
    v_exp_f32 v53, v53
    v_mfma_f32_16x16x32_bf16 v[56:59], v[204:207], a[156:159], v[56:59]
    ds_read_b128 a[160:163], v6 offset:0
    v_cvt_pk_bf16_f32 v82, v52, v53
    v_mfma_f32_16x16x32_bf16 v[60:63], v[220:223], a[156:159], -4.0
    v_exp_f32 v54, v54
    v_mfma_f32_16x16x32_bf16 v[60:63], v[216:219], a[152:155], v[60:63]
    v_fma_f32 v119, v119, v12, v21
    v_cvt_pk_bf16_f32 v112, v112, v113
    v_mfma_f32_16x16x32_bf16 v[60:63], v[212:215], a[148:151], v[60:63]
    v_exp_f32 v55, v55
    v_mfma_f32_16x16x32_bf16 v[60:63], v[208:211], a[144:147], v[60:63]
    s_waitcnt lgkmcnt(1)
    ds_read_b128 a[164:167], v6 offset:2048
    v_cvt_pk_bf16_f32 v83, v54, v55
    v_mfma_f32_16x16x32_bf16 v[104:107], a[32:35], a[176:179], v[104:107]
    v_exp_f32 v56, v56
    v_mfma_f32_16x16x32_bf16 v[104:107], a[36:39], a[180:183], v[104:107]
    ds_write_b128 v3, v[80:83] offset:36864
    v_mfma_f32_16x16x32_bf16 v[104:107], a[40:43], a[184:187], v[104:107]
    v_exp_f32 v57, v57
    v_mfma_f32_16x16x32_bf16 v[104:107], a[44:47], a[188:191], v[104:107]
    v_cvt_pk_bf16_f32 v113, v114, v115
    v_cvt_pk_bf16_f32 v114, v116, v117
    v_mfma_f32_16x16x32_bf16 v[108:111], a[108:111], a[188:191], v[108:111]
    v_exp_f32 v58, v58
    v_mfma_f32_16x16x32_bf16 v[108:111], a[104:107], a[184:187], v[108:111]
    ds_read_b128 a[168:171], v6 offset:4096
    v_cvt_pk_bf16_f32 v84, v56, v57
    v_mfma_f32_16x16x32_bf16 v[108:111], a[100:103], a[180:183], v[108:111]
    v_exp_f32 v59, v59
    v_mfma_f32_16x16x32_bf16 v[108:111], a[96:99], a[176:179], v[108:111]
    ds_read_b128 a[172:175], v6 offset:6144
    v_cvt_pk_bf16_f32 v85, v58, v59
    v_smfmac_f32_16x16x64_bf16 v[28:31], a[192:195], v[72:79], v24
    v_cvt_pk_bf16_f32 v115, v118, v119
    v_mfma_f32_16x16x32_bf16 v[48:51], v[224:227], a[128:131], -4.0
    v_exp_f32 v60, v60
    v_mfma_f32_16x16x32_bf16 v[48:51], v[228:231], a[132:135], v[48:51]
    buffer_store_dwordx4 v[112:115], v2, s[24:27], s31 offen sc1
    v_mfma_f32_16x16x32_bf16 v[48:51], v[232:235], a[136:139], v[48:51]
    s_add_u32 s31, s31, 4096
    v_exp_f32 v61, v61
    v_mfma_f32_16x16x32_bf16 v[48:51], v[236:239], a[140:143], v[48:51]
    ds_read_b128 a[176:179], v6 offset:1024
    v_cvt_pk_bf16_f32 v86, v60, v61
    v_mfma_f32_16x16x32_bf16 v[52:55], v[252:255], a[140:143], -4.0
    v_exp_f32 v62, v62
    v_mfma_f32_16x16x32_bf16 v[52:55], v[248:251], a[136:139], v[52:55]
    v_mul_f32 v21, -v16, v13
    v_fma_f32 v120, v120, v13, v21
    v_mfma_f32_16x16x32_bf16 v[52:55], v[244:247], a[132:135], v[52:55]
    v_exp_f32 v63, v63
    v_mfma_f32_16x16x32_bf16 v[52:55], v[240:243], a[128:131], v[52:55]
    s_waitcnt lgkmcnt(1)
    ds_read_b128 a[180:183], v6 offset:3072
    v_cvt_pk_bf16_f32 v87, v62, v63
    v_mfma_f32_16x16x32_bf16 v[96:99], a[48:51], a[160:163], v[96:99]
    v_exp_f32 v48, v48
    v_mfma_f32_16x16x32_bf16 v[96:99], a[52:55], a[164:167], v[96:99]
    ds_write_b128 v3, v[84:87] offset:37888
    v_mfma_f32_16x16x32_bf16 v[96:99], a[56:59], a[168:171], v[96:99]
    v_exp_f32 v49, v49
    v_mfma_f32_16x16x32_bf16 v[96:99], a[60:63], a[172:175], v[96:99]
    v_fma_f32 v121, v121, v13, v21
    v_fma_f32 v122, v122, v13, v21
    v_mfma_f32_16x16x32_bf16 v[100:103], a[124:127], a[172:175], v[100:103]
    v_exp_f32 v50, v50
    v_mfma_f32_16x16x32_bf16 v[100:103], a[120:123], a[168:171], v[100:103]
    ds_read_b128 a[184:187], v6 offset:5120
    v_cvt_pk_bf16_f32 v88, v48, v49
    v_mfma_f32_16x16x32_bf16 v[100:103], a[116:119], a[164:167], v[100:103]
    v_exp_f32 v51, v51
    v_mfma_f32_16x16x32_bf16 v[100:103], a[112:115], a[160:163], v[100:103]
    ds_read_b128 a[188:191], v6 offset:7168
    v_cvt_pk_bf16_f32 v89, v50, v51
    v_mfma_f32_16x16x32_bf16 v[56:59], v[224:227], a[144:147], -4.0
    v_exp_f32 v52, v52
    v_mfma_f32_16x16x32_bf16 v[56:59], v[228:231], a[148:151], v[56:59]
    v_fma_f32 v123, v123, v13, v21
    v_fma_f32 v124, v124, v13, v21
    v_mfma_f32_16x16x32_bf16 v[56:59], v[232:235], a[152:155], v[56:59]
    v_exp_f32 v53, v53
    v_mfma_f32_16x16x32_bf16 v[56:59], v[236:239], a[156:159], v[56:59]
    ds_read_b128 a[128:131], v7 offset:0
    v_cvt_pk_bf16_f32 v90, v52, v53
    v_mfma_f32_16x16x32_bf16 v[60:63], v[252:255], a[156:159], -4.0
    v_exp_f32 v54, v54
    v_mfma_f32_16x16x32_bf16 v[60:63], v[248:251], a[152:155], v[60:63]
    ds_read_b128 a[132:135], v0 offset:0
    ds_read_b128 a[136:139], v15 offset:0
    v_mfma_f32_16x16x32_bf16 v[60:63], v[244:247], a[148:151], v[60:63]
    v_exp_f32 v55, v55
    v_mfma_f32_16x16x32_bf16 v[60:63], v[240:243], a[144:147], v[60:63]
    s_waitcnt lgkmcnt(3)
    ds_read_b128 a[140:143], v25 offset:0
    v_cvt_pk_bf16_f32 v91, v54, v55
    v_mfma_f32_16x16x32_bf16 v[104:107], a[48:51], a[176:179], v[104:107]
    v_exp_f32 v56, v56
    v_mfma_f32_16x16x32_bf16 v[104:107], a[52:55], a[180:183], v[104:107]
    ds_write_b128 v3, v[88:91] offset:38912
    v_mfma_f32_16x16x32_bf16 v[104:107], a[56:59], a[184:187], v[104:107]
    v_exp_f32 v57, v57
    v_mfma_f32_16x16x32_bf16 v[104:107], a[60:63], a[188:191], v[104:107]
    v_fma_f32 v125, v125, v13, v21
    v_fma_f32 v126, v126, v13, v21
    v_mfma_f32_16x16x32_bf16 v[108:111], a[124:127], a[188:191], v[108:111]
    v_exp_f32 v58, v58
    v_mfma_f32_16x16x32_bf16 v[108:111], a[120:123], a[184:187], v[108:111]
    ds_read_b128 a[144:147], v7 offset:4096
    v_cvt_pk_bf16_f32 v92, v56, v57
    v_mfma_f32_16x16x32_bf16 v[108:111], a[116:119], a[180:183], v[108:111]
    v_exp_f32 v59, v59
    v_mfma_f32_16x16x32_bf16 v[108:111], a[112:115], a[176:179], v[108:111]
    ds_read_b128 a[148:151], v0 offset:4096
    v_cvt_pk_bf16_f32 v93, v58, v59
    v_smfmac_f32_16x16x64_bf16 v[28:31], a[192:195], v[80:87], v24
    s_waitcnt lgkmcnt(3)
    v_fma_f32 v127, v127, v13, v21
    v_mfma_f32_16x16x32_bf16 v[48:51], v[128:131], a[128:131], -4.0
    v_exp_f32 v60, v60
    v_mfma_f32_16x16x32_bf16 v[48:51], v[132:135], a[132:135], v[48:51]
    v_cvt_pk_bf16_f32 v120, v120, v121
    v_cvt_pk_bf16_f32 v121, v122, v123
    v_mfma_f32_16x16x32_bf16 v[48:51], v[136:139], a[136:139], v[48:51]
    v_exp_f32 v61, v61
    v_mfma_f32_16x16x32_bf16 v[48:51], v[140:143], a[140:143], v[48:51]
    ds_read_b128 a[152:155], v15 offset:4096
    v_cvt_pk_bf16_f32 v94, v60, v61
    v_mfma_f32_16x16x32_bf16 v[52:55], v[156:159], a[140:143], -4.0
    s_add_u32 m0, s32, 24576
    v_exp_f32 v62, v62
    v_mfma_f32_16x16x32_bf16 v[52:55], v[152:155], a[136:139], v[52:55]
    buffer_load_dwordx4 v1, s[12:15], s30 offen lds
    v_mfma_f32_16x16x32_bf16 v[52:55], v[148:151], a[132:135], v[52:55]
    s_add_u32 s30, s30, 4096
    v_exp_f32 v63, v63
    v_mfma_f32_16x16x32_bf16 v[52:55], v[144:147], a[128:131], v[52:55]
    ds_read_b128 a[156:159], v25 offset:4096
    v_cvt_pk_bf16_f32 v95, v62, v63
    v_mfma_f32_16x16x32_bf16 v[112:115], a[12:15], v[88:91], v[16:19]
    v_exp_f32 v48, v48
    v_mfma_f32_16x16x32_bf16 v[112:115], a[8:11], v[80:83], v[112:115]
    ds_write_b128 v3, v[92:95] offset:39936
    v_mfma_f32_16x16x32_bf16 v[112:115], a[4:7], v[72:75], v[112:115]
    v_exp_f32 v49, v49
    v_mfma_f32_16x16x32_bf16 v[112:115], a[0:3], v[64:67], v[112:115]
    s_waitcnt vmcnt(6)
    ds_inc_u32 v9, v24 offset:4096
    v_mfma_f32_16x16x32_bf16 v[116:119], a[64:67], v[64:67], v[16:19]
    s_add_u32 s46, s46, 8
    v_exp_f32 v50, v50
    v_mfma_f32_16x16x32_bf16 v[116:119], a[68:71], v[72:75], v[116:119]
    v_cvt_pk_bf16_f32 v64, v48, v49
    v_cvt_pk_bf16_f32 v122, v124, v125
    v_mfma_f32_16x16x32_bf16 v[116:119], a[72:75], v[80:83], v[116:119]
    v_exp_f32 v51, v51
    v_mfma_f32_16x16x32_bf16 v[116:119], a[76:79], v[88:91], v[116:119]
    s_waitcnt lgkmcnt(2)
    v_cvt_pk_bf16_f32 v65, v50, v51
    v_cvt_pk_bf16_f32 v123, v126, v127
    v_mfma_f32_16x16x32_bf16 v[56:59], v[128:131], a[144:147], -4.0
    v_exp_f32 v52, v52
    v_mfma_f32_16x16x32_bf16 v[56:59], v[132:135], a[148:151], v[56:59]
    buffer_store_dwordx4 v[120:123], v2, s[24:27], s31 offen sc1
    v_mfma_f32_16x16x32_bf16 v[56:59], v[136:139], a[152:155], v[56:59]
    s_add_u32 s31, s31, 4096
    v_exp_f32 v53, v53
    v_mfma_f32_16x16x32_bf16 v[56:59], v[140:143], a[156:159], v[56:59]
    v_cvt_pk_bf16_f32 v66, v52, v53
    v_max_u32 v11, v11, v20
    v_mfma_f32_16x16x32_bf16 v[60:63], v[156:159], a[156:159], -4.0
    v_exp_f32 v54, v54
    v_mfma_f32_16x16x32_bf16 v[60:63], v[152:155], a[152:155], v[60:63]
    ds_read_b32 v14, v9 offset:4096
    ds_read_b128 v[20:23], v9 offset:0
    v_mfma_f32_16x16x32_bf16 v[60:63], v[148:151], a[148:151], v[60:63]
    v_exp_f32 v55, v55
    v_mfma_f32_16x16x32_bf16 v[60:63], v[144:147], a[144:147], v[60:63]
    ds_read_b128 a[160:163], v4 offset:32768
    v_cvt_pk_bf16_f32 v67, v54, v55
    v_mfma_f32_16x16x32_bf16 v[120:123], a[12:15], v[92:95], v[16:19]
    v_exp_f32 v56, v56
    v_mfma_f32_16x16x32_bf16 v[120:123], a[8:11], v[84:87], v[120:123]
    ds_read_b128 a[164:167], v4 offset:34816
    ds_read_b128 a[168:171], v4 offset:36864
    v_mfma_f32_16x16x32_bf16 v[120:123], a[4:7], v[76:79], v[120:123]
    s_add_u32 m0, s32, 28672
    v_exp_f32 v57, v57
    v_mfma_f32_16x16x32_bf16 v[120:123], a[0:3], v[68:71], v[120:123]
    buffer_load_dwordx4 v1, s[12:15], s30 offen lds
    v_mfma_f32_16x16x32_bf16 v[124:127], a[64:67], v[68:71], v[16:19]
    s_add_u32 s30, s30, 4096
    v_exp_f32 v58, v58
    v_mfma_f32_16x16x32_bf16 v[124:127], a[68:71], v[76:79], v[124:127]
    s_waitcnt lgkmcnt(4)
    v_cvt_pk_bf16_f32 v68, v56, v57
    v_cmp_gt_u32 vcc, s46, v14
    v_mfma_f32_16x16x32_bf16 v[124:127], a[72:75], v[84:87], v[124:127]
    v_exp_f32 v59, v59
    v_mfma_f32_16x16x32_bf16 v[124:127], a[76:79], v[92:95], v[124:127]
    ds_read_b128 a[172:175], v4 offset:38912
    v_cvt_pk_bf16_f32 v69, v58, v59
    v_smfmac_f32_16x16x64_bf16 v[28:31], a[192:195], v[88:95], v24
    s_cbranch_vccnz L_lateL2
L_backL2:
    s_waitcnt lgkmcnt(3)
    v_add_f32 v20, v20, v21
    v_mfma_f32_16x16x32_bf16 v[48:51], v[160:163], a[128:131], -4.0
    v_exp_f32 v60, v60
    v_mfma_f32_16x16x32_bf16 v[48:51], v[164:167], a[132:135], v[48:51]
    ds_write_b128 v3, v[64:67] offset:0
    v_mfma_f32_16x16x32_bf16 v[48:51], v[168:171], a[136:139], v[48:51]
    v_exp_f32 v61, v61
    v_mfma_f32_16x16x32_bf16 v[48:51], v[172:175], a[140:143], v[48:51]
    ds_read_b128 a[176:179], v4 offset:33792
    v_cvt_pk_bf16_f32 v70, v60, v61
    v_mfma_f32_16x16x32_bf16 v[52:55], v[188:191], a[140:143], -4.0
    v_exp_f32 v62, v62
    v_mfma_f32_16x16x32_bf16 v[52:55], v[184:187], a[136:139], v[52:55]
    v_add_f32 v22, v22, v23
    v_add_f32 v20, v20, v22
    v_mfma_f32_16x16x32_bf16 v[52:55], v[180:183], a[132:135], v[52:55]
    v_exp_f32 v63, v63
    v_mfma_f32_16x16x32_bf16 v[52:55], v[176:179], a[128:131], v[52:55]
    ds_read_b128 a[180:183], v4 offset:35840
    v_cvt_pk_bf16_f32 v71, v62, v63
    v_mfma_f32_16x16x32_bf16 v[112:115], a[16:19], a[160:163], v[112:115]
    s_waitcnt lgkmcnt(3)
    v_exp_f32 v48, v48
    v_mfma_f32_16x16x32_bf16 v[112:115], a[20:23], a[164:167], v[112:115]
    ds_write_b128 v3, v[68:71] offset:1024
    v_mfma_f32_16x16x32_bf16 v[112:115], a[24:27], a[168:171], v[112:115]
    v_exp_f32 v49, v49
    v_mfma_f32_16x16x32_bf16 v[112:115], a[28:31], a[172:175], v[112:115]
    v_rcp_f32 v12, v20
    v_mfma_f32_16x16x32_bf16 v[116:119], a[92:95], a[172:175], v[116:119]
    v_exp_f32 v50, v50
    v_mfma_f32_16x16x32_bf16 v[116:119], a[88:91], a[168:171], v[116:119]
    ds_read_b128 a[184:187], v4 offset:37888
    v_cvt_pk_bf16_f32 v72, v48, v49
    v_mfma_f32_16x16x32_bf16 v[116:119], a[84:87], a[164:167], v[116:119]
    v_exp_f32 v51, v51
    v_mfma_f32_16x16x32_bf16 v[116:119], a[80:83], a[160:163], v[116:119]
    ds_read_b128 a[188:191], v4 offset:39936
    v_cvt_pk_bf16_f32 v73, v50, v51
    v_mfma_f32_16x16x32_bf16 v[56:59], v[160:163], a[144:147], -4.0
    v_exp_f32 v52, v52
    v_mfma_f32_16x16x32_bf16 v[56:59], v[164:167], a[148:151], v[56:59]
    v_add_f32 v14, v28, v29
    v_mov_b64 v[28:29], 0
    v_mfma_f32_16x16x32_bf16 v[56:59], v[168:171], a[152:155], v[56:59]
    v_exp_f32 v53, v53
    v_mfma_f32_16x16x32_bf16 v[56:59], v[172:175], a[156:159], v[56:59]
    ds_read_b128 a[160:163], v5 offset:32768
    v_cvt_pk_bf16_f32 v74, v52, v53
    v_mfma_f32_16x16x32_bf16 v[60:63], v[188:191], a[156:159], -4.0
    v_exp_f32 v54, v54
    v_mfma_f32_16x16x32_bf16 v[60:63], v[184:187], a[152:155], v[60:63]
    v_mov_b32 v13, v12
    v_min_f32 v10, v10, v20
    v_mfma_f32_16x16x32_bf16 v[60:63], v[180:183], a[148:151], v[60:63]
    v_exp_f32 v55, v55
    v_mfma_f32_16x16x32_bf16 v[60:63], v[176:179], a[144:147], v[60:63]
    s_waitcnt lgkmcnt(1)
    ds_read_b128 a[164:167], v5 offset:34816
    v_cvt_pk_bf16_f32 v75, v54, v55
    v_mfma_f32_16x16x32_bf16 v[120:123], a[16:19], a[176:179], v[120:123]
    v_exp_f32 v56, v56
    v_mfma_f32_16x16x32_bf16 v[120:123], a[20:23], a[180:183], v[120:123]
    ds_write_b128 v3, v[72:75] offset:2048
    v_mfma_f32_16x16x32_bf16 v[120:123], a[24:27], a[184:187], v[120:123]
    v_exp_f32 v57, v57
    v_mfma_f32_16x16x32_bf16 v[120:123], a[28:31], a[188:191], v[120:123]
    v_permlane32_swap_b32 v12, v13
    v_mul_f32 v21, -v16, v12
    v_mfma_f32_16x16x32_bf16 v[124:127], a[92:95], a[188:191], v[124:127]
    v_exp_f32 v58, v58
    v_mfma_f32_16x16x32_bf16 v[124:127], a[88:91], a[184:187], v[124:127]
    ds_read_b128 a[168:171], v5 offset:36864
    v_cvt_pk_bf16_f32 v76, v56, v57
    v_mfma_f32_16x16x32_bf16 v[124:127], a[84:87], a[180:183], v[124:127]
    v_exp_f32 v59, v59
    v_mfma_f32_16x16x32_bf16 v[124:127], a[80:83], a[176:179], v[124:127]
    ds_read_b128 a[172:175], v5 offset:38912
    v_cvt_pk_bf16_f32 v77, v58, v59
    v_smfmac_f32_16x16x64_bf16 v[28:31], a[192:195], v[64:71], v24
    v_fma_f32 v96, v96, v12, v21
    v_mfma_f32_16x16x32_bf16 v[48:51], v[192:195], a[128:131], -4.0
    v_exp_f32 v60, v60
    v_mfma_f32_16x16x32_bf16 v[48:51], v[196:199], a[132:135], v[48:51]
    ds_write_b32 v8, v14 offset:512
    v_mfma_f32_16x16x32_bf16 v[48:51], v[200:203], a[136:139], v[48:51]
    v_exp_f32 v61, v61
    v_mfma_f32_16x16x32_bf16 v[48:51], v[204:207], a[140:143], v[48:51]
    ds_read_b128 a[176:179], v5 offset:33792
    v_cvt_pk_bf16_f32 v78, v60, v61
    v_mfma_f32_16x16x32_bf16 v[52:55], v[220:223], a[140:143], -4.0
    v_exp_f32 v62, v62
    v_mfma_f32_16x16x32_bf16 v[52:55], v[216:219], a[136:139], v[52:55]
    v_fma_f32 v97, v97, v12, v21
    v_fma_f32 v98, v98, v12, v21
    v_mfma_f32_16x16x32_bf16 v[52:55], v[212:215], a[132:135], v[52:55]
    v_exp_f32 v63, v63
    v_mfma_f32_16x16x32_bf16 v[52:55], v[208:211], a[128:131], v[52:55]
    s_waitcnt lgkmcnt(2)
    ds_read_b128 a[180:183], v5 offset:35840
    v_cvt_pk_bf16_f32 v79, v62, v63
    v_mfma_f32_16x16x32_bf16 v[112:115], a[32:35], a[160:163], v[112:115]
    v_exp_f32 v48, v48
    v_mfma_f32_16x16x32_bf16 v[112:115], a[36:39], a[164:167], v[112:115]
    ds_write_b128 v3, v[76:79] offset:3072
    v_mfma_f32_16x16x32_bf16 v[112:115], a[40:43], a[168:171], v[112:115]
    v_exp_f32 v49, v49
    v_mfma_f32_16x16x32_bf16 v[112:115], a[44:47], a[172:175], v[112:115]
    v_fma_f32 v99, v99, v12, v21
    v_fma_f32 v100, v100, v12, v21
    v_mfma_f32_16x16x32_bf16 v[116:119], a[108:111], a[172:175], v[116:119]
    v_exp_f32 v50, v50
    v_mfma_f32_16x16x32_bf16 v[116:119], a[104:107], a[168:171], v[116:119]
    ds_read_b128 a[184:187], v5 offset:37888
    v_cvt_pk_bf16_f32 v80, v48, v49
    v_mfma_f32_16x16x32_bf16 v[116:119], a[100:103], a[164:167], v[116:119]
    v_exp_f32 v51, v51
    v_mfma_f32_16x16x32_bf16 v[116:119], a[96:99], a[160:163], v[116:119]
    ds_read_b128 a[188:191], v5 offset:39936
    v_cvt_pk_bf16_f32 v81, v50, v51
    v_mfma_f32_16x16x32_bf16 v[56:59], v[192:195], a[144:147], -4.0
    v_exp_f32 v52, v52
    v_mfma_f32_16x16x32_bf16 v[56:59], v[196:199], a[148:151], v[56:59]
    v_fma_f32 v101, v101, v12, v21
    v_fma_f32 v102, v102, v12, v21
    v_mfma_f32_16x16x32_bf16 v[56:59], v[200:203], a[152:155], v[56:59]
    v_exp_f32 v53, v53
    v_mfma_f32_16x16x32_bf16 v[56:59], v[204:207], a[156:159], v[56:59]
    ds_read_b128 a[160:163], v6 offset:32768
    v_cvt_pk_bf16_f32 v82, v52, v53
    v_mfma_f32_16x16x32_bf16 v[60:63], v[220:223], a[156:159], -4.0
    v_exp_f32 v54, v54
    v_mfma_f32_16x16x32_bf16 v[60:63], v[216:219], a[152:155], v[60:63]
    v_fma_f32 v103, v103, v12, v21
    v_cvt_pk_bf16_f32 v96, v96, v97
    v_mfma_f32_16x16x32_bf16 v[60:63], v[212:215], a[148:151], v[60:63]
    v_exp_f32 v55, v55
    v_mfma_f32_16x16x32_bf16 v[60:63], v[208:211], a[144:147], v[60:63]
    s_waitcnt lgkmcnt(1)
    ds_read_b128 a[164:167], v6 offset:34816
    v_cvt_pk_bf16_f32 v83, v54, v55
    v_mfma_f32_16x16x32_bf16 v[120:123], a[32:35], a[176:179], v[120:123]
    v_exp_f32 v56, v56
    v_mfma_f32_16x16x32_bf16 v[120:123], a[36:39], a[180:183], v[120:123]
    ds_write_b128 v3, v[80:83] offset:4096
    v_mfma_f32_16x16x32_bf16 v[120:123], a[40:43], a[184:187], v[120:123]
    v_exp_f32 v57, v57
    v_mfma_f32_16x16x32_bf16 v[120:123], a[44:47], a[188:191], v[120:123]
    v_cvt_pk_bf16_f32 v97, v98, v99
    v_cvt_pk_bf16_f32 v98, v100, v101
    v_mfma_f32_16x16x32_bf16 v[124:127], a[108:111], a[188:191], v[124:127]
    v_exp_f32 v58, v58
    v_mfma_f32_16x16x32_bf16 v[124:127], a[104:107], a[184:187], v[124:127]
    ds_read_b128 a[168:171], v6 offset:36864
    v_cvt_pk_bf16_f32 v84, v56, v57
    v_mfma_f32_16x16x32_bf16 v[124:127], a[100:103], a[180:183], v[124:127]
    v_exp_f32 v59, v59
    v_mfma_f32_16x16x32_bf16 v[124:127], a[96:99], a[176:179], v[124:127]
    ds_read_b128 a[172:175], v6 offset:38912
    v_cvt_pk_bf16_f32 v85, v58, v59
    v_smfmac_f32_16x16x64_bf16 v[28:31], a[192:195], v[72:79], v24
    v_cvt_pk_bf16_f32 v99, v102, v103
    v_mfma_f32_16x16x32_bf16 v[48:51], v[224:227], a[128:131], -4.0
    v_exp_f32 v60, v60
    v_mfma_f32_16x16x32_bf16 v[48:51], v[228:231], a[132:135], v[48:51]
    buffer_store_dwordx4 v[96:99], v2, s[24:27], s31 offen sc1
    v_mfma_f32_16x16x32_bf16 v[48:51], v[232:235], a[136:139], v[48:51]
    s_add_u32 s31, s31, 4096
    v_exp_f32 v61, v61
    v_mfma_f32_16x16x32_bf16 v[48:51], v[236:239], a[140:143], v[48:51]
    ds_read_b128 a[176:179], v6 offset:33792
    v_cvt_pk_bf16_f32 v86, v60, v61
    v_mfma_f32_16x16x32_bf16 v[52:55], v[252:255], a[140:143], -4.0
    v_exp_f32 v62, v62
    v_mfma_f32_16x16x32_bf16 v[52:55], v[248:251], a[136:139], v[52:55]
    v_mul_f32 v21, -v16, v13
    v_fma_f32 v104, v104, v13, v21
    v_mfma_f32_16x16x32_bf16 v[52:55], v[244:247], a[132:135], v[52:55]
    v_exp_f32 v63, v63
    v_mfma_f32_16x16x32_bf16 v[52:55], v[240:243], a[128:131], v[52:55]
    s_waitcnt lgkmcnt(1)
    ds_read_b128 a[180:183], v6 offset:35840
    v_cvt_pk_bf16_f32 v87, v62, v63
    v_mfma_f32_16x16x32_bf16 v[112:115], a[48:51], a[160:163], v[112:115]
    v_exp_f32 v48, v48
    v_mfma_f32_16x16x32_bf16 v[112:115], a[52:55], a[164:167], v[112:115]
    ds_write_b128 v3, v[84:87] offset:5120
    v_mfma_f32_16x16x32_bf16 v[112:115], a[56:59], a[168:171], v[112:115]
    v_exp_f32 v49, v49
    v_mfma_f32_16x16x32_bf16 v[112:115], a[60:63], a[172:175], v[112:115]
    v_fma_f32 v105, v105, v13, v21
    v_fma_f32 v106, v106, v13, v21
    v_mfma_f32_16x16x32_bf16 v[116:119], a[124:127], a[172:175], v[116:119]
    v_exp_f32 v50, v50
    v_mfma_f32_16x16x32_bf16 v[116:119], a[120:123], a[168:171], v[116:119]
    ds_read_b128 a[184:187], v6 offset:37888
    v_cvt_pk_bf16_f32 v88, v48, v49
    v_mfma_f32_16x16x32_bf16 v[116:119], a[116:119], a[164:167], v[116:119]
    v_exp_f32 v51, v51
    v_mfma_f32_16x16x32_bf16 v[116:119], a[112:115], a[160:163], v[116:119]
    ds_read_b128 a[188:191], v6 offset:39936
    v_cvt_pk_bf16_f32 v89, v50, v51
    v_mfma_f32_16x16x32_bf16 v[56:59], v[224:227], a[144:147], -4.0
    v_exp_f32 v52, v52
    v_mfma_f32_16x16x32_bf16 v[56:59], v[228:231], a[148:151], v[56:59]
    v_fma_f32 v107, v107, v13, v21
    v_fma_f32 v108, v108, v13, v21
    v_mfma_f32_16x16x32_bf16 v[56:59], v[232:235], a[152:155], v[56:59]
    v_exp_f32 v53, v53
    v_mfma_f32_16x16x32_bf16 v[56:59], v[236:239], a[156:159], v[56:59]
    ds_read_b128 a[128:131], v7 offset:8192
    v_cvt_pk_bf16_f32 v90, v52, v53
    v_mfma_f32_16x16x32_bf16 v[60:63], v[252:255], a[156:159], -4.0
    v_exp_f32 v54, v54
    v_mfma_f32_16x16x32_bf16 v[60:63], v[248:251], a[152:155], v[60:63]
    ds_read_b128 a[132:135], v0 offset:8192
    ds_read_b128 a[136:139], v15 offset:8192
    v_mfma_f32_16x16x32_bf16 v[60:63], v[244:247], a[148:151], v[60:63]
    v_exp_f32 v55, v55
    v_mfma_f32_16x16x32_bf16 v[60:63], v[240:243], a[144:147], v[60:63]
    s_waitcnt lgkmcnt(3)
    ds_read_b128 a[140:143], v25 offset:8192
    v_cvt_pk_bf16_f32 v91, v54, v55
    v_mfma_f32_16x16x32_bf16 v[120:123], a[48:51], a[176:179], v[120:123]
    v_exp_f32 v56, v56
    v_mfma_f32_16x16x32_bf16 v[120:123], a[52:55], a[180:183], v[120:123]
    ds_write_b128 v3, v[88:91] offset:6144
    v_mfma_f32_16x16x32_bf16 v[120:123], a[56:59], a[184:187], v[120:123]
    v_exp_f32 v57, v57
    v_mfma_f32_16x16x32_bf16 v[120:123], a[60:63], a[188:191], v[120:123]
    v_fma_f32 v109, v109, v13, v21
    v_fma_f32 v110, v110, v13, v21
    v_mfma_f32_16x16x32_bf16 v[124:127], a[124:127], a[188:191], v[124:127]
    v_exp_f32 v58, v58
    v_mfma_f32_16x16x32_bf16 v[124:127], a[120:123], a[184:187], v[124:127]
    ds_read_b128 a[144:147], v7 offset:12288
    v_cvt_pk_bf16_f32 v92, v56, v57
    v_mfma_f32_16x16x32_bf16 v[124:127], a[116:119], a[180:183], v[124:127]
    v_exp_f32 v59, v59
    v_mfma_f32_16x16x32_bf16 v[124:127], a[112:115], a[176:179], v[124:127]
    ds_read_b128 a[148:151], v0 offset:12288
    v_cvt_pk_bf16_f32 v93, v58, v59
    v_smfmac_f32_16x16x64_bf16 v[28:31], a[192:195], v[80:87], v24
    s_waitcnt lgkmcnt(3)
    v_fma_f32 v111, v111, v13, v21
    v_mfma_f32_16x16x32_bf16 v[48:51], v[128:131], a[128:131], -4.0
    v_exp_f32 v60, v60
    v_mfma_f32_16x16x32_bf16 v[48:51], v[132:135], a[132:135], v[48:51]
    v_cvt_pk_bf16_f32 v104, v104, v105
    v_cvt_pk_bf16_f32 v105, v106, v107
    v_mfma_f32_16x16x32_bf16 v[48:51], v[136:139], a[136:139], v[48:51]
    v_exp_f32 v61, v61
    v_mfma_f32_16x16x32_bf16 v[48:51], v[140:143], a[140:143], v[48:51]
    ds_read_b128 a[152:155], v15 offset:12288
    v_cvt_pk_bf16_f32 v94, v60, v61
    v_mfma_f32_16x16x32_bf16 v[52:55], v[156:159], a[140:143], -4.0
    s_add_u32 m0, s32, 0
    v_exp_f32 v62, v62
    v_mfma_f32_16x16x32_bf16 v[52:55], v[152:155], a[136:139], v[52:55]
    buffer_load_dwordx4 v1, s[12:15], s30 offen lds
    v_mfma_f32_16x16x32_bf16 v[52:55], v[148:151], a[132:135], v[52:55]
    s_add_u32 s30, s30, 4096
    v_exp_f32 v63, v63
    v_mfma_f32_16x16x32_bf16 v[52:55], v[144:147], a[128:131], v[52:55]
    ds_read_b128 a[156:159], v25 offset:12288
    v_cvt_pk_bf16_f32 v95, v62, v63
    v_mfma_f32_16x16x32_bf16 v[96:99], a[12:15], v[88:91], v[16:19]
    v_exp_f32 v48, v48
    v_mfma_f32_16x16x32_bf16 v[96:99], a[8:11], v[80:83], v[96:99]
    ds_write_b128 v3, v[92:95] offset:7168
    v_mfma_f32_16x16x32_bf16 v[96:99], a[4:7], v[72:75], v[96:99]
    v_exp_f32 v49, v49
    v_mfma_f32_16x16x32_bf16 v[96:99], a[0:3], v[64:67], v[96:99]
    s_waitcnt vmcnt(6)
    ds_inc_u32 v9, v24 offset:4096
    v_mfma_f32_16x16x32_bf16 v[100:103], a[64:67], v[64:67], v[16:19]
    s_add_u32 s46, s46, 8
    v_exp_f32 v50, v50
    v_mfma_f32_16x16x32_bf16 v[100:103], a[68:71], v[72:75], v[100:103]
    v_cvt_pk_bf16_f32 v64, v48, v49
    v_cvt_pk_bf16_f32 v106, v108, v109
    v_mfma_f32_16x16x32_bf16 v[100:103], a[72:75], v[80:83], v[100:103]
    v_exp_f32 v51, v51
    v_mfma_f32_16x16x32_bf16 v[100:103], a[76:79], v[88:91], v[100:103]
    s_waitcnt lgkmcnt(2)
    v_cvt_pk_bf16_f32 v65, v50, v51
    v_cvt_pk_bf16_f32 v107, v110, v111
    v_mfma_f32_16x16x32_bf16 v[56:59], v[128:131], a[144:147], -4.0
    v_exp_f32 v52, v52
    v_mfma_f32_16x16x32_bf16 v[56:59], v[132:135], a[148:151], v[56:59]
    buffer_store_dwordx4 v[104:107], v2, s[24:27], s31 offen sc1
    v_mfma_f32_16x16x32_bf16 v[56:59], v[136:139], a[152:155], v[56:59]
    s_add_u32 s31, s31, 4096
    v_exp_f32 v53, v53
    v_mfma_f32_16x16x32_bf16 v[56:59], v[140:143], a[156:159], v[56:59]
    v_cvt_pk_bf16_f32 v66, v52, v53
    v_max_u32 v11, v11, v20
    v_mfma_f32_16x16x32_bf16 v[60:63], v[156:159], a[156:159], -4.0
    v_exp_f32 v54, v54
    v_mfma_f32_16x16x32_bf16 v[60:63], v[152:155], a[152:155], v[60:63]
    ds_read_b32 v14, v9 offset:4096
    ds_read_b128 v[20:23], v9 offset:512
    v_mfma_f32_16x16x32_bf16 v[60:63], v[148:151], a[148:151], v[60:63]
    v_exp_f32 v55, v55
    v_mfma_f32_16x16x32_bf16 v[60:63], v[144:147], a[144:147], v[60:63]
    ds_read_b128 a[160:163], v4 offset:0
    v_cvt_pk_bf16_f32 v67, v54, v55
    v_mfma_f32_16x16x32_bf16 v[104:107], a[12:15], v[92:95], v[16:19]
    v_exp_f32 v56, v56
    v_mfma_f32_16x16x32_bf16 v[104:107], a[8:11], v[84:87], v[104:107]
    ds_read_b128 a[164:167], v4 offset:2048
    ds_read_b128 a[168:171], v4 offset:4096
    v_mfma_f32_16x16x32_bf16 v[104:107], a[4:7], v[76:79], v[104:107]
    s_add_u32 m0, s32, 4096
    v_exp_f32 v57, v57
    v_mfma_f32_16x16x32_bf16 v[104:107], a[0:3], v[68:71], v[104:107]
    buffer_load_dwordx4 v1, s[12:15], s30 offen lds
    v_mfma_f32_16x16x32_bf16 v[108:111], a[64:67], v[68:71], v[16:19]
    s_add_u32 s30, s30, 4096
    v_exp_f32 v58, v58
    v_mfma_f32_16x16x32_bf16 v[108:111], a[68:71], v[76:79], v[108:111]
    s_waitcnt lgkmcnt(4)
    v_cvt_pk_bf16_f32 v68, v56, v57
    v_cmp_gt_u32 vcc, s46, v14
    v_mfma_f32_16x16x32_bf16 v[108:111], a[72:75], v[84:87], v[108:111]
    v_exp_f32 v59, v59
    v_mfma_f32_16x16x32_bf16 v[108:111], a[76:79], v[92:95], v[108:111]
    ds_read_b128 a[172:175], v4 offset:6144
    v_cvt_pk_bf16_f32 v69, v58, v59
    v_smfmac_f32_16x16x64_bf16 v[28:31], a[192:195], v[88:95], v24
    s_cbranch_vccnz L_lateL3
L_backL3:
    s_waitcnt lgkmcnt(3)
    v_add_f32 v20, v20, v21
    v_mfma_f32_16x16x32_bf16 v[48:51], v[160:163], a[128:131], -4.0
    v_exp_f32 v60, v60
    v_mfma_f32_16x16x32_bf16 v[48:51], v[164:167], a[132:135], v[48:51]
    ds_write_b128 v3, v[64:67] offset:32768
    v_mfma_f32_16x16x32_bf16 v[48:51], v[168:171], a[136:139], v[48:51]
    v_exp_f32 v61, v61
    v_mfma_f32_16x16x32_bf16 v[48:51], v[172:175], a[140:143], v[48:51]
    ds_read_b128 a[176:179], v4 offset:1024
    v_cvt_pk_bf16_f32 v70, v60, v61
    v_mfma_f32_16x16x32_bf16 v[52:55], v[188:191], a[140:143], -4.0
    v_exp_f32 v62, v62
    v_mfma_f32_16x16x32_bf16 v[52:55], v[184:187], a[136:139], v[52:55]
    v_add_f32 v22, v22, v23
    v_add_f32 v20, v20, v22
    v_mfma_f32_16x16x32_bf16 v[52:55], v[180:183], a[132:135], v[52:55]
    v_exp_f32 v63, v63
    v_mfma_f32_16x16x32_bf16 v[52:55], v[176:179], a[128:131], v[52:55]
    ds_read_b128 a[180:183], v4 offset:3072
    v_cvt_pk_bf16_f32 v71, v62, v63
    v_mfma_f32_16x16x32_bf16 v[96:99], a[16:19], a[160:163], v[96:99]
    s_waitcnt lgkmcnt(3)
    v_exp_f32 v48, v48
    v_mfma_f32_16x16x32_bf16 v[96:99], a[20:23], a[164:167], v[96:99]
    ds_write_b128 v3, v[68:71] offset:33792
    v_mfma_f32_16x16x32_bf16 v[96:99], a[24:27], a[168:171], v[96:99]
    v_exp_f32 v49, v49
    v_mfma_f32_16x16x32_bf16 v[96:99], a[28:31], a[172:175], v[96:99]
    v_rcp_f32 v12, v20
    v_mfma_f32_16x16x32_bf16 v[100:103], a[92:95], a[172:175], v[100:103]
    v_exp_f32 v50, v50
    v_mfma_f32_16x16x32_bf16 v[100:103], a[88:91], a[168:171], v[100:103]
    ds_read_b128 a[184:187], v4 offset:5120
    v_cvt_pk_bf16_f32 v72, v48, v49
    v_mfma_f32_16x16x32_bf16 v[100:103], a[84:87], a[164:167], v[100:103]
    v_exp_f32 v51, v51
    v_mfma_f32_16x16x32_bf16 v[100:103], a[80:83], a[160:163], v[100:103]
    ds_read_b128 a[188:191], v4 offset:7168
    v_cvt_pk_bf16_f32 v73, v50, v51
    v_mfma_f32_16x16x32_bf16 v[56:59], v[160:163], a[144:147], -4.0
    s_sub_u32 s29, s29, 1
    v_exp_f32 v52, v52
    v_mfma_f32_16x16x32_bf16 v[56:59], v[164:167], a[148:151], v[56:59]
    v_add_f32 v14, v28, v29
    v_mov_b64 v[28:29], 0
    v_mfma_f32_16x16x32_bf16 v[56:59], v[168:171], a[152:155], v[56:59]
    s_cmp_lg_u32 s29, 0
    v_exp_f32 v53, v53
    v_mfma_f32_16x16x32_bf16 v[56:59], v[172:175], a[156:159], v[56:59]
    ds_read_b128 a[160:163], v5 offset:0
    v_cvt_pk_bf16_f32 v74, v52, v53
    v_mfma_f32_16x16x32_bf16 v[60:63], v[188:191], a[156:159], -4.0
    v_exp_f32 v54, v54
    v_mfma_f32_16x16x32_bf16 v[60:63], v[184:187], a[152:155], v[60:63]
    v_mov_b32 v13, v12
    v_min_f32 v10, v10, v20
    s_cbranch_scc1 L_loop
    v_mfma_f32_16x16x32_bf16 v[60:63], v[180:183], a[148:151], v[60:63]
    v_exp_f32 v55, v55
    v_mfma_f32_16x16x32_bf16 v[60:63], v[176:179], a[144:147], v[60:63]
    s_waitcnt lgkmcnt(1)
    ds_read_b128 a[164:167], v5 offset:2048
    ds_read_b128 v[88:91], v9 offset:3072
    v_cvt_pk_bf16_f32 v75, v54, v55
    v_mfma_f32_16x16x32_bf16 v[104:107], a[16:19], a[176:179], v[104:107]
    v_exp_f32 v56, v56
    v_mfma_f32_16x16x32_bf16 v[104:107], a[20:23], a[180:183], v[104:107]
    ds_write_b128 v3, v[72:75] offset:34816
    v_mfma_f32_16x16x32_bf16 v[104:107], a[24:27], a[184:187], v[104:107]
    v_exp_f32 v57, v57
    v_mfma_f32_16x16x32_bf16 v[104:107], a[28:31], a[188:191], v[104:107]
    v_permlane32_swap_b32 v12, v13
    v_mul_f32 v21, -v16, v12
    v_mfma_f32_16x16x32_bf16 v[108:111], a[92:95], a[188:191], v[108:111]
    v_exp_f32 v58, v58
    v_mfma_f32_16x16x32_bf16 v[108:111], a[88:91], a[184:187], v[108:111]
    ds_read_b128 a[168:171], v5 offset:4096
    v_cvt_pk_bf16_f32 v76, v56, v57
    v_mfma_f32_16x16x32_bf16 v[108:111], a[84:87], a[180:183], v[108:111]
    v_exp_f32 v59, v59
    v_mfma_f32_16x16x32_bf16 v[108:111], a[80:83], a[176:179], v[108:111]
    ds_read_b128 a[172:175], v5 offset:6144
    v_cvt_pk_bf16_f32 v77, v58, v59
    v_smfmac_f32_16x16x64_bf16 v[28:31], a[192:195], v[64:71], v24
    v_fma_f32 v112, v112, v12, v21
    v_mfma_f32_16x16x32_bf16 v[48:51], v[192:195], a[128:131], -4.0
    v_exp_f32 v60, v60
    v_mfma_f32_16x16x32_bf16 v[48:51], v[196:199], a[132:135], v[48:51]
    ds_write_b32 v8, v14 offset:0
    s_waitcnt lgkmcnt(4)
    v_add_f32 v88, v88, v89
    v_add_f32 v90, v90, v91
    v_add_f32 v88, v88, v90
    v_rcp_f32 v26, v88
    s_nop 0
    v_mov_b32 v27, v26
    s_nop 1
    v_permlane32_swap_b32 v26, v27
    v_min_f32 v10, v10, v88
    v_max_u32 v11, v11, v88
    v_mfma_f32_16x16x32_bf16 v[48:51], v[200:203], a[136:139], v[48:51]
    v_exp_f32 v61, v61
    v_mfma_f32_16x16x32_bf16 v[48:51], v[204:207], a[140:143], v[48:51]
    ds_read_b128 a[176:179], v5 offset:1024
    v_cvt_pk_bf16_f32 v78, v60, v61
    v_mfma_f32_16x16x32_bf16 v[52:55], v[220:223], a[140:143], -4.0
    v_exp_f32 v62, v62
    v_mfma_f32_16x16x32_bf16 v[52:55], v[216:219], a[136:139], v[52:55]
    v_fma_f32 v113, v113, v12, v21
    v_fma_f32 v114, v114, v12, v21
    v_mfma_f32_16x16x32_bf16 v[52:55], v[212:215], a[132:135], v[52:55]
    v_exp_f32 v63, v63
    v_mfma_f32_16x16x32_bf16 v[52:55], v[208:211], a[128:131], v[52:55]
    ds_read_b128 a[180:183], v5 offset:3072
    v_cvt_pk_bf16_f32 v79, v62, v63
    v_mfma_f32_16x16x32_bf16 v[96:99], a[32:35], a[160:163], v[96:99]
    v_exp_f32 v48, v48
    v_mfma_f32_16x16x32_bf16 v[96:99], a[36:39], a[164:167], v[96:99]
    s_waitcnt lgkmcnt(3)
    ds_write_b128 v3, v[76:79] offset:35840
    v_accvgpr_read_b32 v88, a216
    v_accvgpr_read_b32 v89, a217
    v_accvgpr_read_b32 v90, a218
    v_accvgpr_read_b32 v91, a219
    v_accvgpr_read_b32 v92, a220
    v_accvgpr_read_b32 v93, a221
    v_accvgpr_read_b32 v94, a222
    v_accvgpr_read_b32 v95, a223
    v_pk_mul_f32 v[88:89], v[88:89], v[26:27] op_sel:[0,0] op_sel_hi:[1,0]
    v_pk_mul_f32 v[90:91], v[90:91], v[26:27] op_sel:[0,0] op_sel_hi:[1,0]
    v_pk_mul_f32 v[92:93], v[92:93], v[26:27] op_sel:[0,0] op_sel_hi:[1,0]
    v_pk_mul_f32 v[94:95], v[94:95], v[26:27] op_sel:[0,0] op_sel_hi:[1,0]
    v_cvt_pk_bf16_f32 v88, v88, v89
    v_cvt_pk_bf16_f32 v89, v90, v91
    v_cvt_pk_bf16_f32 v90, v92, v93
    v_cvt_pk_bf16_f32 v91, v94, v95
    s_mov_b32 s45, 32768
    v_mfma_f32_16x16x32_bf16 v[96:99], a[40:43], a[168:171], v[96:99]
    buffer_store_dwordx4 v[88:91], v2, s[24:27], s45 offen sc1
    v_exp_f32 v49, v49
    v_mfma_f32_16x16x32_bf16 v[96:99], a[44:47], a[172:175], v[96:99]
    v_fma_f32 v115, v115, v12, v21
    v_fma_f32 v116, v116, v12, v21
    v_mfma_f32_16x16x32_bf16 v[100:103], a[108:111], a[172:175], v[100:103]
    v_exp_f32 v50, v50
    v_mfma_f32_16x16x32_bf16 v[100:103], a[104:107], a[168:171], v[100:103]
    ds_read_b128 a[184:187], v5 offset:5120
    v_cvt_pk_bf16_f32 v80, v48, v49
    v_mfma_f32_16x16x32_bf16 v[100:103], a[100:103], a[164:167], v[100:103]
    v_exp_f32 v51, v51
    v_mfma_f32_16x16x32_bf16 v[100:103], a[96:99], a[160:163], v[100:103]
    ds_read_b128 a[188:191], v5 offset:7168
    v_cvt_pk_bf16_f32 v81, v50, v51
    v_mfma_f32_16x16x32_bf16 v[56:59], v[192:195], a[144:147], -4.0
    v_exp_f32 v52, v52
    v_mfma_f32_16x16x32_bf16 v[56:59], v[196:199], a[148:151], v[56:59]
    v_fma_f32 v117, v117, v12, v21
    v_fma_f32 v118, v118, v12, v21
    v_mfma_f32_16x16x32_bf16 v[56:59], v[200:203], a[152:155], v[56:59]
    v_exp_f32 v53, v53
    v_mfma_f32_16x16x32_bf16 v[56:59], v[204:207], a[156:159], v[56:59]
    ds_read_b128 a[160:163], v6 offset:0
    v_cvt_pk_bf16_f32 v82, v52, v53
    v_mfma_f32_16x16x32_bf16 v[60:63], v[220:223], a[156:159], -4.0
    v_exp_f32 v54, v54
    v_mfma_f32_16x16x32_bf16 v[60:63], v[216:219], a[152:155], v[60:63]
    v_fma_f32 v119, v119, v12, v21
    v_cvt_pk_bf16_f32 v112, v112, v113
    v_mfma_f32_16x16x32_bf16 v[60:63], v[212:215], a[148:151], v[60:63]
    v_exp_f32 v55, v55
    v_mfma_f32_16x16x32_bf16 v[60:63], v[208:211], a[144:147], v[60:63]
    s_waitcnt lgkmcnt(1)
    ds_read_b128 a[164:167], v6 offset:2048
    v_cvt_pk_bf16_f32 v83, v54, v55
    v_mfma_f32_16x16x32_bf16 v[104:107], a[32:35], a[176:179], v[104:107]
    v_exp_f32 v56, v56
    v_mfma_f32_16x16x32_bf16 v[104:107], a[36:39], a[180:183], v[104:107]
    ds_write_b128 v3, v[80:83] offset:36864
    v_accvgpr_read_b32 v88, a224
    v_accvgpr_read_b32 v89, a225
    v_accvgpr_read_b32 v90, a226
    v_accvgpr_read_b32 v91, a227
    v_accvgpr_read_b32 v92, a228
    v_accvgpr_read_b32 v93, a229
    v_accvgpr_read_b32 v94, a230
    v_accvgpr_read_b32 v95, a231
    v_pk_mul_f32 v[88:89], v[88:89], v[26:27] op_sel:[0,1] op_sel_hi:[1,1]
    v_pk_mul_f32 v[90:91], v[90:91], v[26:27] op_sel:[0,1] op_sel_hi:[1,1]
    v_pk_mul_f32 v[92:93], v[92:93], v[26:27] op_sel:[0,1] op_sel_hi:[1,1]
    v_pk_mul_f32 v[94:95], v[94:95], v[26:27] op_sel:[0,1] op_sel_hi:[1,1]
    v_cvt_pk_bf16_f32 v88, v88, v89
    v_cvt_pk_bf16_f32 v89, v90, v91
    v_cvt_pk_bf16_f32 v90, v92, v93
    v_cvt_pk_bf16_f32 v91, v94, v95
    s_mov_b32 s45, 36864
    v_mfma_f32_16x16x32_bf16 v[104:107], a[40:43], a[184:187], v[104:107]
    buffer_store_dwordx4 v[88:91], v2, s[24:27], s45 offen sc1
    v_exp_f32 v57, v57
    v_mfma_f32_16x16x32_bf16 v[104:107], a[44:47], a[188:191], v[104:107]
    v_cvt_pk_bf16_f32 v113, v114, v115
    v_cvt_pk_bf16_f32 v114, v116, v117
    v_mfma_f32_16x16x32_bf16 v[108:111], a[108:111], a[188:191], v[108:111]
    v_exp_f32 v58, v58
    v_mfma_f32_16x16x32_bf16 v[108:111], a[104:107], a[184:187], v[108:111]
    ds_read_b128 a[168:171], v6 offset:4096
    v_cvt_pk_bf16_f32 v84, v56, v57
    v_mfma_f32_16x16x32_bf16 v[108:111], a[100:103], a[180:183], v[108:111]
    v_exp_f32 v59, v59
    v_mfma_f32_16x16x32_bf16 v[108:111], a[96:99], a[176:179], v[108:111]
    ds_read_b128 a[172:175], v6 offset:6144
    v_cvt_pk_bf16_f32 v85, v58, v59
    v_smfmac_f32_16x16x64_bf16 v[28:31], a[192:195], v[72:79], v24
    v_cvt_pk_bf16_f32 v115, v118, v119
    v_mfma_f32_16x16x32_bf16 v[48:51], v[224:227], a[128:131], -4.0
    v_exp_f32 v60, v60
    v_mfma_f32_16x16x32_bf16 v[48:51], v[228:231], a[132:135], v[48:51]
    buffer_store_dwordx4 v[112:115], v2, s[24:27], s31 offen sc1
    v_mfma_f32_16x16x32_bf16 v[48:51], v[232:235], a[136:139], v[48:51]
    s_add_u32 s31, s31, 4096
    v_exp_f32 v61, v61
    v_mfma_f32_16x16x32_bf16 v[48:51], v[236:239], a[140:143], v[48:51]
    ds_read_b128 a[176:179], v6 offset:1024
    v_cvt_pk_bf16_f32 v86, v60, v61
    v_mfma_f32_16x16x32_bf16 v[52:55], v[252:255], a[140:143], -4.0
    v_exp_f32 v62, v62
    v_mfma_f32_16x16x32_bf16 v[52:55], v[248:251], a[136:139], v[52:55]
    v_mul_f32 v21, -v16, v13
    v_fma_f32 v120, v120, v13, v21
    v_mfma_f32_16x16x32_bf16 v[52:55], v[244:247], a[132:135], v[52:55]
    v_exp_f32 v63, v63
    v_mfma_f32_16x16x32_bf16 v[52:55], v[240:243], a[128:131], v[52:55]
    s_waitcnt lgkmcnt(1)
    ds_read_b128 a[180:183], v6 offset:3072
    v_cvt_pk_bf16_f32 v87, v62, v63
    v_mfma_f32_16x16x32_bf16 v[96:99], a[48:51], a[160:163], v[96:99]
    v_exp_f32 v48, v48
    v_mfma_f32_16x16x32_bf16 v[96:99], a[52:55], a[164:167], v[96:99]
    ds_write_b128 v3, v[84:87] offset:37888
    v_mfma_f32_16x16x32_bf16 v[96:99], a[56:59], a[168:171], v[96:99]
    v_exp_f32 v49, v49
    v_mfma_f32_16x16x32_bf16 v[96:99], a[60:63], a[172:175], v[96:99]
    v_fma_f32 v121, v121, v13, v21
    v_fma_f32 v122, v122, v13, v21
    v_mfma_f32_16x16x32_bf16 v[100:103], a[124:127], a[172:175], v[100:103]
    v_exp_f32 v50, v50
    v_mfma_f32_16x16x32_bf16 v[100:103], a[120:123], a[168:171], v[100:103]
    ds_read_b128 a[184:187], v6 offset:5120
    v_cvt_pk_bf16_f32 v88, v48, v49
    v_mfma_f32_16x16x32_bf16 v[100:103], a[116:119], a[164:167], v[100:103]
    v_exp_f32 v51, v51
    v_mfma_f32_16x16x32_bf16 v[100:103], a[112:115], a[160:163], v[100:103]
    ds_read_b128 a[188:191], v6 offset:7168
    v_cvt_pk_bf16_f32 v89, v50, v51
    v_mfma_f32_16x16x32_bf16 v[56:59], v[224:227], a[144:147], -4.0
    v_exp_f32 v52, v52
    v_mfma_f32_16x16x32_bf16 v[56:59], v[228:231], a[148:151], v[56:59]
    v_fma_f32 v123, v123, v13, v21
    v_fma_f32 v124, v124, v13, v21
    v_mfma_f32_16x16x32_bf16 v[56:59], v[232:235], a[152:155], v[56:59]
    v_exp_f32 v53, v53
    v_mfma_f32_16x16x32_bf16 v[56:59], v[236:239], a[156:159], v[56:59]
    v_cvt_pk_bf16_f32 v90, v52, v53
    v_mfma_f32_16x16x32_bf16 v[60:63], v[252:255], a[156:159], -4.0
    v_exp_f32 v54, v54
    v_mfma_f32_16x16x32_bf16 v[60:63], v[248:251], a[152:155], v[60:63]
    v_mfma_f32_16x16x32_bf16 v[60:63], v[244:247], a[148:151], v[60:63]
    v_exp_f32 v55, v55
    v_mfma_f32_16x16x32_bf16 v[60:63], v[240:243], a[144:147], v[60:63]
    s_waitcnt lgkmcnt(0)
    v_cvt_pk_bf16_f32 v91, v54, v55
    v_mfma_f32_16x16x32_bf16 v[104:107], a[48:51], a[176:179], v[104:107]
    v_exp_f32 v56, v56
    v_mfma_f32_16x16x32_bf16 v[104:107], a[52:55], a[180:183], v[104:107]
    ds_write_b128 v3, v[88:91] offset:38912
    v_mfma_f32_16x16x32_bf16 v[104:107], a[56:59], a[184:187], v[104:107]
    v_exp_f32 v57, v57
    v_mfma_f32_16x16x32_bf16 v[104:107], a[60:63], a[188:191], v[104:107]
    v_fma_f32 v125, v125, v13, v21
    v_fma_f32 v126, v126, v13, v21
    v_mfma_f32_16x16x32_bf16 v[108:111], a[124:127], a[188:191], v[108:111]
    v_exp_f32 v58, v58
    v_mfma_f32_16x16x32_bf16 v[108:111], a[120:123], a[184:187], v[108:111]
    s_waitcnt lgkmcnt(0)
    s_barrier
    v_cvt_pk_bf16_f32 v92, v56, v57
    v_mfma_f32_16x16x32_bf16 v[108:111], a[116:119], a[180:183], v[108:111]
    ds_read_b128 a[168:171], v4 offset:36864
    v_exp_f32 v59, v59
    v_mfma_f32_16x16x32_bf16 v[108:111], a[112:115], a[176:179], v[108:111]
    ds_read_b128 a[160:163], v4 offset:32768
    ds_read_b128 a[172:175], v4 offset:38912
    v_cvt_pk_bf16_f32 v93, v58, v59
    v_smfmac_f32_16x16x64_bf16 v[28:31], a[192:195], v[80:87], v24
    v_fma_f32 v127, v127, v13, v21
    v_mfma_f32_16x16x32_bf16 v[112:115], a[0:3], v[64:67], 0
    v_exp_f32 v60, v60
    v_mfma_f32_16x16x32_bf16 v[112:115], a[4:7], v[72:75], v[112:115]
    v_exp_f32 v61, v61
    v_mfma_f32_16x16x32_bf16 v[112:115], a[8:11], v[80:83], v[112:115]
    ds_read_b128 a[164:167], v4 offset:34816
    v_cvt_pk_bf16_f32 v94, v60, v61
    v_mfma_f32_16x16x32_bf16 v[112:115], a[12:15], v[88:91], v[112:115]
    v_exp_f32 v62, v62
    v_mfma_f32_16x16x32_bf16 v[116:119], a[76:79], v[88:91], 0
    v_exp_f32 v63, v63
    v_mfma_f32_16x16x32_bf16 v[116:119], a[72:75], v[80:83], v[116:119]
    v_cvt_pk_bf16_f32 v95, v62, v63
    v_max_u32 v11, v11, v20
    v_mfma_f32_16x16x32_bf16 v[116:119], a[68:71], v[72:75], v[116:119]
    ds_write_b128 v3, v[92:95] offset:39936
    v_mfma_f32_16x16x32_bf16 v[116:119], a[64:67], v[64:67], v[116:119]
    v_cvt_pk_bf16_f32 v120, v120, v121
    v_cvt_pk_bf16_f32 v121, v122, v123
    v_smfmac_f32_16x16x64_bf16 v[28:31], a[192:195], v[88:95], v24
    s_waitcnt lgkmcnt(2)
    v_cvt_pk_bf16_f32 v122, v124, v125
    v_cvt_pk_bf16_f32 v123, v126, v127
    v_mfma_f32_16x16x32_bf16 v[112:115], a[16:19], a[160:163], v[112:115]
    s_waitcnt lgkmcnt(1)
    buffer_store_dwordx4 v[120:123], v2, s[24:27], s31 offen sc1
    v_mfma_f32_16x16x32_bf16 v[112:115], a[20:23], a[164:167], v[112:115]
    ds_read_b128 a[176:179], v5 offset:32768
    ds_read_b128 a[180:183], v5 offset:34816
    v_mfma_f32_16x16x32_bf16 v[112:115], a[24:27], a[168:171], v[112:115]
    ds_read_b128 a[184:187], v5 offset:36864
    ds_read_b128 a[188:191], v5 offset:38912
    v_mfma_f32_16x16x32_bf16 v[112:115], a[28:31], a[172:175], v[112:115]
    ds_read_b128 v[20:23], v9 offset:0
    ds_read_b128 v[56:59], v9 offset:2048
    v_mfma_f32_16x16x32_bf16 v[116:119], a[92:95], a[172:175], v[116:119]
    v_add_f32 v14, v28, v29
    v_mfma_f32_16x16x32_bf16 v[116:119], a[88:91], a[168:171], v[116:119]
    ds_write_b32 v8, v14 offset:512
    v_mfma_f32_16x16x32_bf16 v[116:119], a[84:87], a[164:167], v[116:119]
    s_waitcnt lgkmcnt(2)
    v_add_f32 v20, v20, v21
    v_add_f32 v22, v22, v23
    v_mfma_f32_16x16x32_bf16 v[116:119], a[80:83], a[160:163], v[116:119]
    ds_read_b128 a[160:163], v6 offset:32768
    ds_read_b128 a[164:167], v6 offset:34816
    v_mfma_f32_16x16x32_bf16 v[112:115], a[32:35], a[176:179], v[112:115]
    ds_read_b128 a[168:171], v6 offset:36864
    ds_read_b128 a[172:175], v6 offset:38912
    v_mfma_f32_16x16x32_bf16 v[112:115], a[36:39], a[180:183], v[112:115]
    v_add_f32 v20, v20, v22
    v_mfma_f32_16x16x32_bf16 v[112:115], a[40:43], a[184:187], v[112:115]
    s_waitcnt lgkmcnt(4)
    s_barrier
    v_mfma_f32_16x16x32_bf16 v[112:115], a[44:47], a[188:191], v[112:115]
    ds_read_b128 v[48:51], v9 offset:512
    v_mfma_f32_16x16x32_bf16 v[116:119], a[108:111], a[188:191], v[116:119]
    v_rcp_f32 v12, v20
    v_mfma_f32_16x16x32_bf16 v[116:119], a[104:107], a[184:187], v[116:119]
    v_mov_b32 v13, v12
    s_nop 1
    v_permlane32_swap_b32 v12, v13
    v_mfma_f32_16x16x32_bf16 v[116:119], a[100:103], a[180:183], v[116:119]
    v_min_f32 v10, v10, v20
    v_max_u32 v11, v11, v20
    v_mfma_f32_16x16x32_bf16 v[116:119], a[96:99], a[176:179], v[116:119]
    s_waitcnt lgkmcnt(3)
    ds_read_b128 a[176:179], v4 offset:33792
    ds_read_b128 a[180:183], v4 offset:35840
    v_mfma_f32_16x16x32_bf16 v[112:115], a[48:51], a[160:163], v[112:115]
    ds_read_b128 a[184:187], v4 offset:37888
    ds_read_b128 a[188:191], v4 offset:39936
    v_mfma_f32_16x16x32_bf16 v[112:115], a[52:55], a[164:167], v[112:115]
    s_waitcnt lgkmcnt(5)
    v_mul_f32 v21, -v16, v12
    v_fma_f32 v96, v96, v12, v21
    v_mfma_f32_16x16x32_bf16 v[112:115], a[56:59], a[168:171], v[112:115]
    v_fma_f32 v97, v97, v12, v21
    v_fma_f32 v98, v98, v12, v21
    v_mfma_f32_16x16x32_bf16 v[112:115], a[60:63], a[172:175], v[112:115]
    v_fma_f32 v99, v99, v12, v21
    v_fma_f32 v100, v100, v12, v21
    v_mfma_f32_16x16x32_bf16 v[116:119], a[124:127], a[172:175], v[116:119]
    v_fma_f32 v101, v101, v12, v21
    v_fma_f32 v102, v102, v12, v21
    v_mfma_f32_16x16x32_bf16 v[116:119], a[120:123], a[168:171], v[116:119]
    v_fma_f32 v103, v103, v12, v21
    v_cvt_pk_bf16_f32 v96, v96, v97
    v_mfma_f32_16x16x32_bf16 v[116:119], a[116:119], a[164:167], v[116:119]
    v_cvt_pk_bf16_f32 v97, v98, v99
    v_cvt_pk_bf16_f32 v98, v100, v101
    v_mfma_f32_16x16x32_bf16 v[116:119], a[112:115], a[160:163], v[116:119]
    ds_read_b128 a[160:163], v5 offset:33792
    ds_read_b128 a[164:167], v5 offset:35840
    v_mfma_f32_16x16x32_bf16 v[120:123], a[0:3], v[68:71], 0
    ds_read_b128 a[168:171], v5 offset:37888
    ds_read_b128 a[172:175], v5 offset:39936
    v_mfma_f32_16x16x32_bf16 v[120:123], a[4:7], v[76:79], v[120:123]
    v_cvt_pk_bf16_f32 v99, v102, v103
    v_mfma_f32_16x16x32_bf16 v[120:123], a[8:11], v[84:87], v[120:123]
    s_mov_b32 s44, 393216
    buffer_store_dwordx4 v[96:99], v2, s[24:27], s44 offen sc1
    v_mfma_f32_16x16x32_bf16 v[120:123], a[12:15], v[92:95], v[120:123]
    v_mul_f32 v21, -v16, v13
    v_fma_f32 v104, v104, v13, v21
    v_mfma_f32_16x16x32_bf16 v[124:127], a[76:79], v[92:95], 0
    v_fma_f32 v105, v105, v13, v21
    v_fma_f32 v106, v106, v13, v21
    v_mfma_f32_16x16x32_bf16 v[124:127], a[72:75], v[84:87], v[124:127]
    v_fma_f32 v107, v107, v13, v21
    v_fma_f32 v108, v108, v13, v21
    v_mfma_f32_16x16x32_bf16 v[124:127], a[68:71], v[76:79], v[124:127]
    v_fma_f32 v109, v109, v13, v21
    v_fma_f32 v110, v110, v13, v21
    v_mfma_f32_16x16x32_bf16 v[124:127], a[64:67], v[68:71], v[124:127]
    s_waitcnt lgkmcnt(2)
    v_fma_f32 v111, v111, v13, v21
    v_cvt_pk_bf16_f32 v104, v104, v105
    v_mfma_f32_16x16x32_bf16 v[120:123], a[16:19], a[176:179], v[120:123]
    v_cvt_pk_bf16_f32 v105, v106, v107
    v_cvt_pk_bf16_f32 v106, v108, v109
    v_mfma_f32_16x16x32_bf16 v[120:123], a[20:23], a[180:183], v[120:123]
    v_cvt_pk_bf16_f32 v107, v110, v111
    v_mfma_f32_16x16x32_bf16 v[120:123], a[24:27], a[184:187], v[120:123]
    s_mov_b32 s44, 397312
    buffer_store_dwordx4 v[104:107], v2, s[24:27], s44 offen sc1
    v_mfma_f32_16x16x32_bf16 v[120:123], a[28:31], a[188:191], v[120:123]
    v_add_f32 v48, v48, v49
    v_add_f32 v50, v50, v51
    v_mfma_f32_16x16x32_bf16 v[124:127], a[92:95], a[188:191], v[124:127]
    v_add_f32 v48, v48, v50
    v_mfma_f32_16x16x32_bf16 v[124:127], a[88:91], a[184:187], v[124:127]
    v_rcp_f32 v52, v48
    v_mfma_f32_16x16x32_bf16 v[124:127], a[84:87], a[180:183], v[124:127]
    v_mov_b32 v53, v52
    s_nop 1
    v_permlane32_swap_b32 v52, v53
    v_mfma_f32_16x16x32_bf16 v[124:127], a[80:83], a[176:179], v[124:127]
    ds_read_b128 a[176:179], v6 offset:33792
    ds_read_b128 a[180:183], v6 offset:35840
    v_mfma_f32_16x16x32_bf16 v[120:123], a[32:35], a[160:163], v[120:123]
    ds_read_b128 a[184:187], v6 offset:37888
    ds_read_b128 a[188:191], v6 offset:39936
    v_mfma_f32_16x16x32_bf16 v[120:123], a[36:39], a[164:167], v[120:123]
    s_waitcnt lgkmcnt(4)
    v_min_f32 v10, v10, v48
    v_max_u32 v11, v11, v48
    v_mfma_f32_16x16x32_bf16 v[120:123], a[40:43], a[168:171], v[120:123]
    v_mul_f32 v112, v112, v52
    v_mul_f32 v113, v113, v52
    v_mfma_f32_16x16x32_bf16 v[120:123], a[44:47], a[172:175], v[120:123]
    v_mul_f32 v114, v114, v52
    v_mul_f32 v115, v115, v52
    v_mfma_f32_16x16x32_bf16 v[124:127], a[108:111], a[172:175], v[124:127]
    v_mul_f32 v116, v116, v52
    v_mul_f32 v117, v117, v52
    v_mfma_f32_16x16x32_bf16 v[124:127], a[104:107], a[168:171], v[124:127]
    v_mul_f32 v118, v118, v52
    v_mul_f32 v119, v119, v52
    v_mfma_f32_16x16x32_bf16 v[124:127], a[100:103], a[164:167], v[124:127]
    v_cvt_pk_bf16_f32 v112, v112, v113
    v_cvt_pk_bf16_f32 v113, v114, v115
    v_mfma_f32_16x16x32_bf16 v[124:127], a[96:99], a[160:163], v[124:127]
    s_waitcnt lgkmcnt(2)
    v_cvt_pk_bf16_f32 v114, v116, v117
    v_cvt_pk_bf16_f32 v115, v118, v119
    v_mfma_f32_16x16x32_bf16 v[120:123], a[48:51], a[176:179], v[120:123]
    s_mov_b32 s44, 401408
    buffer_store_dwordx4 v[112:115], v2, s[24:27], s44 offen sc1
    v_mfma_f32_16x16x32_bf16 v[120:123], a[52:55], a[180:183], v[120:123]
    s_waitcnt lgkmcnt(0)
    v_add_f32 v56, v56, v57
    v_add_f32 v58, v58, v59
    v_mfma_f32_16x16x32_bf16 v[120:123], a[56:59], a[184:187], v[120:123]
    v_add_f32 v56, v56, v58
    v_mfma_f32_16x16x32_bf16 v[120:123], a[60:63], a[188:191], v[120:123]
    v_rcp_f32 v26, v56
    v_mfma_f32_16x16x32_bf16 v[124:127], a[124:127], a[188:191], v[124:127]
    v_mov_b32 v27, v26
    s_nop 1
    v_permlane32_swap_b32 v26, v27
    v_mfma_f32_16x16x32_bf16 v[124:127], a[120:123], a[184:187], v[124:127]
    v_min_f32 v10, v10, v56
    v_max_u32 v11, v11, v56
    v_mfma_f32_16x16x32_bf16 v[124:127], a[116:119], a[180:183], v[124:127]
    v_mul_f32 v32, v32, v26
    v_mul_f32 v33, v33, v26
    v_mfma_f32_16x16x32_bf16 v[124:127], a[112:115], a[176:179], v[124:127]
    v_mul_f32 v34, v34, v26
    v_mul_f32 v35, v35, v26
    v_mul_f32 v36, v36, v26
    v_mul_f32 v37, v37, v26
    v_mul_f32 v38, v38, v26
    v_mul_f32 v39, v39, v26
    v_cvt_pk_bf16_f32 v32, v32, v33
    v_cvt_pk_bf16_f32 v33, v34, v35
    v_cvt_pk_bf16_f32 v34, v36, v37
    v_cvt_pk_bf16_f32 v35, v38, v39
    s_mov_b32 s44, 16384
    buffer_store_dwordx4 v[32:35], v2, s[24:27], s44 offen sc1
    v_mul_f32 v40, v40, v27
    v_mul_f32 v41, v41, v27
    v_mul_f32 v42, v42, v27
    v_mul_f32 v43, v43, v27
    v_mul_f32 v44, v44, v27
    v_mul_f32 v45, v45, v27
    v_mul_f32 v46, v46, v27
    v_mul_f32 v47, v47, v27
    v_cvt_pk_bf16_f32 v40, v40, v41
    v_cvt_pk_bf16_f32 v41, v42, v43
    v_cvt_pk_bf16_f32 v42, v44, v45
    v_cvt_pk_bf16_f32 v43, v46, v47
    s_mov_b32 s44, 20480
    buffer_store_dwordx4 v[40:43], v2, s[24:27], s44 offen sc1
    v_pk_mul_f32 v[120:121], v[120:121], v[52:53] op_sel:[0,1] op_sel_hi:[1,1]
    v_pk_mul_f32 v[122:123], v[122:123], v[52:53] op_sel:[0,1] op_sel_hi:[1,1]
    v_pk_mul_f32 v[124:125], v[124:125], v[52:53] op_sel:[0,1] op_sel_hi:[1,1]
    v_pk_mul_f32 v[126:127], v[126:127], v[52:53] op_sel:[0,1] op_sel_hi:[1,1]
    v_cvt_pk_bf16_f32 v120, v120, v121
    v_cvt_pk_bf16_f32 v121, v122, v123
    v_cvt_pk_bf16_f32 v122, v124, v125
    v_cvt_pk_bf16_f32 v123, v126, v127
    s_mov_b32 s44, 405504
    buffer_store_dwordx4 v[120:123], v2, s[24:27], s44 offen sc1
    s_mov_b32 s47, 0x51800000
    v_cmp_gt_f32 vcc, s60, v10
    v_cmp_lt_u32 s[48:49], s47, v11
    s_nop 4
    s_or_b64 vcc, vcc, s[48:49]
    s_cmp_eq_u64 vcc, 0
    s_cbranch_scc1 L_end
    s_mov_b32 s30, 0
    s_branch L_slow
L_wait0:
    ds_read_b32 v11, v9 offset:4608
    s_waitcnt lgkmcnt(0)
    v_cmp_gt_u32 vcc, 8, v11
    s_nop 1
    s_cbranch_vccnz L_wait0
    s_branch L_go0
L_wait1:
    ds_read_b32 v11, v9 offset:4612
    s_waitcnt lgkmcnt(0)
    v_cmp_gt_u32 vcc, 8, v11
    s_nop 1
    s_cbranch_vccnz L_wait1
    s_branch L_go1
L_wait2:
    ds_read_b32 v11, v9 offset:4616
    s_waitcnt lgkmcnt(0)
    v_cmp_gt_u32 vcc, 8, v11
    s_nop 1
    s_cbranch_vccnz L_wait2
    s_branch L_go2
L_wait3:
    ds_read_b32 v11, v9 offset:4620
    s_waitcnt lgkmcnt(0)
    v_cmp_gt_u32 vcc, 8, v11
    s_nop 1
    s_cbranch_vccnz L_wait3
    s_branch L_go3
L_wait4:
    ds_read_b32 v11, v9 offset:5120
    s_waitcnt lgkmcnt(0)
    v_cmp_gt_u32 vcc, 8, v11
    s_nop 1
    s_cbranch_vccnz L_wait4
    s_branch L_go4
L_wait5:
    ds_read_b32 v11, v9 offset:5124
    s_waitcnt lgkmcnt(0)
    v_cmp_gt_u32 vcc, 8, v11
    s_nop 1
    s_cbranch_vccnz L_wait5
    s_branch L_go5
L_wait6:
    ds_read_b32 v11, v9 offset:5128
    s_waitcnt lgkmcnt(0)
    v_cmp_gt_u32 vcc, 8, v11
    s_nop 1
    s_cbranch_vccnz L_wait6
    s_branch L_go6
L_wait7:
    ds_read_b32 v11, v9 offset:5132
    s_waitcnt lgkmcnt(0)
    v_cmp_gt_u32 vcc, 8, v11
    s_nop 1
    s_cbranch_vccnz L_wait7
    s_branch L_go7
L_wait8:
    ds_read_b32 v11, v9 offset:5632
    s_waitcnt lgkmcnt(0)
    v_cmp_gt_u32 vcc, 8, v11
    s_nop 1
    s_cbranch_vccnz L_wait8
    s_branch L_go8
L_wait9:
    ds_read_b32 v11, v9 offset:5636
    s_waitcnt lgkmcnt(0)
    v_cmp_gt_u32 vcc, 8, v11
    s_nop 1
    s_cbranch_vccnz L_wait9
    s_branch L_go9
L_wait10:
    ds_read_b32 v11, v9 offset:5640
    s_waitcnt lgkmcnt(0)
    v_cmp_gt_u32 vcc, 8, v11
    s_nop 1
    s_cbranch_vccnz L_wait10
    s_branch L_go10
L_late6:
    ds_read_b32 v14, v9 offset:4096
    s_waitcnt lgkmcnt(0)
    v_cmp_gt_u32 vcc, s46, v14
    s_nop 1
    s_cbranch_vccnz L_late6
    ds_read_b128 v[20:23], v9 offset:1536
    ds_read_b128 a[160:163], v4 offset:32768
    ds_read_b128 a[164:167], v4 offset:34816
    ds_read_b128 a[168:171], v4 offset:36864
    ds_read_b128 a[172:175], v4 offset:38912
    s_waitcnt lgkmcnt(0)
    s_branch L_back6
L_late7:
    ds_read_b32 v14, v9 offset:4096
    s_waitcnt lgkmcnt(0)
    v_cmp_gt_u32 vcc, s46, v14
    s_nop 1
    s_cbranch_vccnz L_late7
    ds_read_b128 v[20:23], v9 offset:512
    ds_read_b128 a[160:163], v4 offset:0
    ds_read_b128 a[164:167], v4 offset:2048
    ds_read_b128 a[168:171], v4 offset:4096
    ds_read_b128 a[172:175], v4 offset:6144
    s_waitcnt lgkmcnt(0)
    s_branch L_back7
L_late8:
    ds_read_b32 v14, v9 offset:4096
    s_waitcnt lgkmcnt(0)
    v_cmp_gt_u32 vcc, s46, v14
    s_nop 1
    s_cbranch_vccnz L_late8
    ds_read_b128 v[20:23], v9 offset:0
    ds_read_b128 a[160:163], v4 offset:32768
    ds_read_b128 a[164:167], v4 offset:34816
    ds_read_b128 a[168:171], v4 offset:36864
    ds_read_b128 a[172:175], v4 offset:38912
    s_waitcnt lgkmcnt(0)
    s_branch L_back8
L_late9:
    ds_read_b32 v14, v9 offset:4096
    s_waitcnt lgkmcnt(0)
    v_cmp_gt_u32 vcc, s46, v14
    s_nop 1
    s_cbranch_vccnz L_late9
    ds_read_b128 v[20:23], v9 offset:512
    ds_read_b128 a[160:163], v4 offset:0
    ds_read_b128 a[164:167], v4 offset:2048
    ds_read_b128 a[168:171], v4 offset:4096
    ds_read_b128 a[172:175], v4 offset:6144
    s_waitcnt lgkmcnt(0)
    s_branch L_back9
L_lateL0:
    ds_read_b32 v14, v9 offset:4096
    s_waitcnt lgkmcnt(0)
    v_cmp_gt_u32 vcc, s46, v14
    s_nop 1
    s_cbranch_vccnz L_lateL0
    ds_read_b128 v[20:23], v9 offset:0
    ds_read_b128 a[160:163], v4 offset:32768
    ds_read_b128 a[164:167], v4 offset:34816
    ds_read_b128 a[168:171], v4 offset:36864
    ds_read_b128 a[172:175], v4 offset:38912
    s_waitcnt lgkmcnt(0)
    s_branch L_backL0
L_lateL1:
    ds_read_b32 v14, v9 offset:4096
    s_waitcnt lgkmcnt(0)
    v_cmp_gt_u32 vcc, s46, v14
    s_nop 1
    s_cbranch_vccnz L_lateL1
    ds_read_b128 v[20:23], v9 offset:512
    ds_read_b128 a[160:163], v4 offset:0
    ds_read_b128 a[164:167], v4 offset:2048
    ds_read_b128 a[168:171], v4 offset:4096
    ds_read_b128 a[172:175], v4 offset:6144
    s_waitcnt lgkmcnt(0)
    s_branch L_backL1
L_lateL2:
    ds_read_b32 v14, v9 offset:4096
    s_waitcnt lgkmcnt(0)
    v_cmp_gt_u32 vcc, s46, v14
    s_nop 1
    s_cbranch_vccnz L_lateL2
    ds_read_b128 v[20:23], v9 offset:0
    ds_read_b128 a[160:163], v4 offset:32768
    ds_read_b128 a[164:167], v4 offset:34816
    ds_read_b128 a[168:171], v4 offset:36864
    ds_read_b128 a[172:175], v4 offset:38912
    s_waitcnt lgkmcnt(0)
    s_branch L_backL2
L_lateL3:
    ds_read_b32 v14, v9 offset:4096
    s_waitcnt lgkmcnt(0)
    v_cmp_gt_u32 vcc, s46, v14
    s_nop 1
    s_cbranch_vccnz L_lateL3
    ds_read_b128 v[20:23], v9 offset:512
    ds_read_b128 a[160:163], v4 offset:0
    ds_read_b128 a[164:167], v4 offset:2048
    ds_read_b128 a[168:171], v4 offset:4096
    ds_read_b128 a[172:175], v4 offset:6144
    s_waitcnt lgkmcnt(0)
    s_branch L_backL3
L_slow:
    s_waitcnt vmcnt(0) lgkmcnt(0)
    s_barrier
    s_mov_b32 m0, s32
    s_nop 0
    buffer_load_dwordx4 v1, s[12:15], s30 offen lds
    s_add_u32 m0, s32, 4096
    s_add_u32 s43, s30, 4096
    buffer_load_dwordx4 v1, s[12:15], s43 offen lds
    s_waitcnt vmcnt(0)
    s_barrier
    ds_read_b128 a[128:131], v7 offset:0
    ds_read_b128 a[132:135], v0 offset:0
    ds_read_b128 a[136:139], v15 offset:0
    ds_read_b128 a[140:143], v25 offset:0
    ds_read_b128 a[144:147], v7 offset:4096
    ds_read_b128 a[148:151], v0 offset:4096
    ds_read_b128 a[152:155], v15 offset:4096
    ds_read_b128 a[156:159], v25 offset:4096
    s_waitcnt lgkmcnt(7)
    v_mfma_f32_16x16x32_bf16 v[32:35], v[128:131], a[128:131], 0
    s_waitcnt lgkmcnt(6)
    v_mfma_f32_16x16x32_bf16 v[32:35], v[132:135], a[132:135], v[32:35]
    s_waitcnt lgkmcnt(5)
    v_mfma_f32_16x16x32_bf16 v[32:35], v[136:139], a[136:139], v[32:35]
    s_waitcnt lgkmcnt(4)
    v_mfma_f32_16x16x32_bf16 v[32:35], v[140:143], a[140:143], v[32:35]
    v_mfma_f32_16x16x32_bf16 v[36:39], v[144:147], a[128:131], 0
    v_mfma_f32_16x16x32_bf16 v[36:39], v[148:151], a[132:135], v[36:39]
    v_mfma_f32_16x16x32_bf16 v[36:39], v[152:155], a[136:139], v[36:39]
    v_mfma_f32_16x16x32_bf16 v[36:39], v[156:159], a[140:143], v[36:39]
    s_waitcnt lgkmcnt(0)
    v_mfma_f32_16x16x32_bf16 v[40:43], v[128:131], a[144:147], 0
    v_mfma_f32_16x16x32_bf16 v[40:43], v[132:135], a[148:151], v[40:43]
    v_mfma_f32_16x16x32_bf16 v[40:43], v[136:139], a[152:155], v[40:43]
    v_mfma_f32_16x16x32_bf16 v[40:43], v[140:143], a[156:159], v[40:43]
    v_mfma_f32_16x16x32_bf16 v[44:47], v[144:147], a[144:147], 0
    v_mfma_f32_16x16x32_bf16 v[44:47], v[148:151], a[148:151], v[44:47]
    v_mfma_f32_16x16x32_bf16 v[44:47], v[152:155], a[152:155], v[44:47]
    v_mfma_f32_16x16x32_bf16 v[44:47], v[156:159], a[156:159], v[44:47]
    v_mfma_f32_16x16x32_bf16 v[48:51], v[160:163], a[128:131], 0
    v_mfma_f32_16x16x32_bf16 v[48:51], v[164:167], a[132:135], v[48:51]
    v_mfma_f32_16x16x32_bf16 v[48:51], v[168:171], a[136:139], v[48:51]
    v_mfma_f32_16x16x32_bf16 v[48:51], v[172:175], a[140:143], v[48:51]
    v_mfma_f32_16x16x32_bf16 v[52:55], v[176:179], a[128:131], 0
    v_mfma_f32_16x16x32_bf16 v[52:55], v[180:183], a[132:135], v[52:55]
    v_mfma_f32_16x16x32_bf16 v[52:55], v[184:187], a[136:139], v[52:55]
    v_mfma_f32_16x16x32_bf16 v[52:55], v[188:191], a[140:143], v[52:55]
    v_mfma_f32_16x16x32_bf16 v[56:59], v[160:163], a[144:147], 0
    v_mfma_f32_16x16x32_bf16 v[56:59], v[164:167], a[148:151], v[56:59]
    v_mfma_f32_16x16x32_bf16 v[56:59], v[168:171], a[152:155], v[56:59]
    v_mfma_f32_16x16x32_bf16 v[56:59], v[172:175], a[156:159], v[56:59]
    v_mfma_f32_16x16x32_bf16 v[60:63], v[176:179], a[144:147], 0
    v_mfma_f32_16x16x32_bf16 v[60:63], v[180:183], a[148:151], v[60:63]
    v_mfma_f32_16x16x32_bf16 v[60:63], v[184:187], a[152:155], v[60:63]
    v_mfma_f32_16x16x32_bf16 v[60:63], v[188:191], a[156:159], v[60:63]
    v_mfma_f32_16x16x32_bf16 v[64:67], v[192:195], a[128:131], 0
    v_mfma_f32_16x16x32_bf16 v[64:67], v[196:199], a[132:135], v[64:67]
    v_mfma_f32_16x16x32_bf16 v[64:67], v[200:203], a[136:139], v[64:67]
    v_mfma_f32_16x16x32_bf16 v[64:67], v[204:207], a[140:143], v[64:67]
    v_mfma_f32_16x16x32_bf16 v[68:71], v[208:211], a[128:131], 0
    v_mfma_f32_16x16x32_bf16 v[68:71], v[212:215], a[132:135], v[68:71]
    v_mfma_f32_16x16x32_bf16 v[68:71], v[216:219], a[136:139], v[68:71]
    v_mfma_f32_16x16x32_bf16 v[68:71], v[220:223], a[140:143], v[68:71]
    v_mfma_f32_16x16x32_bf16 v[72:75], v[192:195], a[144:147], 0
    v_mfma_f32_16x16x32_bf16 v[72:75], v[196:199], a[148:151], v[72:75]
    v_mfma_f32_16x16x32_bf16 v[72:75], v[200:203], a[152:155], v[72:75]
    v_mfma_f32_16x16x32_bf16 v[72:75], v[204:207], a[156:159], v[72:75]
    v_mfma_f32_16x16x32_bf16 v[76:79], v[208:211], a[144:147], 0
    v_mfma_f32_16x16x32_bf16 v[76:79], v[212:215], a[148:151], v[76:79]
    v_mfma_f32_16x16x32_bf16 v[76:79], v[216:219], a[152:155], v[76:79]
    v_mfma_f32_16x16x32_bf16 v[76:79], v[220:223], a[156:159], v[76:79]
    v_mfma_f32_16x16x32_bf16 v[80:83], v[224:227], a[128:131], 0
    v_mfma_f32_16x16x32_bf16 v[80:83], v[228:231], a[132:135], v[80:83]
    v_mfma_f32_16x16x32_bf16 v[80:83], v[232:235], a[136:139], v[80:83]
    v_mfma_f32_16x16x32_bf16 v[80:83], v[236:239], a[140:143], v[80:83]
    v_mfma_f32_16x16x32_bf16 v[84:87], v[240:243], a[128:131], 0
    v_mfma_f32_16x16x32_bf16 v[84:87], v[244:247], a[132:135], v[84:87]
    v_mfma_f32_16x16x32_bf16 v[84:87], v[248:251], a[136:139], v[84:87]
    v_mfma_f32_16x16x32_bf16 v[84:87], v[252:255], a[140:143], v[84:87]
    v_mfma_f32_16x16x32_bf16 v[88:91], v[224:227], a[144:147], 0
    v_mfma_f32_16x16x32_bf16 v[88:91], v[228:231], a[148:151], v[88:91]
    v_mfma_f32_16x16x32_bf16 v[88:91], v[232:235], a[152:155], v[88:91]
    v_mfma_f32_16x16x32_bf16 v[88:91], v[236:239], a[156:159], v[88:91]
    v_mfma_f32_16x16x32_bf16 v[92:95], v[240:243], a[144:147], 0
    v_mfma_f32_16x16x32_bf16 v[92:95], v[244:247], a[148:151], v[92:95]
    v_mfma_f32_16x16x32_bf16 v[92:95], v[248:251], a[152:155], v[92:95]
    v_mfma_f32_16x16x32_bf16 v[92:95], v[252:255], a[156:159], v[92:95]
    v_max_f32 v16, v32, v33
    v_max3_f32 v16, v16, v34, v35
    v_max3_f32 v16, v16, v36, v37
    v_max3_f32 v16, v16, v38, v39
    v_max3_f32 v16, v16, v48, v49
    v_max3_f32 v16, v16, v50, v51
    v_max3_f32 v16, v16, v52, v53
    v_max3_f32 v16, v16, v54, v55
    v_max3_f32 v16, v16, v64, v65
    v_max3_f32 v16, v16, v66, v67
    v_max3_f32 v16, v16, v68, v69
    v_max3_f32 v16, v16, v70, v71
    v_max3_f32 v16, v16, v80, v81
    v_max3_f32 v16, v16, v82, v83
    v_max3_f32 v16, v16, v84, v85
    v_max3_f32 v16, v16, v86, v87
    v_max_f32 v17, v40, v41
    v_max3_f32 v17, v17, v42, v43
    v_max3_f32 v17, v17, v44, v45
    v_max3_f32 v17, v17, v46, v47
    v_max3_f32 v17, v17, v56, v57
    v_max3_f32 v17, v17, v58, v59
    v_max3_f32 v17, v17, v60, v61
    v_max3_f32 v17, v17, v62, v63
    v_max3_f32 v17, v17, v72, v73
    v_max3_f32 v17, v17, v74, v75
    v_max3_f32 v17, v17, v76, v77
    v_max3_f32 v17, v17, v78, v79
    v_max3_f32 v17, v17, v88, v89
    v_max3_f32 v17, v17, v90, v91
    v_max3_f32 v17, v17, v92, v93
    v_max3_f32 v17, v17, v94, v95
    s_nop 1
    v_permlane32_swap_b32 v16, v17
    s_nop 1
    v_max_f32 v16, v16, v17
    v_mov_b32 v17, v16
    s_nop 1
    v_permlane16_swap_b32 v16, v17
    s_nop 1
    v_max_f32 v16, v16, v17
    ds_write_b32 v8, v16 offset:0
    s_waitcnt lgkmcnt(0)
    s_barrier
    ds_read_b128 v[20:23], v9 offset:0
    s_waitcnt lgkmcnt(0)
    v_max3_f32 v16, v20, v21, v22
    v_max_f32 v16, v16, v23
    v_mov_b32 v17, v16
    s_nop 1
    v_permlane32_swap_b32 v16, v17
    v_mov_b64 v[28:29], 0
    v_sub_f32 v32, v32, v16
    v_sub_f32 v33, v33, v16
    v_sub_f32 v34, v34, v16
    v_sub_f32 v35, v35, v16
    v_sub_f32 v36, v36, v16
    v_sub_f32 v37, v37, v16
    v_sub_f32 v38, v38, v16
    v_sub_f32 v39, v39, v16
    v_exp_f32 v32, v32
    v_exp_f32 v33, v33
    v_exp_f32 v34, v34
    v_exp_f32 v35, v35
    v_exp_f32 v36, v36
    v_exp_f32 v37, v37
    v_exp_f32 v38, v38
    v_exp_f32 v39, v39
    v_cvt_pk_bf16_f32 v96, v32, v33
    v_cvt_pk_bf16_f32 v97, v34, v35
    v_cvt_pk_bf16_f32 v98, v36, v37
    v_cvt_pk_bf16_f32 v99, v38, v39
    ds_write_b128 v3, v[96:99] offset:0
    v_add_f32 v28, v28, v32
    v_add_f32 v28, v28, v33
    v_add_f32 v28, v28, v34
    v_add_f32 v28, v28, v35
    v_add_f32 v28, v28, v36
    v_add_f32 v28, v28, v37
    v_add_f32 v28, v28, v38
    v_add_f32 v28, v28, v39
    v_sub_f32 v40, v40, v17
    v_sub_f32 v41, v41, v17
    v_sub_f32 v42, v42, v17
    v_sub_f32 v43, v43, v17
    v_sub_f32 v44, v44, v17
    v_sub_f32 v45, v45, v17
    v_sub_f32 v46, v46, v17
    v_sub_f32 v47, v47, v17
    v_exp_f32 v40, v40
    v_exp_f32 v41, v41
    v_exp_f32 v42, v42
    v_exp_f32 v43, v43
    v_exp_f32 v44, v44
    v_exp_f32 v45, v45
    v_exp_f32 v46, v46
    v_exp_f32 v47, v47
    v_cvt_pk_bf16_f32 v100, v40, v41
    v_cvt_pk_bf16_f32 v101, v42, v43
    v_cvt_pk_bf16_f32 v102, v44, v45
    v_cvt_pk_bf16_f32 v103, v46, v47
    ds_write_b128 v3, v[100:103] offset:1024
    v_add_f32 v29, v29, v40
    v_add_f32 v29, v29, v41
    v_add_f32 v29, v29, v42
    v_add_f32 v29, v29, v43
    v_add_f32 v29, v29, v44
    v_add_f32 v29, v29, v45
    v_add_f32 v29, v29, v46
    v_add_f32 v29, v29, v47
    v_sub_f32 v48, v48, v16
    v_sub_f32 v49, v49, v16
    v_sub_f32 v50, v50, v16
    v_sub_f32 v51, v51, v16
    v_sub_f32 v52, v52, v16
    v_sub_f32 v53, v53, v16
    v_sub_f32 v54, v54, v16
    v_sub_f32 v55, v55, v16
    v_exp_f32 v48, v48
    v_exp_f32 v49, v49
    v_exp_f32 v50, v50
    v_exp_f32 v51, v51
    v_exp_f32 v52, v52
    v_exp_f32 v53, v53
    v_exp_f32 v54, v54
    v_exp_f32 v55, v55
    v_cvt_pk_bf16_f32 v104, v48, v49
    v_cvt_pk_bf16_f32 v105, v50, v51
    v_cvt_pk_bf16_f32 v106, v52, v53
    v_cvt_pk_bf16_f32 v107, v54, v55
    ds_write_b128 v3, v[104:107] offset:2048
    v_add_f32 v28, v28, v48
    v_add_f32 v28, v28, v49
    v_add_f32 v28, v28, v50
    v_add_f32 v28, v28, v51
    v_add_f32 v28, v28, v52
    v_add_f32 v28, v28, v53
    v_add_f32 v28, v28, v54
    v_add_f32 v28, v28, v55
    v_sub_f32 v56, v56, v17
    v_sub_f32 v57, v57, v17
    v_sub_f32 v58, v58, v17
    v_sub_f32 v59, v59, v17
    v_sub_f32 v60, v60, v17
    v_sub_f32 v61, v61, v17
    v_sub_f32 v62, v62, v17
    v_sub_f32 v63, v63, v17
    v_exp_f32 v56, v56
    v_exp_f32 v57, v57
    v_exp_f32 v58, v58
    v_exp_f32 v59, v59
    v_exp_f32 v60, v60
    v_exp_f32 v61, v61
    v_exp_f32 v62, v62
    v_exp_f32 v63, v63
    v_cvt_pk_bf16_f32 v108, v56, v57
    v_cvt_pk_bf16_f32 v109, v58, v59
    v_cvt_pk_bf16_f32 v110, v60, v61
    v_cvt_pk_bf16_f32 v111, v62, v63
    ds_write_b128 v3, v[108:111] offset:3072
    v_add_f32 v29, v29, v56
    v_add_f32 v29, v29, v57
    v_add_f32 v29, v29, v58
    v_add_f32 v29, v29, v59
    v_add_f32 v29, v29, v60
    v_add_f32 v29, v29, v61
    v_add_f32 v29, v29, v62
    v_add_f32 v29, v29, v63
    v_sub_f32 v64, v64, v16
    v_sub_f32 v65, v65, v16
    v_sub_f32 v66, v66, v16
    v_sub_f32 v67, v67, v16
    v_sub_f32 v68, v68, v16
    v_sub_f32 v69, v69, v16
    v_sub_f32 v70, v70, v16
    v_sub_f32 v71, v71, v16
    v_exp_f32 v64, v64
    v_exp_f32 v65, v65
    v_exp_f32 v66, v66
    v_exp_f32 v67, v67
    v_exp_f32 v68, v68
    v_exp_f32 v69, v69
    v_exp_f32 v70, v70
    v_exp_f32 v71, v71
    v_cvt_pk_bf16_f32 v112, v64, v65
    v_cvt_pk_bf16_f32 v113, v66, v67
    v_cvt_pk_bf16_f32 v114, v68, v69
    v_cvt_pk_bf16_f32 v115, v70, v71
    ds_write_b128 v3, v[112:115] offset:4096
    v_add_f32 v28, v28, v64
    v_add_f32 v28, v28, v65
    v_add_f32 v28, v28, v66
    v_add_f32 v28, v28, v67
    v_add_f32 v28, v28, v68
    v_add_f32 v28, v28, v69
    v_add_f32 v28, v28, v70
    v_add_f32 v28, v28, v71
    v_sub_f32 v72, v72, v17
    v_sub_f32 v73, v73, v17
    v_sub_f32 v74, v74, v17
    v_sub_f32 v75, v75, v17
    v_sub_f32 v76, v76, v17
    v_sub_f32 v77, v77, v17
    v_sub_f32 v78, v78, v17
    v_sub_f32 v79, v79, v17
    v_exp_f32 v72, v72
    v_exp_f32 v73, v73
    v_exp_f32 v74, v74
    v_exp_f32 v75, v75
    v_exp_f32 v76, v76
    v_exp_f32 v77, v77
    v_exp_f32 v78, v78
    v_exp_f32 v79, v79
    v_cvt_pk_bf16_f32 v116, v72, v73
    v_cvt_pk_bf16_f32 v117, v74, v75
    v_cvt_pk_bf16_f32 v118, v76, v77
    v_cvt_pk_bf16_f32 v119, v78, v79
    ds_write_b128 v3, v[116:119] offset:5120
    v_add_f32 v29, v29, v72
    v_add_f32 v29, v29, v73
    v_add_f32 v29, v29, v74
    v_add_f32 v29, v29, v75
    v_add_f32 v29, v29, v76
    v_add_f32 v29, v29, v77
    v_add_f32 v29, v29, v78
    v_add_f32 v29, v29, v79
    v_sub_f32 v80, v80, v16
    v_sub_f32 v81, v81, v16
    v_sub_f32 v82, v82, v16
    v_sub_f32 v83, v83, v16
    v_sub_f32 v84, v84, v16
    v_sub_f32 v85, v85, v16
    v_sub_f32 v86, v86, v16
    v_sub_f32 v87, v87, v16
    v_exp_f32 v80, v80
    v_exp_f32 v81, v81
    v_exp_f32 v82, v82
    v_exp_f32 v83, v83
    v_exp_f32 v84, v84
    v_exp_f32 v85, v85
    v_exp_f32 v86, v86
    v_exp_f32 v87, v87
    v_cvt_pk_bf16_f32 v120, v80, v81
    v_cvt_pk_bf16_f32 v121, v82, v83
    v_cvt_pk_bf16_f32 v122, v84, v85
    v_cvt_pk_bf16_f32 v123, v86, v87
    ds_write_b128 v3, v[120:123] offset:6144
    v_add_f32 v28, v28, v80
    v_add_f32 v28, v28, v81
    v_add_f32 v28, v28, v82
    v_add_f32 v28, v28, v83
    v_add_f32 v28, v28, v84
    v_add_f32 v28, v28, v85
    v_add_f32 v28, v28, v86
    v_add_f32 v28, v28, v87
    v_sub_f32 v88, v88, v17
    v_sub_f32 v89, v89, v17
    v_sub_f32 v90, v90, v17
    v_sub_f32 v91, v91, v17
    v_sub_f32 v92, v92, v17
    v_sub_f32 v93, v93, v17
    v_sub_f32 v94, v94, v17
    v_sub_f32 v95, v95, v17
    v_exp_f32 v88, v88
    v_exp_f32 v89, v89
    v_exp_f32 v90, v90
    v_exp_f32 v91, v91
    v_exp_f32 v92, v92
    v_exp_f32 v93, v93
    v_exp_f32 v94, v94
    v_exp_f32 v95, v95
    v_cvt_pk_bf16_f32 v124, v88, v89
    v_cvt_pk_bf16_f32 v125, v90, v91
    v_cvt_pk_bf16_f32 v126, v92, v93
    v_cvt_pk_bf16_f32 v127, v94, v95
    ds_write_b128 v3, v[124:127] offset:7168
    v_add_f32 v29, v29, v88
    v_add_f32 v29, v29, v89
    v_add_f32 v29, v29, v90
    v_add_f32 v29, v29, v91
    v_add_f32 v29, v29, v92
    v_add_f32 v29, v29, v93
    v_add_f32 v29, v29, v94
    v_add_f32 v29, v29, v95
    s_nop 1
    v_permlane32_swap_b32 v28, v29
    s_nop 1
    v_add_f32 v28, v28, v29
    v_mov_b32 v29, v28
    s_nop 1
    v_permlane16_swap_b32 v28, v29
    s_nop 1
    v_add_f32 v14, v28, v29
    ds_write_b32 v8, v14 offset:512
    s_waitcnt lgkmcnt(0)
    s_barrier
    ds_read_b128 v[20:23], v9 offset:512
    v_mfma_f32_16x16x32_bf16 v[32:35], a[0:3], v[96:99], 0
    v_mfma_f32_16x16x32_bf16 v[32:35], a[4:7], v[104:107], v[32:35]
    v_mfma_f32_16x16x32_bf16 v[32:35], a[8:11], v[112:115], v[32:35]
    v_mfma_f32_16x16x32_bf16 v[32:35], a[12:15], v[120:123], v[32:35]
    v_mfma_f32_16x16x32_bf16 v[36:39], a[64:67], v[96:99], 0
    v_mfma_f32_16x16x32_bf16 v[36:39], a[68:71], v[104:107], v[36:39]
    v_mfma_f32_16x16x32_bf16 v[36:39], a[72:75], v[112:115], v[36:39]
    v_mfma_f32_16x16x32_bf16 v[36:39], a[76:79], v[120:123], v[36:39]
    v_mfma_f32_16x16x32_bf16 v[40:43], a[0:3], v[100:103], 0
    v_mfma_f32_16x16x32_bf16 v[40:43], a[4:7], v[108:111], v[40:43]
    v_mfma_f32_16x16x32_bf16 v[40:43], a[8:11], v[116:119], v[40:43]
    v_mfma_f32_16x16x32_bf16 v[40:43], a[12:15], v[124:127], v[40:43]
    v_mfma_f32_16x16x32_bf16 v[44:47], a[64:67], v[100:103], 0
    v_mfma_f32_16x16x32_bf16 v[44:47], a[68:71], v[108:111], v[44:47]
    v_mfma_f32_16x16x32_bf16 v[44:47], a[72:75], v[116:119], v[44:47]
    v_mfma_f32_16x16x32_bf16 v[44:47], a[76:79], v[124:127], v[44:47]
    ds_read_b128 a[160:163], v4 offset:0
    ds_read_b128 a[164:167], v4 offset:1024
    ds_read_b128 a[168:171], v4 offset:2048
    ds_read_b128 a[172:175], v4 offset:3072
    ds_read_b128 a[176:179], v4 offset:4096
    ds_read_b128 a[180:183], v4 offset:5120
    ds_read_b128 a[184:187], v4 offset:6144
    ds_read_b128 a[188:191], v4 offset:7168
    s_waitcnt lgkmcnt(7)
    v_mfma_f32_16x16x32_bf16 v[32:35], a[16:19], a[160:163], v[32:35]
    s_waitcnt lgkmcnt(5)
    v_mfma_f32_16x16x32_bf16 v[32:35], a[20:23], a[168:171], v[32:35]
    s_waitcnt lgkmcnt(3)
    v_mfma_f32_16x16x32_bf16 v[32:35], a[24:27], a[176:179], v[32:35]
    s_waitcnt lgkmcnt(1)
    v_mfma_f32_16x16x32_bf16 v[32:35], a[28:31], a[184:187], v[32:35]
    v_mfma_f32_16x16x32_bf16 v[36:39], a[80:83], a[160:163], v[36:39]
    v_mfma_f32_16x16x32_bf16 v[36:39], a[84:87], a[168:171], v[36:39]
    v_mfma_f32_16x16x32_bf16 v[36:39], a[88:91], a[176:179], v[36:39]
    v_mfma_f32_16x16x32_bf16 v[36:39], a[92:95], a[184:187], v[36:39]
    v_mfma_f32_16x16x32_bf16 v[40:43], a[16:19], a[164:167], v[40:43]
    v_mfma_f32_16x16x32_bf16 v[40:43], a[20:23], a[172:175], v[40:43]
    v_mfma_f32_16x16x32_bf16 v[40:43], a[24:27], a[180:183], v[40:43]
    s_waitcnt lgkmcnt(0)
    v_mfma_f32_16x16x32_bf16 v[40:43], a[28:31], a[188:191], v[40:43]
    v_mfma_f32_16x16x32_bf16 v[44:47], a[80:83], a[164:167], v[44:47]
    v_mfma_f32_16x16x32_bf16 v[44:47], a[84:87], a[172:175], v[44:47]
    v_mfma_f32_16x16x32_bf16 v[44:47], a[88:91], a[180:183], v[44:47]
    v_mfma_f32_16x16x32_bf16 v[44:47], a[92:95], a[188:191], v[44:47]
    ds_read_b128 a[160:163], v5 offset:0
    ds_read_b128 a[164:167], v5 offset:1024
    ds_read_b128 a[168:171], v5 offset:2048
    ds_read_b128 a[172:175], v5 offset:3072
    ds_read_b128 a[176:179], v5 offset:4096
    ds_read_b128 a[180:183], v5 offset:5120
    ds_read_b128 a[184:187], v5 offset:6144
    ds_read_b128 a[188:191], v5 offset:7168
    s_waitcnt lgkmcnt(7)
    v_mfma_f32_16x16x32_bf16 v[32:35], a[32:35], a[160:163], v[32:35]
    s_waitcnt lgkmcnt(5)
    v_mfma_f32_16x16x32_bf16 v[32:35], a[36:39], a[168:171], v[32:35]
    s_waitcnt lgkmcnt(3)
    v_mfma_f32_16x16x32_bf16 v[32:35], a[40:43], a[176:179], v[32:35]
    s_waitcnt lgkmcnt(1)
    v_mfma_f32_16x16x32_bf16 v[32:35], a[44:47], a[184:187], v[32:35]
    v_mfma_f32_16x16x32_bf16 v[36:39], a[96:99], a[160:163], v[36:39]
    v_mfma_f32_16x16x32_bf16 v[36:39], a[100:103], a[168:171], v[36:39]
    v_mfma_f32_16x16x32_bf16 v[36:39], a[104:107], a[176:179], v[36:39]
    v_mfma_f32_16x16x32_bf16 v[36:39], a[108:111], a[184:187], v[36:39]
    v_mfma_f32_16x16x32_bf16 v[40:43], a[32:35], a[164:167], v[40:43]
    v_mfma_f32_16x16x32_bf16 v[40:43], a[36:39], a[172:175], v[40:43]
    v_mfma_f32_16x16x32_bf16 v[40:43], a[40:43], a[180:183], v[40:43]
    s_waitcnt lgkmcnt(0)
    v_mfma_f32_16x16x32_bf16 v[40:43], a[44:47], a[188:191], v[40:43]
    v_mfma_f32_16x16x32_bf16 v[44:47], a[96:99], a[164:167], v[44:47]
    v_mfma_f32_16x16x32_bf16 v[44:47], a[100:103], a[172:175], v[44:47]
    v_mfma_f32_16x16x32_bf16 v[44:47], a[104:107], a[180:183], v[44:47]
    v_mfma_f32_16x16x32_bf16 v[44:47], a[108:111], a[188:191], v[44:47]
    ds_read_b128 a[160:163], v6 offset:0
    ds_read_b128 a[164:167], v6 offset:1024
    ds_read_b128 a[168:171], v6 offset:2048
    ds_read_b128 a[172:175], v6 offset:3072
    ds_read_b128 a[176:179], v6 offset:4096
    ds_read_b128 a[180:183], v6 offset:5120
    ds_read_b128 a[184:187], v6 offset:6144
    ds_read_b128 a[188:191], v6 offset:7168
    s_waitcnt lgkmcnt(7)
    v_mfma_f32_16x16x32_bf16 v[32:35], a[48:51], a[160:163], v[32:35]
    s_waitcnt lgkmcnt(5)
    v_mfma_f32_16x16x32_bf16 v[32:35], a[52:55], a[168:171], v[32:35]
    s_waitcnt lgkmcnt(3)
    v_mfma_f32_16x16x32_bf16 v[32:35], a[56:59], a[176:179], v[32:35]
    s_waitcnt lgkmcnt(1)
    v_mfma_f32_16x16x32_bf16 v[32:35], a[60:63], a[184:187], v[32:35]
    v_mfma_f32_16x16x32_bf16 v[36:39], a[112:115], a[160:163], v[36:39]
    v_mfma_f32_16x16x32_bf16 v[36:39], a[116:119], a[168:171], v[36:39]
    v_mfma_f32_16x16x32_bf16 v[36:39], a[120:123], a[176:179], v[36:39]
    v_mfma_f32_16x16x32_bf16 v[36:39], a[124:127], a[184:187], v[36:39]
    v_mfma_f32_16x16x32_bf16 v[40:43], a[48:51], a[164:167], v[40:43]
    v_mfma_f32_16x16x32_bf16 v[40:43], a[52:55], a[172:175], v[40:43]
    v_mfma_f32_16x16x32_bf16 v[40:43], a[56:59], a[180:183], v[40:43]
    s_waitcnt lgkmcnt(0)
    v_mfma_f32_16x16x32_bf16 v[40:43], a[60:63], a[188:191], v[40:43]
    v_mfma_f32_16x16x32_bf16 v[44:47], a[112:115], a[164:167], v[44:47]
    v_mfma_f32_16x16x32_bf16 v[44:47], a[116:119], a[172:175], v[44:47]
    v_mfma_f32_16x16x32_bf16 v[44:47], a[120:123], a[180:183], v[44:47]
    v_mfma_f32_16x16x32_bf16 v[44:47], a[124:127], a[188:191], v[44:47]
    v_add_f32 v20, v20, v21
    v_add_f32 v22, v22, v23
    v_add_f32 v20, v20, v22
    v_rcp_f32 v12, v20
    s_nop 0
    v_mov_b32 v13, v12
    s_nop 1
    v_permlane32_swap_b32 v12, v13
    v_mul_f32 v32, v32, v12
    v_mul_f32 v33, v33, v12
    v_mul_f32 v34, v34, v12
    v_mul_f32 v35, v35, v12
    v_mul_f32 v36, v36, v12
    v_mul_f32 v37, v37, v12
    v_mul_f32 v38, v38, v12
    v_mul_f32 v39, v39, v12
    v_cvt_pk_bf16_f32 v32, v32, v33
    v_cvt_pk_bf16_f32 v33, v34, v35
    v_cvt_pk_bf16_f32 v34, v36, v37
    v_cvt_pk_bf16_f32 v35, v38, v39
    buffer_store_dwordx4 v[32:35], v2, s[24:27], s30 offen
    s_add_u32 s30, s30, 4096
    v_mul_f32 v40, v40, v13
    v_mul_f32 v41, v41, v13
    v_mul_f32 v42, v42, v13
    v_mul_f32 v43, v43, v13
    v_mul_f32 v44, v44, v13
    v_mul_f32 v45, v45, v13
    v_mul_f32 v46, v46, v13
    v_mul_f32 v47, v47, v13
    v_cvt_pk_bf16_f32 v40, v40, v41
    v_cvt_pk_bf16_f32 v41, v42, v43
    v_cvt_pk_bf16_f32 v42, v44, v45
    v_cvt_pk_bf16_f32 v43, v46, v47
    buffer_store_dwordx4 v[40:43], v2, s[24:27], s30 offen
    s_add_u32 s30, s30, 4096
    s_cmp_lt_u32 s30, 409600
    s_cbranch_scc1 L_slow
L_end:
    s_endpgm
.section .rodata,"a"
.p2align 6
.amdhsa_kernel standalone__mha_softmax__near_ridge_kernel
  .amdhsa_next_free_vgpr 512
  .amdhsa_next_free_sgpr 102
  .amdhsa_accum_offset 256
  .amdhsa_group_segment_fixed_size 0
  .amdhsa_kernarg_size 48
  .amdhsa_user_sgpr_count 2
  .amdhsa_user_sgpr_kernarg_segment_ptr 1
  .amdhsa_system_sgpr_workgroup_id_x 1
.end_amdhsa_kernel
```
